```python
import torch

def _softmax(x, axis=-1):
    return torch.softmax(x, dim=axis)
def _gelu(x):
    return torch.nn.functional.gelu(x, approximate="tanh")
def _silu(x):
    return torch.nn.functional.silu(x)
def _sigmoid(x):
    return torch.sigmoid(x)
def _layernorm(x, axis=-1, eps=1e-5):
    m = x.mean(dim=axis, keepdim=True)
    v = x.var(dim=axis, keepdim=True, unbiased=False)
    return (x - m) / torch.sqrt(v + eps)
def _scatter_add(tgt, idx, src, axis=0):
    return tgt.clone().index_add_(axis, idx, src)
def _segment_sum(src, seg, n):
    out = torch.zeros((n,) + src.shape[1:], dtype=src.dtype)
    return out.index_add_(0, seg, src)
def _pad(x, pw):
    flat = tuple(v for pair in reversed(pw) for v in pair)
    return torch.nn.functional.pad(x, flat)

kernel_name = 'parallel_sum__mha_block__glu_gated_reglu__prompt'

def setup_inputs():

    _w = (lambda a: (lambda t: t.to(torch.bfloat16) if t.is_floating_point() else t)(torch.as_tensor(a)))
    def _A_setup():
        B, S, D, H = 1, 2048, 512, 32
        return {
            "x": _w((lambda *s: torch.randn(*s, dtype=torch.bfloat16) * 0.05)(B, S, D)),
            "wqkv": _w((lambda *s: torch.randn(*s, dtype=torch.bfloat16) * 0.05)(D, 3 * D)),
            "wo": _w((lambda *s: torch.randn(*s, dtype=torch.bfloat16) * 0.05)(D, D)),
        }
    _A_in = _A_setup()

    def _B_setup():
        B, S, D, F = 1, 2048, 512, 1792
        return {
            "x": _w((lambda *s: torch.randn(*s, dtype=torch.bfloat16) * 0.05)(B, S, D)),
            "W_gate": _w((lambda *s: torch.randn(*s, dtype=torch.bfloat16) * 0.4)(D, F) * (2.0 / D) ** 0.5),
            "W_up": _w((lambda *s: torch.randn(*s, dtype=torch.bfloat16) * 0.4)(D, F) * (2.0 / D) ** 0.5),
            "W_down": _w((lambda *s: torch.randn(*s, dtype=torch.bfloat16) * 0.4)(F, D) * (1.0 / F) ** 0.5),
        }
    _B_in = _B_setup()

    return {
        "A_x": _A_in["x"],
        "A_wqkv": _A_in["wqkv"],
        "A_wo": _A_in["wo"],
        "B_x": _B_in["x"],
        "B_W_gate": _B_in["W_gate"],
        "B_W_up": _B_in["W_up"],
        "B_W_down": _B_in["W_down"],
    }

def reference(A_x, A_wqkv, A_wo, B_x, B_W_gate, B_W_up, B_W_down):
    def _A_ref(x, wqkv, wo):
        B, S, D = x.shape
        H = 32
        Dh = D // H
        qkv = (lambda x, *d: x.permute(*d))((x @ wqkv).reshape(B, S, 3, H, Dh), 2, 0, 3, 1, 4)
        q, k, v = qkv[0], qkv[1], qkv[2]
        scores = torch.einsum("bhqd,bhkd->bhqk", q, k) * (Dh ** -0.5)
        p = _softmax(scores, axis=-1)
        o = torch.einsum("bhqk,bhkd->bhqd", p, v)
        return (lambda x, *d: x.permute(*d))(o, 0, 2, 1, 3).reshape(B, S, D) @ wo

    def _B_ref(x, W_gate, W_up, W_down):
        gate = torch.einsum("bsd,df->bsf", x, W_gate)
        up = torch.einsum("bsd,df->bsf", x, W_up)
        gate = gate * (lambda x, dt: x.to(dt))(gate > 0, gate.dtype)
        h = gate * up
        return torch.einsum("bsf,fd->bsd", h, W_down)

    x = A_x
    xn = _layernorm(x, axis=-1)
    return x + _A_ref(xn, A_wqkv, A_wo) + _B_ref(xn, B_W_gate, B_W_up, B_W_down)
```

```asm
; @launch grid=(256,1,1) block=(512,1,1) lds=163840
.amdgcn_target "amdgcn-amd-amdhsa--gfx950"
.text
.globl parallel_sum__mha_block__glu_gated_reglu__prompt_kernel
.p2align 8
.type parallel_sum__mha_block__glu_gated_reglu__prompt_kernel,@function
parallel_sum__mha_block__glu_gated_reglu__prompt_kernel:
    s_cmpk_ge_u32 s2, 0x100
    s_cbranch_scc1 L_exit
    s_load_dwordx2 s[8:9], s[0:1], 0
    s_load_dwordx2 s[12:13], s[0:1], 8
    v_lshrrev_b32 v3, 6, v0
    v_and_b32 v4, 63, v0
    v_readfirstlane_b32 s3, v3
    s_lshr_b32 s5, s2, 3
    v_lshlrev_b32 v1, 4, v4
    s_cmp_lg_u32 s3, 7
    s_cbranch_scc1 L_nocpf
    s_getpc_b64 s[52:53]
L_pc:
    s_and_b32 s51, s5, 7
    s_lshl_b32 s51, s51, 13
    v_lshl_add_u32 v5, v4, 7, s51
    v_min_u32 v5, L_exit-L_pc, v5
    global_load_dword v255, v5, s[52:53]
L_nocpf:
    s_and_b32 s32, s3, 3
    s_lshl2_add_u32 s33, s2, s2
    s_and_b32 s33, s33, 6
    v_lshrrev_b32 v5, 3, v4
    s_cmp_ge_u32 s3, 4
    s_cbranch_scc1 L_iG
    s_and_b32 s51, s5, 3
    s_and_b32 s52, s2, 6
    s_lshl1_add_u32 s52, s52, s51
    s_lshl2_add_u32 s52, s52, s32
    s_lshl_b32 s52, s52, 8
    s_add_u32 s52, s52, s33
    s_lshl_b32 s54, s52, 7
    s_lshl_b32 s56, s32, 12
    v_lshrrev_b32 v3, 4, v4
    v_xor_b32 v3, v3, v4
    v_and_b32 v3, 7, v3
    v_lshlrev_b32 v44, 10, v5
    v_lshl_add_u32 v44, v3, 4, v44
    v_xor_b32 v45, 64, v44
    v_add_u32 v45, 7168, v45
    s_bfm_b32 s10, 1, 21
    s_mov_b32 s11, 0x00020000
    s_add_u32 m0, s56, 0
    s_waitcnt lgkmcnt(0)
    buffer_load_dwordx4 v44, s[8:11], s54 offen lds
    s_add_u32 s55, s54, 14336
    buffer_load_dwordx4 v45, s[8:11], s54 offen offset:1024 lds
    buffer_load_dwordx4 v44, s[8:11], s55 offen offset:2048 lds
    buffer_load_dwordx4 v45, s[8:11], s55 offen offset:3072 lds
    s_barrier
    s_add_u32 m0, s56, 32768
    s_add_u32 s54, s54, 128
    buffer_load_dwordx4 v44, s[8:11], s54 offen lds
    s_add_u32 s55, s54, 14336
    buffer_load_dwordx4 v45, s[8:11], s54 offen offset:1024 lds
    buffer_load_dwordx4 v44, s[8:11], s55 offen offset:2048 lds
    buffer_load_dwordx4 v45, s[8:11], s55 offen offset:3072 lds
    s_branch L_iX
L_iG:
    s_and_b32 s51, s2, 1
    s_lshr_b32 s52, s2, 7
    s_lshl1_add_u32 s51, s51, s52
    s_bitcmp1_b32 s2, 5
    s_addc_u32 s51, s51, s51
    s_lshl2_add_u32 s52, s33, s32
    s_mulk_i32 s52, 384
    s_add_u32 s51, s51, s52
    s_bitcmp1_b32 s2, 6
    s_cselect_b32 s52, 0, 16
    s_add_u32 s51, s51, s52
    s_lshl_b32 s54, s51, 7
    s_add_u32 s51, s32, 8
    s_lshl_b32 s56, s51, 11
    v_lshrrev_b32 v3, 2, v4
    v_and_b32 v3, 4, v3
    v_xor_b32 v3, v3, v4
    v_and_b32 v3, 7, v3
    v_mul_u32_u24 v44, 3072, v5
    v_lshl_add_u32 v44, v3, 4, v44
    v_xor_b32 v45, 32, v44
    v_add_u32 v45, 23552, v45
    s_bfm_b32 s14, 2, 19
    s_mov_b32 s15, 0x00020000
    s_add_u32 m0, s56, 0
    s_waitcnt lgkmcnt(0)
    buffer_load_dwordx4 v44, s[12:15], s54 offen lds
    buffer_load_dwordx4 v45, s[12:15], s54 offen offset:1024 lds
    s_add_u32 m0, s56, 7168
    s_bitcmp0_b32 s2, 6
    s_cbranch_scc1 L_ip0
    buffer_load_dwordx4 v44, s[12:15], s54 offen offset:1024 lds
    buffer_load_dwordx4 v45, s[12:15], s54 offen offset:2048 lds
L_ip0:
    s_barrier
    s_add_u32 m0, s56, 32768
    s_add_u32 s54, s54, 196608
    buffer_load_dwordx4 v44, s[12:15], s54 offen lds
    buffer_load_dwordx4 v45, s[12:15], s54 offen offset:1024 lds
    s_add_u32 m0, s56, 39936
    s_bitcmp0_b32 s2, 6
    s_cbranch_scc1 L_ip1
    buffer_load_dwordx4 v44, s[12:15], s54 offen offset:1024 lds
    buffer_load_dwordx4 v45, s[12:15], s54 offen offset:2048 lds
L_ip1:
L_iX:
    s_load_dwordx2 s[16:17], s[0:1], 72
    s_load_dwordx2 s[44:45], s[0:1], 64
    s_load_dwordx2 s[20:21], s[0:1], 32
    s_load_dwordx2 s[24:25], s[0:1], 40
    s_load_dwordx2 s[28:29], s[0:1], 48
    s_load_dwordx2 s[36:37], s[0:1], 16
    s_load_dwordx2 s[40:41], s[0:1], 56
    s_bfm_b32 s10, 1, 21
    s_mov_b32 s11, 0x00020000
    s_bfm_b32 s14, 2, 19
    s_mov_b32 s15, 0x00020000
    v_and_b32 v3, 0xc0, v1
    v_and_b32 v5, 0xb0, v1
    v_lshrrev_b32 v5, 1, v5
    v_lshl_add_u32 v9, v3, 1, v5
    v_lshrrev_b32 v5, 4, v4
    v_lshl_add_u32 v9, v5, 10, v9
    v_and_b32 v3, 16, v4
    v_lshl_add_u32 v9, v3, 1, v9
    s_and_b32 s51, s3, 4
    s_lshl_b32 s51, s51, 4
    v_xor_b32 v46, s51, v9
    v_xor_b32 v6, 32, v46
    s_and_b32 s51, s32, 2
    s_lshl_b32 s51, s51, 4
    s_and_b32 s52, s32, 1
    s_lshl_b32 s52, s52, 12
    s_or_b32 s51, s51, s52
    v_xor_b32 v7, s51, v46
    v_bfe_u32 v3, v4, 1, 3
    v_xor_b32 v3, v3, v5
    v_lshlrev_b32 v3, 4, v3
    v_and_b32 v5, 15, v4
    v_lshl_add_u32 v3, v5, 7, v3
    s_lshl_b32 s51, s32, 12
    v_add_u32 v12, s51, v3
    v_xor_b32 v13, 64, v12
    v_mov_b32 v14, 0
    v_mov_b32 v15, 0
    s_mov_b32 s71, 0x3f803f80
    v_mov_b32 v40, 0
    v_mov_b32 v41, 0
    v_mov_b32 v42, 0
    v_mov_b32 v43, 0
    s_cmp_ge_u32 s3, 4
    s_cbranch_scc1 L_gem
    s_and_b32 s4, s2, 7
    s_and_b32 s51, s5, 3
    s_and_b32 s52, s2, 6
    s_lshl1_add_u32 s6, s52, s51
    s_lshr_b32 s35, s5, 2
    s_and_b32 s52, s2, 1
    s_lshl3_add_u32 s7, s52, s35
    s_lshl2_add_u32 s34, s4, s51
    s_mov_b32 s72, 0xffff0000
    s_lshr_b32 s61, s3, 2
    s_lshl2_add_u32 s62, s6, s32
    s_mov_b32 s18, 0x1800000
    s_mov_b32 s19, 0x00020000
    s_mov_b32 s46, 0x100
    s_mov_b32 s47, 0x00020000
    s_mov_b32 s22, 0x1c0000
    s_mov_b32 s23, 0x00020000
    s_mov_b32 s26, 0x1c0000
    s_mov_b32 s27, 0x00020000
    s_mov_b32 s30, 0x1c0000
    s_mov_b32 s31, 0x00020000
    s_mov_b32 s38, 0x80000
    s_mov_b32 s39, 0x00020000
    s_mov_b32 s42, 0x200000
    s_mov_b32 s43, 0x00020000
    s_or_b32 s51, s3, s2
    s_cmp_lg_u32 s51, 0
    s_cbranch_scc1 L_notok
    s_memrealtime s[52:53]
    s_waitcnt lgkmcnt(0)
    s_or_b32 s52, s52, 1
    v_mov_b32 v4, s52
    v_mov_b32 v5, s53
    s_mov_b64 exec, 1
    buffer_store_dwordx2 v[4:5], off, s[44:47], 0 sc1
    s_mov_b64 exec, -1
    s_nop 1
L_notok:
    s_lshr_b32 s51, s7, 2
    s_mul_i32 s51, s51, 7
    s_and_b32 s52, s7, 3
    s_lshl1_add_u32 s51, s52, s51
    s_cmp_eq_u32 s52, 3
    s_cselect_b32 s63, 2, 0
    s_subb_u32 s51, s51, 0
    s_bitcmp1_b32 s2, 6
    s_cselect_b32 s52, 3, 4
    s_mul_i32 s52, s52, s61
    s_add_u32 s63, s63, s52
    s_lshl3_add_u32 s52, s33, s3
    s_mul_i32 s52, s52, 224
    s_add_u32 s52, s52, s51
    s_lshl_b32 s58, s52, 7
    s_lshl_b32 s59, s3, 10
    s_lshl2_add_u32 s51, s51, s63
    s_mul_i32 s52, s62, 144
    s_add_u32 s51, s51, s52
    s_lshl_b32 s51, s51, 10
    s_add_u32 s77, s51, 8388608
    s_lshr_b32 s51, s7, 2
    s_and_b32 s52, s7, 1
    s_lshl1_add_u32 s51, s51, s52
    s_lshl1_add_u32 s51, s51, s61
    s_lshl_b32 s51, s51, 7
    s_add_u32 s51, s51, s62
    s_lshl_b32 s51, s51, 10
    s_add_u32 s74, s51, 2097152
    v_lshrrev_b32 v3, 2, v1
    v_and_b32 v3, 64, v3
    v_xor_b32 v3, v3, v1
    v_and_b32 v3, 0x70, v3
    s_and_b32 s51, s3, 1
    s_lshl_b32 s51, s51, 5
    v_xor_b32 v3, s51, v3
    v_lshrrev_b32 v4, 7, v1
    v_mul_u32_u24 v8, 3584, v4
    v_add_u32 v8, v8, v3
    v_mov_b32 v3, v9
    s_add_u32 s51, s63, 0
    s_and_b32 s52, s51, 3
    s_lshl_b32 s52, s52, 5
    s_lshr_b32 s51, s51, 2
    s_lshl_b32 s51, s51, 14
    s_or_b32 s51, s51, s52
    v_xor_b32 v9, s51, v3
    s_add_u32 s51, s63, 1
    s_and_b32 s52, s51, 3
    s_lshl_b32 s52, s52, 5
    s_lshr_b32 s51, s51, 2
    s_lshl_b32 s51, s51, 14
    s_or_b32 s51, s51, s52
    v_xor_b32 v10, s51, v3
    s_add_u32 s51, s63, 2
    s_and_b32 s52, s51, 3
    s_lshl_b32 s52, s52, 5
    s_lshr_b32 s51, s51, 2
    s_lshl_b32 s51, s51, 14
    s_or_b32 s51, s51, s52
    v_xor_b32 v11, s51, v3
    s_add_u32 s51, s63, 3
    s_and_b32 s52, s51, 3
    s_lshl_b32 s52, s52, 5
    s_lshr_b32 s51, s51, 2
    s_lshl_b32 s51, s51, 14
    s_or_b32 s51, s51, s52
    v_xor_b32 v47, s51, v3
    s_waitcnt lgkmcnt(0)
    s_lshr_b32 s51, s62, 1
    s_lshl4_add_u32 s51, s51, s7
    s_lshl1_add_u32 s51, s51, s61
    s_and_b32 s52, s62, 1
    s_lshl1_add_u32 s51, s51, s52
    s_lshl_b32 s51, s51, 3
    s_add_u32 s78, s51, 17891328
    s_lshl_b32 s94, s34, 16
    s_lshl_b32 s52, s35, 7
    s_add_u32 s94, s94, s52
    s_lshl1_add_u32 s0, s7, s61
    s_lshl_b32 s0, s0, 13
    s_add_u32 s0, s0, 18350080
    s_lshl_b32 s52, s6, 9
    s_add_u32 s1, s0, s52
    s_lshl_b32 s51, s61, 1
    s_cmp_eq_u32 s32, s51
    s_cselect_b32 s1, s1, 0x7ff00000
    s_and_b32 s52, s6, 1
    s_lshl_b32 s60, s52, 12
    s_bitcmp1_b32 s6, 1
    s_cselect_b32 s52, 32768, 0
    s_add_u32 s60, s60, s52
    s_and_b32 s52, s32, 1
    s_lshl_b32 s52, s52, 12
    s_add_u32 s0, s0, s52
    s_lshr_b32 s52, s32, 1
    s_lshl_b32 s52, s52, 8
    s_add_u32 s0, s0, s52
    s_lshl_b32 s57, s7, 4
    s_add_u32 s57, s57, s6
    s_lshl_b32 s57, s57, 7
    s_add_u32 s57, s57, 17825792
    s_lshl_b32 s51, s34, 16
    s_add_u32 s81, s51, 4194304
    s_lshl_b32 s52, s3, 14
    s_add_u32 s79, s81, s52
    s_add_u32 s80, s79, 2097152
    s_lshl_b32 s52, s35, 13
    s_add_u32 s51, s51, s52
    s_add_u32 s51, s51, 2097152
    s_mov_b32 s82, 0x0000ffff
    s_mov_b32 s83, 0x0000ffff
    s_add_u32 s52, s3, 1
    s_and_b32 s52, s52, 3
    s_lshl_b32 s52, s52, 11
    s_add_u32 s86, s52, s51
    s_add_u32 s52, s3, 2
    s_and_b32 s52, s52, 3
    s_lshl_b32 s52, s52, 11
    s_add_u32 s87, s52, s51
    s_add_u32 s52, s3, 3
    s_and_b32 s52, s52, 3
    s_lshl_b32 s52, s52, 11
    s_add_u32 s88, s52, s51
    s_add_u32 s52, s3, 4
    s_and_b32 s52, s52, 3
    s_lshl_b32 s52, s52, 11
    s_add_u32 s89, s52, s51
    s_lshl_b32 s52, s35, 2
    s_add_u32 s52, s52, s3
    s_lshl_b32 s85, s52, 5
    s_add_u32 s85, s85, s34
    s_lshl_b32 s85, s85, 7
    s_add_u32 s85, s85, 17956864
    s_mul_i32 s84, s52, 288
    s_add_u32 s84, s84, s34
    s_add_u32 s84, s84, 112
    s_lshl_b32 s84, s84, 10
    s_add_u32 s84, s84, 8388608
    s_add_u32 s52, s3, 0
    s_and_b32 s52, s52, 3
    s_mul_i32 s90, s52, 18432
    s_add_u32 s90, s90, 73728
    s_add_u32 s52, s3, 1
    s_and_b32 s52, s52, 3
    s_mul_i32 s91, s52, 18432
    s_add_u32 s91, s91, 73728
    s_add_u32 s52, s3, 2
    s_and_b32 s52, s52, 3
    s_mul_i32 s92, s52, 18432
    s_add_u32 s92, s92, 79872
    s_add_u32 s52, s3, 3
    s_and_b32 s52, s52, 3
    s_mul_i32 s93, s52, 18432
    s_add_u32 s93, s93, 86016
    s_bitcmp1_b32 s2, 6
    s_cbranch_scc1 L_AR
    s_setprio 0
    s_waitcnt vmcnt(4)
    s_barrier
    s_add_u32 m0, s56, 65536
    s_add_u32 s54, s54, 128
    s_cmp_eq_u32 s33, 6
    s_cselect_b32 s52, 1024, 0
    s_sub_u32 s54, s54, s52
    buffer_load_dwordx4 v44, s[8:11], s54 offen lds
    s_add_u32 s55, s54, 14336
    buffer_load_dwordx4 v45, s[8:11], s54 offen offset:1024 lds
    buffer_load_dwordx4 v44, s[8:11], s55 offen offset:2048 lds
    buffer_load_dwordx4 v45, s[8:11], s55 offen offset:3072 lds
    s_add_u32 m0, s56, 98304
    s_add_u32 s54, s54, 128
    buffer_load_dwordx4 v44, s[8:11], s54 offen lds
    s_add_u32 s55, s54, 14336
    buffer_load_dwordx4 v45, s[8:11], s54 offen offset:1024 lds
    buffer_load_dwordx4 v44, s[8:11], s55 offen offset:2048 lds
    buffer_load_dwordx4 v45, s[8:11], s55 offen offset:3072 lds
    ds_read_b128 v[128:131], v12 offset:0
    ds_read_b128 v[132:135], v12 offset:2048
    ds_read_b128 v[136:139], v13 offset:0
    ds_read_b128 v[140:143], v13 offset:2048
    ds_read_b64_tr_b16 v[16:17], v46 offset:16384
    ds_read_b64_tr_b16 v[18:19], v46 offset:16896
    ds_read_b64_tr_b16 v[20:21], v6 offset:16384
    ds_read_b64_tr_b16 v[22:23], v6 offset:16896
    ds_read_b64_tr_b16 v[24:25], v46 offset:20480
    ds_read_b64_tr_b16 v[26:27], v46 offset:20992
    ds_read_b64_tr_b16 v[28:29], v6 offset:20480
    ds_read_b64_tr_b16 v[30:31], v6 offset:20992
    ds_read_b64_tr_b16 v[88:89], v7 offset:16384
    ds_read_b64_tr_b16 v[90:91], v7 offset:16896
    s_waitcnt lgkmcnt(0)
    s_waitcnt vmcnt(8)
    s_barrier
    s_add_u32 m0, s56, 0
    s_add_u32 s54, s54, 128
    s_cmp_eq_u32 s33, 4
    s_cselect_b32 s52, 1024, 0
    s_sub_u32 s54, s54, s52
    buffer_load_dwordx4 v44, s[8:11], s54 offen lds
    s_add_u32 s55, s54, 14336
    buffer_load_dwordx4 v45, s[8:11], s54 offen offset:1024 lds
    buffer_load_dwordx4 v44, s[8:11], s55 offen offset:2048 lds
    buffer_load_dwordx4 v45, s[8:11], s55 offen offset:3072 lds
    ds_read_b128 v[144:147], v12 offset:32768
    ds_read_b128 v[148:151], v12 offset:34816
    ds_read_b128 v[152:155], v13 offset:32768
    ds_read_b128 v[156:159], v13 offset:34816
    ds_read_b64_tr_b16 v[48:49], v46 offset:49152
    ds_read_b64_tr_b16 v[50:51], v46 offset:49664
    ds_read_b64_tr_b16 v[52:53], v6 offset:49152
    ds_read_b64_tr_b16 v[54:55], v6 offset:49664
    ds_read_b64_tr_b16 v[56:57], v46 offset:53248
    ds_read_b64_tr_b16 v[58:59], v46 offset:53760
    ds_read_b64_tr_b16 v[60:61], v6 offset:53248
    ds_read_b64_tr_b16 v[62:63], v6 offset:53760
    v_dot2c_f32_bf16 v40, s71, v88
    v_dot2c_f32_bf16 v40, s71, v89
    v_dot2c_f32_bf16 v40, s71, v90
    v_dot2c_f32_bf16 v40, s71, v91
    v_mfma_f32_16x16x32_bf16 v[112:115], v[128:131], v[16:19], 0
    v_mfma_f32_16x16x32_bf16 v[116:119], v[132:135], v[16:19], 0
    ds_read_b64_tr_b16 v[88:89], v7 offset:49152
    ds_read_b64_tr_b16 v[90:91], v7 offset:49664
    v_mfma_f32_16x16x32_bf16 v[120:123], v[128:131], v[20:23], 0
    v_mfma_f32_16x16x32_bf16 v[124:127], v[132:135], v[20:23], 0
    v_mfma_f32_16x16x32_bf16 v[112:115], v[136:139], v[24:27], v[112:115]
    v_mfma_f32_16x16x32_bf16 v[116:119], v[140:143], v[24:27], v[116:119]
    v_mfma_f32_16x16x32_bf16 v[120:123], v[136:139], v[28:31], v[120:123]
    v_mfma_f32_16x16x32_bf16 v[124:127], v[140:143], v[28:31], v[124:127]
    v_add_u32 v12, 0x10000, v12
    v_add_u32 v13, 0x10000, v13
    v_add_u32 v46, 0x10000, v46
    v_add_u32 v6, 0x10000, v6
    v_add_u32 v7, 0x10000, v7
    s_waitcnt lgkmcnt(0)
    s_waitcnt vmcnt(8)
    s_barrier
    s_add_u32 m0, s56, 32768
    s_add_u32 s54, s54, 128
    buffer_load_dwordx4 v44, s[8:11], s54 offen lds
    s_add_u32 s55, s54, 14336
    buffer_load_dwordx4 v45, s[8:11], s54 offen offset:1024 lds
    buffer_load_dwordx4 v44, s[8:11], s55 offen offset:2048 lds
    buffer_load_dwordx4 v45, s[8:11], s55 offen offset:3072 lds
    ds_read_b128 v[160:163], v12 offset:0
    ds_read_b128 v[164:167], v12 offset:2048
    ds_read_b128 v[168:171], v13 offset:0
    ds_read_b128 v[172:175], v13 offset:2048
    ds_read_b64_tr_b16 v[16:17], v46 offset:16384
    ds_read_b64_tr_b16 v[18:19], v46 offset:16896
    ds_read_b64_tr_b16 v[20:21], v6 offset:16384
    ds_read_b64_tr_b16 v[22:23], v6 offset:16896
    ds_read_b64_tr_b16 v[24:25], v46 offset:20480
    ds_read_b64_tr_b16 v[26:27], v46 offset:20992
    ds_read_b64_tr_b16 v[28:29], v6 offset:20480
    ds_read_b64_tr_b16 v[30:31], v6 offset:20992
    v_dot2c_f32_bf16 v40, s71, v88
    v_dot2c_f32_bf16 v40, s71, v89
    v_dot2c_f32_bf16 v40, s71, v90
    v_dot2c_f32_bf16 v40, s71, v91
    v_mfma_f32_16x16x32_bf16 v[112:115], v[144:147], v[48:51], v[112:115]
    v_mfma_f32_16x16x32_bf16 v[116:119], v[148:151], v[48:51], v[116:119]
    ds_read_b64_tr_b16 v[88:89], v7 offset:16384
    ds_read_b64_tr_b16 v[90:91], v7 offset:16896
    v_mfma_f32_16x16x32_bf16 v[120:123], v[144:147], v[52:55], v[120:123]
    v_mfma_f32_16x16x32_bf16 v[124:127], v[148:151], v[52:55], v[124:127]
    v_mfma_f32_16x16x32_bf16 v[112:115], v[152:155], v[56:59], v[112:115]
    v_mfma_f32_16x16x32_bf16 v[116:119], v[156:159], v[56:59], v[116:119]
    v_mfma_f32_16x16x32_bf16 v[120:123], v[152:155], v[60:63], v[120:123]
    v_mfma_f32_16x16x32_bf16 v[124:127], v[156:159], v[60:63], v[124:127]
    s_waitcnt lgkmcnt(0)
    s_waitcnt vmcnt(8)
    s_barrier
    s_add_u32 m0, s56, 65536
    s_add_u32 s54, s54, 128
    s_cmp_eq_u32 s33, 2
    s_cselect_b32 s52, 1024, 0
    s_sub_u32 s54, s54, s52
    buffer_load_dwordx4 v44, s[8:11], s54 offen lds
    s_add_u32 s55, s54, 14336
    buffer_load_dwordx4 v45, s[8:11], s54 offen offset:1024 lds
    buffer_load_dwordx4 v44, s[8:11], s55 offen offset:2048 lds
    buffer_load_dwordx4 v45, s[8:11], s55 offen offset:3072 lds
    ds_read_b128 v[176:179], v12 offset:32768
    ds_read_b128 v[180:183], v12 offset:34816
    ds_read_b128 v[184:187], v13 offset:32768
    ds_read_b128 v[188:191], v13 offset:34816
    ds_read_b64_tr_b16 v[48:49], v46 offset:49152
    ds_read_b64_tr_b16 v[50:51], v46 offset:49664
    ds_read_b64_tr_b16 v[52:53], v6 offset:49152
    ds_read_b64_tr_b16 v[54:55], v6 offset:49664
    ds_read_b64_tr_b16 v[56:57], v46 offset:53248
    ds_read_b64_tr_b16 v[58:59], v46 offset:53760
    ds_read_b64_tr_b16 v[60:61], v6 offset:53248
    ds_read_b64_tr_b16 v[62:63], v6 offset:53760
    v_dot2c_f32_bf16 v40, s71, v88
    v_dot2c_f32_bf16 v40, s71, v89
    v_dot2c_f32_bf16 v40, s71, v90
    v_dot2c_f32_bf16 v40, s71, v91
    v_mfma_f32_16x16x32_bf16 v[112:115], v[160:163], v[16:19], v[112:115]
    v_mfma_f32_16x16x32_bf16 v[116:119], v[164:167], v[16:19], v[116:119]
    ds_read_b64_tr_b16 v[88:89], v7 offset:49152
    ds_read_b64_tr_b16 v[90:91], v7 offset:49664
    v_mfma_f32_16x16x32_bf16 v[120:123], v[160:163], v[20:23], v[120:123]
    v_mfma_f32_16x16x32_bf16 v[124:127], v[164:167], v[20:23], v[124:127]
    v_mfma_f32_16x16x32_bf16 v[112:115], v[168:171], v[24:27], v[112:115]
    v_mfma_f32_16x16x32_bf16 v[116:119], v[172:175], v[24:27], v[116:119]
    v_mfma_f32_16x16x32_bf16 v[120:123], v[168:171], v[28:31], v[120:123]
    v_mfma_f32_16x16x32_bf16 v[124:127], v[172:175], v[28:31], v[124:127]
    v_add_u32 v12, 0xffff0000, v12
    v_add_u32 v13, 0xffff0000, v13
    v_add_u32 v46, 0xffff0000, v46
    v_add_u32 v6, 0xffff0000, v6
    v_add_u32 v7, 0xffff0000, v7
    s_waitcnt lgkmcnt(0)
    s_waitcnt vmcnt(8)
    s_barrier
    s_add_u32 m0, s56, 98304
    s_add_u32 s54, s54, 128
    buffer_load_dwordx4 v44, s[8:11], s54 offen lds
    s_add_u32 s55, s54, 14336
    buffer_load_dwordx4 v45, s[8:11], s54 offen offset:1024 lds
    buffer_load_dwordx4 v44, s[8:11], s55 offen offset:2048 lds
    buffer_load_dwordx4 v45, s[8:11], s55 offen offset:3072 lds
    ds_read_b128 v[192:195], v12 offset:0
    ds_read_b128 v[196:199], v12 offset:2048
    ds_read_b128 v[200:203], v13 offset:0
    ds_read_b128 v[204:207], v13 offset:2048
    ds_read_b64_tr_b16 v[16:17], v46 offset:16384
    ds_read_b64_tr_b16 v[18:19], v46 offset:16896
    ds_read_b64_tr_b16 v[20:21], v6 offset:16384
    ds_read_b64_tr_b16 v[22:23], v6 offset:16896
    ds_read_b64_tr_b16 v[24:25], v46 offset:20480
    ds_read_b64_tr_b16 v[26:27], v46 offset:20992
    ds_read_b64_tr_b16 v[28:29], v6 offset:20480
    ds_read_b64_tr_b16 v[30:31], v6 offset:20992
    v_dot2c_f32_bf16 v40, s71, v88
    v_dot2c_f32_bf16 v40, s71, v89
    v_dot2c_f32_bf16 v40, s71, v90
    v_dot2c_f32_bf16 v40, s71, v91
    v_mfma_f32_16x16x32_bf16 v[112:115], v[176:179], v[48:51], v[112:115]
    v_mfma_f32_16x16x32_bf16 v[116:119], v[180:183], v[48:51], v[116:119]
    ds_read_b64_tr_b16 v[88:89], v7 offset:16384
    ds_read_b64_tr_b16 v[90:91], v7 offset:16896
    v_mfma_f32_16x16x32_bf16 v[120:123], v[176:179], v[52:55], v[120:123]
    v_mfma_f32_16x16x32_bf16 v[124:127], v[180:183], v[52:55], v[124:127]
    v_mfma_f32_16x16x32_bf16 v[112:115], v[184:187], v[56:59], v[112:115]
    v_mfma_f32_16x16x32_bf16 v[116:119], v[188:191], v[56:59], v[116:119]
    v_mfma_f32_16x16x32_bf16 v[120:123], v[184:187], v[60:63], v[120:123]
    v_mfma_f32_16x16x32_bf16 v[124:127], v[188:191], v[60:63], v[124:127]
    s_waitcnt lgkmcnt(0)
    s_waitcnt vmcnt(8)
    s_barrier
    s_load_dwordx2 s[48:49], s[44:45], 0
    s_add_u32 m0, s59, 0
    s_nop 0
    buffer_load_dwordx4 v8, s[20:23], s58 offen offset:0 lds
    s_add_u32 m0, s59, 8192
    s_nop 0
    buffer_load_dwordx4 v8, s[24:27], s58 offen offset:0 lds
    s_add_u32 m0, s59, 16256
    s_nop 0
    buffer_load_dwordx4 v8, s[20:23], s58 offen offset:128 lds
    s_add_u32 m0, s59, 24448
    s_nop 0
    buffer_load_dwordx4 v8, s[24:27], s58 offen offset:128 lds
    ds_read_b128 v[208:211], v12 offset:32768
    ds_read_b128 v[212:215], v12 offset:34816
    ds_read_b128 v[216:219], v13 offset:32768
    ds_read_b128 v[220:223], v13 offset:34816
    ds_read_b64_tr_b16 v[48:49], v46 offset:49152
    ds_read_b64_tr_b16 v[50:51], v46 offset:49664
    ds_read_b64_tr_b16 v[52:53], v6 offset:49152
    ds_read_b64_tr_b16 v[54:55], v6 offset:49664
    ds_read_b64_tr_b16 v[56:57], v46 offset:53248
    ds_read_b64_tr_b16 v[58:59], v46 offset:53760
    ds_read_b64_tr_b16 v[60:61], v6 offset:53248
    ds_read_b64_tr_b16 v[62:63], v6 offset:53760
    v_dot2c_f32_bf16 v40, s71, v88
    v_dot2c_f32_bf16 v40, s71, v89
    v_dot2c_f32_bf16 v40, s71, v90
    v_dot2c_f32_bf16 v40, s71, v91
    v_mfma_f32_16x16x32_bf16 v[112:115], v[192:195], v[16:19], v[112:115]
    v_mfma_f32_16x16x32_bf16 v[116:119], v[196:199], v[16:19], v[116:119]
    ds_read_b64_tr_b16 v[88:89], v7 offset:49152
    ds_read_b64_tr_b16 v[90:91], v7 offset:49664
    v_mfma_f32_16x16x32_bf16 v[120:123], v[192:195], v[20:23], v[120:123]
    v_mfma_f32_16x16x32_bf16 v[124:127], v[196:199], v[20:23], v[124:127]
    v_mfma_f32_16x16x32_bf16 v[112:115], v[200:203], v[24:27], v[112:115]
    v_mfma_f32_16x16x32_bf16 v[116:119], v[204:207], v[24:27], v[116:119]
    v_mfma_f32_16x16x32_bf16 v[120:123], v[200:203], v[28:31], v[120:123]
    v_mfma_f32_16x16x32_bf16 v[124:127], v[204:207], v[28:31], v[124:127]
    v_add_u32 v12, 0x10000, v12
    v_add_u32 v13, 0x10000, v13
    v_add_u32 v46, 0x10000, v46
    v_add_u32 v6, 0x10000, v6
    v_add_u32 v7, 0x10000, v7
    s_waitcnt lgkmcnt(0)
    s_waitcnt vmcnt(8)
    s_barrier
    s_add_u32 m0, s59, 32768
    s_add_u32 s58, s58, 229376
    buffer_load_dwordx4 v8, s[20:23], s58 offen offset:0 lds
    s_add_u32 m0, s59, 40960
    s_nop 0
    buffer_load_dwordx4 v8, s[24:27], s58 offen offset:0 lds
    s_add_u32 m0, s59, 49024
    s_nop 0
    buffer_load_dwordx4 v8, s[20:23], s58 offen offset:128 lds
    s_add_u32 m0, s59, 57216
    s_nop 0
    buffer_load_dwordx4 v8, s[24:27], s58 offen offset:128 lds
    ds_read_b128 v[224:227], v12 offset:0
    ds_read_b128 v[228:231], v12 offset:2048
    ds_read_b128 v[232:235], v13 offset:0
    ds_read_b128 v[236:239], v13 offset:2048
    ds_read_b64_tr_b16 v[16:17], v46 offset:16384
    ds_read_b64_tr_b16 v[18:19], v46 offset:16896
    ds_read_b64_tr_b16 v[20:21], v6 offset:16384
    ds_read_b64_tr_b16 v[22:23], v6 offset:16896
    ds_read_b64_tr_b16 v[24:25], v46 offset:20480
    ds_read_b64_tr_b16 v[26:27], v46 offset:20992
    ds_read_b64_tr_b16 v[28:29], v6 offset:20480
    ds_read_b64_tr_b16 v[30:31], v6 offset:20992
    v_dot2c_f32_bf16 v40, s71, v88
    v_dot2c_f32_bf16 v40, s71, v89
    v_dot2c_f32_bf16 v40, s71, v90
    v_dot2c_f32_bf16 v40, s71, v91
    v_mfma_f32_16x16x32_bf16 v[112:115], v[208:211], v[48:51], v[112:115]
    v_mfma_f32_16x16x32_bf16 v[116:119], v[212:215], v[48:51], v[116:119]
    ds_read_b64_tr_b16 v[88:89], v7 offset:16384
    ds_read_b64_tr_b16 v[90:91], v7 offset:16896
    v_mfma_f32_16x16x32_bf16 v[120:123], v[208:211], v[52:55], v[120:123]
    v_mfma_f32_16x16x32_bf16 v[124:127], v[212:215], v[52:55], v[124:127]
    v_mfma_f32_16x16x32_bf16 v[112:115], v[216:219], v[56:59], v[112:115]
    v_mfma_f32_16x16x32_bf16 v[116:119], v[220:223], v[56:59], v[116:119]
    v_mfma_f32_16x16x32_bf16 v[120:123], v[216:219], v[60:63], v[120:123]
    v_mfma_f32_16x16x32_bf16 v[124:127], v[220:223], v[60:63], v[124:127]
    s_waitcnt lgkmcnt(0)
    s_waitcnt vmcnt(8)
    s_barrier
    ds_read_b128 v[240:243], v12 offset:32768
    ds_read_b128 v[244:247], v12 offset:34816
    ds_read_b128 v[248:251], v13 offset:32768
    ds_read_b128 v[252:255], v13 offset:34816
    ds_read_b64_tr_b16 v[48:49], v46 offset:49152
    ds_read_b64_tr_b16 v[50:51], v46 offset:49664
    ds_read_b64_tr_b16 v[52:53], v6 offset:49152
    ds_read_b64_tr_b16 v[54:55], v6 offset:49664
    ds_read_b64_tr_b16 v[56:57], v46 offset:53248
    ds_read_b64_tr_b16 v[58:59], v46 offset:53760
    ds_read_b64_tr_b16 v[60:61], v6 offset:53248
    ds_read_b64_tr_b16 v[62:63], v6 offset:53760
    v_dot2c_f32_bf16 v40, s71, v88
    v_dot2c_f32_bf16 v40, s71, v89
    v_dot2c_f32_bf16 v40, s71, v90
    v_dot2c_f32_bf16 v40, s71, v91
    v_mfma_f32_16x16x32_bf16 v[112:115], v[224:227], v[16:19], v[112:115]
    v_mfma_f32_16x16x32_bf16 v[116:119], v[228:231], v[16:19], v[116:119]
    ds_read_b64_tr_b16 v[88:89], v7 offset:49152
    ds_read_b64_tr_b16 v[90:91], v7 offset:49664
    v_mfma_f32_16x16x32_bf16 v[120:123], v[224:227], v[20:23], v[120:123]
    v_mfma_f32_16x16x32_bf16 v[124:127], v[228:231], v[20:23], v[124:127]
    v_mfma_f32_16x16x32_bf16 v[112:115], v[232:235], v[24:27], v[112:115]
    v_mfma_f32_16x16x32_bf16 v[116:119], v[236:239], v[24:27], v[116:119]
    v_mfma_f32_16x16x32_bf16 v[120:123], v[232:235], v[28:31], v[120:123]
    v_mfma_f32_16x16x32_bf16 v[124:127], v[236:239], v[28:31], v[124:127]
    s_cmp_lg_u32 s48, 0
    s_cbranch_scc1 L_tokAP_x
    s_mov_b32 s50, 131072
L_tokAP:
    buffer_load_dwordx2 v[44:45], off, s[44:47], 0 sc1
    s_waitcnt vmcnt(0)
    v_readfirstlane_b32 s48, v44
    v_readfirstlane_b32 s49, v45
    s_sub_u32 s50, s50, 1
    s_cbranch_scc1 L_tokAP_x
    s_cmp_eq_u32 s48, 0
    s_cbranch_scc1 L_tokAP
L_tokAP_x:
    s_waitcnt lgkmcnt(0)
    v_dot2c_f32_bf16 v40, s71, v88
    v_dot2c_f32_bf16 v40, s71, v89
    v_dot2c_f32_bf16 v40, s71, v90
    v_dot2c_f32_bf16 v40, s71, v91
    s_lshl_b32 s52, s32, 2
    s_add_u32 s52, s52, 151552
    v_add_u32 v4, s52, v1
    v_cvt_pk_bf16_f32 v3, v40, v40
    v_lshlrev_b32 v3, 16, v3
    v_sub_f32 v5, v40, v3
    v_cvt_pk_bf16_f32 v3, v3, v5
    ds_write_b32 v4, v3 offset:0
    s_waitcnt lgkmcnt(0)
    s_waitcnt vmcnt(4)
    s_barrier
    s_setprio 0
    v_mfma_f32_16x16x32_bf16 v[112:115], v[240:243], v[48:51], v[112:115]
    v_mfma_f32_16x16x32_bf16 v[116:119], v[244:247], v[48:51], v[116:119]
    s_lshl_b32 s52, s32, 9
    s_add_u32 s52, s52, 159744
    v_bfe_u32 v3, v1, 4, 4
    v_lshl_add_u32 v3, v3, 3, s52
    ds_read_b64 v[12:13], v3
    ds_read_b64 v[14:15], v3 offset:128
    v_add_u32 v4, 151552, v1
    ds_read_b128 v[32:35], v4 offset:0
    s_lshl_b32 s52, s32, 8
    s_add_u32 s52, s52, 161792
    v_lshrrev_b32 v3, 8, v1
    v_lshl_add_u32 v3, v3, 4, s52
    ds_read_b128 v[96:99], v3 offset:0
    ds_read_b128 v[100:103], v3 offset:64
    v_mfma_f32_16x16x32_bf16 v[120:123], v[240:243], v[52:55], v[120:123]
    v_mfma_f32_16x16x32_bf16 v[124:127], v[244:247], v[52:55], v[124:127]
    ds_read_b64_tr_b16 v[16:17], v9 offset:0
    ds_read_b64_tr_b16 v[18:19], v9 offset:512
    ds_read_b64_tr_b16 v[20:21], v10 offset:0
    ds_read_b64_tr_b16 v[22:23], v10 offset:512
    ds_read_b64_tr_b16 v[24:25], v11 offset:0
    ds_read_b64_tr_b16 v[26:27], v11 offset:512
    ds_read_b64_tr_b16 v[28:29], v47 offset:0
    ds_read_b64_tr_b16 v[30:31], v47 offset:512
    v_mfma_f32_16x16x32_bf16 v[112:115], v[248:251], v[56:59], v[112:115]
    v_mfma_f32_16x16x32_bf16 v[116:119], v[252:255], v[56:59], v[116:119]
    s_waitcnt lgkmcnt(11)
    v_mov_b32 v88, 0
    v_mov_b32 v89, 0
    v_mov_b32 v90, v12
    v_mov_b32 v91, v12
    v_mov_b32 v92, 0
    v_mov_b32 v93, 0
    v_mov_b32 v64, 0
    v_mov_b32 v65, 0
    v_mov_b32 v66, v14
    v_mov_b32 v67, v14
    v_mov_b32 v68, 0
    v_mov_b32 v69, 0
    v_mov_b32 v6, s48
    v_mov_b32 v7, s49
    v_mfma_f32_16x16x32_bf16 v[120:123], v[248:251], v[60:63], v[120:123]
    v_mfma_f32_16x16x32_bf16 v[124:127], v[252:255], v[60:63], v[124:127]
    s_waitcnt lgkmcnt(10)
    v_mfma_f32_16x16x32_bf16 v[112:115], v[90:93], v[32:35], v[112:115]
    v_mfma_f32_16x16x32_bf16 v[116:119], v[66:69], v[32:35], v[116:119]
    v_mfma_f32_16x16x32_bf16 v[120:123], v[88:91], v[32:35], v[120:123]
    v_mfma_f32_16x16x32_bf16 v[124:127], v[64:67], v[32:35], v[124:127]
    s_add_u32 m0, s59, 65536
    s_add_u32 s58, s58, 229376
    s_cmp_eq_u32 s33, 6
    s_cselect_b32 s52, 1835008, 0
    s_sub_u32 s58, s58, s52
    buffer_load_dwordx4 v8, s[20:23], s58 offen offset:0 lds
    s_add_u32 m0, s59, 73728
    s_nop 0
    buffer_load_dwordx4 v8, s[24:27], s58 offen offset:0 lds
    s_add_u32 m0, s59, 81792
    s_nop 0
    buffer_load_dwordx4 v8, s[20:23], s58 offen offset:128 lds
    s_add_u32 m0, s59, 89984
    s_nop 0
    buffer_load_dwordx4 v8, s[24:27], s58 offen offset:128 lds
    v_lshrrev_b32 v46, 1, v1
    v_xor_b32 v46, v46, v1
    v_and_b32 v46, 0x100, v46
    v_mul_u32_u24 v46, 3, v46
    v_xor_b32 v46, v46, v1
    s_waitcnt lgkmcnt(8)
    v_mul_f32 v112, v96, v112
    v_mul_f32 v113, v97, v113
    v_mul_f32 v114, v98, v114
    v_mul_f32 v115, v99, v115
    v_mul_f32 v116, v100, v116
    v_mul_f32 v117, v101, v117
    v_mul_f32 v118, v102, v118
    v_mul_f32 v119, v103, v119
    v_mul_f32 v120, v96, v120
    v_mul_f32 v121, v97, v121
    v_mul_f32 v122, v98, v122
    v_mul_f32 v123, v99, v123
    v_mul_f32 v124, v100, v124
    v_mul_f32 v125, v101, v125
    v_mul_f32 v126, v102, v126
    v_mul_f32 v127, v103, v127
    v_cvt_pk_bf16_f32 v112, v112, v113
    v_cvt_pk_bf16_f32 v113, v114, v115
    v_cvt_pk_bf16_f32 v114, v116, v117
    v_cvt_pk_bf16_f32 v115, v118, v119
    v_cvt_pk_bf16_f32 v116, v120, v121
    v_cvt_pk_bf16_f32 v117, v122, v123
    v_cvt_pk_bf16_f32 v118, v124, v125
    v_cvt_pk_bf16_f32 v119, v126, v127
    v_permlane32_swap_b32 v112, v114
    v_permlane32_swap_b32 v113, v115
    v_permlane32_swap_b32 v116, v118
    v_permlane32_swap_b32 v117, v119
    s_add_u32 s52, s74, 4194304
    s_add_u32 s53, s74, 4259840
    buffer_store_dwordx4 v[112:115], v1, s[16:19], s52 offen sc1
    buffer_store_dwordx4 v[116:119], v1, s[16:19], s53 offen sc1
    s_waitcnt lgkmcnt(6)
    v_mfma_f32_16x16x32_bf16 v[48:51], v[16:19], v[128:131], 0
    ds_read_b64_tr_b16 v[32:33], v9 offset:8192
    v_mfma_f32_16x16x32_bf16 v[52:55], v[16:19], v[132:135], 0
    ds_read_b64_tr_b16 v[34:35], v9 offset:8704
    s_waitcnt lgkmcnt(6)
    v_mfma_f32_16x16x32_bf16 v[64:67], v[20:23], v[128:131], 0
    ds_read_b64_tr_b16 v[36:37], v10 offset:8192
    v_mfma_f32_16x16x32_bf16 v[68:71], v[20:23], v[132:135], 0
    ds_read_b64_tr_b16 v[38:39], v10 offset:8704
    s_waitcnt lgkmcnt(6)
    v_mfma_f32_16x16x32_bf16 v[80:83], v[24:27], v[128:131], 0
    ds_read_b64_tr_b16 v[16:17], v11 offset:8192
    v_mfma_f32_16x16x32_bf16 v[84:87], v[24:27], v[132:135], 0
    ds_read_b64_tr_b16 v[18:19], v11 offset:8704
    s_waitcnt lgkmcnt(6)
    v_mfma_f32_16x16x32_bf16 v[96:99], v[28:31], v[128:131], 0
    ds_read_b64_tr_b16 v[20:21], v47 offset:8192
    v_mfma_f32_16x16x32_bf16 v[100:103], v[28:31], v[132:135], 0
    ds_read_b64_tr_b16 v[22:23], v47 offset:8704
    s_waitcnt lgkmcnt(6)
    v_mfma_f32_16x16x32_bf16 v[56:59], v[32:35], v[128:131], 0
    ds_read_b64_tr_b16 v[24:25], v9 offset:4096
    v_mfma_f32_16x16x32_bf16 v[60:63], v[32:35], v[132:135], 0
    ds_read_b64_tr_b16 v[26:27], v9 offset:4608
    s_waitcnt lgkmcnt(6)
    v_mfma_f32_16x16x32_bf16 v[72:75], v[36:39], v[128:131], 0
    ds_read_b64_tr_b16 v[28:29], v10 offset:4096
    v_mfma_f32_16x16x32_bf16 v[76:79], v[36:39], v[132:135], 0
    ds_read_b64_tr_b16 v[30:31], v10 offset:4608
    s_waitcnt lgkmcnt(6)
    v_mfma_f32_16x16x32_bf16 v[88:91], v[16:19], v[128:131], 0
    ds_read_b64_tr_b16 v[32:33], v11 offset:4096
    v_mfma_f32_16x16x32_bf16 v[92:95], v[16:19], v[132:135], 0
    ds_read_b64_tr_b16 v[34:35], v11 offset:4608
    s_waitcnt lgkmcnt(6)
    v_mfma_f32_16x16x32_bf16 v[104:107], v[20:23], v[128:131], 0
    ds_read_b64_tr_b16 v[36:37], v47 offset:4096
    v_mfma_f32_16x16x32_bf16 v[108:111], v[20:23], v[132:135], 0
    ds_read_b64_tr_b16 v[38:39], v47 offset:4608
    s_waitcnt lgkmcnt(6)
    v_mfma_f32_16x16x32_bf16 v[48:51], v[24:27], v[136:139], v[48:51]
    ds_read_b64_tr_b16 v[16:17], v9 offset:12288
    v_mfma_f32_16x16x32_bf16 v[52:55], v[24:27], v[140:143], v[52:55]
    ds_read_b64_tr_b16 v[18:19], v9 offset:12800
    s_waitcnt lgkmcnt(6)
    v_mfma_f32_16x16x32_bf16 v[64:67], v[28:31], v[136:139], v[64:67]
    ds_read_b64_tr_b16 v[20:21], v10 offset:12288
    v_mfma_f32_16x16x32_bf16 v[68:71], v[28:31], v[140:143], v[68:71]
    ds_read_b64_tr_b16 v[22:23], v10 offset:12800
    s_waitcnt lgkmcnt(6)
    v_mfma_f32_16x16x32_bf16 v[80:83], v[32:35], v[136:139], v[80:83]
    ds_read_b64_tr_b16 v[24:25], v11 offset:12288
    v_mfma_f32_16x16x32_bf16 v[84:87], v[32:35], v[140:143], v[84:87]
    ds_read_b64_tr_b16 v[26:27], v11 offset:12800
    s_waitcnt lgkmcnt(6)
    v_mfma_f32_16x16x32_bf16 v[96:99], v[36:39], v[136:139], v[96:99]
    ds_read_b64_tr_b16 v[28:29], v47 offset:12288
    v_mfma_f32_16x16x32_bf16 v[100:103], v[36:39], v[140:143], v[100:103]
    ds_read_b64_tr_b16 v[30:31], v47 offset:12800
    s_waitcnt vmcnt(6)
    s_barrier
    s_add_u32 m0, s59, 98304
    s_add_u32 s58, s58, 229376
    buffer_load_dwordx4 v8, s[20:23], s58 offen offset:0 lds
    s_add_u32 m0, s59, 106496
    s_nop 0
    buffer_load_dwordx4 v8, s[24:27], s58 offen offset:0 lds
    s_add_u32 m0, s59, 114560
    s_nop 0
    buffer_load_dwordx4 v8, s[20:23], s58 offen offset:128 lds
    s_add_u32 m0, s59, 122752
    s_nop 0
    buffer_load_dwordx4 v8, s[24:27], s58 offen offset:128 lds
    s_cmp_lg_u32 s32, 0
    s_cbranch_scc1 L_ncsAP
    v_mov_b32 v40, 0
    v_mov_b32 v44, 0
    v_mov_b32 v41, 0
    v_mov_b32 v45, 0
    v_mov_b32 v42, 0
    v_mov_b32 v4, 0
    v_mov_b32 v43, 0
    v_mov_b32 v5, 0
    v_add_u32 v3, s60, v9
    ds_read_b64_tr_b16 v[128:129], v3 offset:0
    ds_read_b64_tr_b16 v[130:131], v3 offset:512
    ds_read_b64_tr_b16 v[132:133], v3 offset:8192
    ds_read_b64_tr_b16 v[134:135], v3 offset:8704
    v_add_u32 v3, s60, v10
    ds_read_b64_tr_b16 v[120:121], v3 offset:0
    ds_read_b64_tr_b16 v[122:123], v3 offset:512
    ds_read_b64_tr_b16 v[124:125], v3 offset:8192
    ds_read_b64_tr_b16 v[126:127], v3 offset:8704
    s_waitcnt lgkmcnt(0)
    v_dot2c_f32_bf16 v40, s71, v128
    v_dot2c_f32_bf16 v40, s71, v129
    v_dot2c_f32_bf16 v40, s71, v130
    v_dot2c_f32_bf16 v40, s71, v131
    v_dot2c_f32_bf16 v44, s71, v132
    v_dot2c_f32_bf16 v44, s71, v133
    v_dot2c_f32_bf16 v44, s71, v134
    v_dot2c_f32_bf16 v44, s71, v135
    v_dot2c_f32_bf16 v41, s71, v120
    v_dot2c_f32_bf16 v41, s71, v121
    v_dot2c_f32_bf16 v41, s71, v122
    v_dot2c_f32_bf16 v41, s71, v123
    v_dot2c_f32_bf16 v45, s71, v124
    v_dot2c_f32_bf16 v45, s71, v125
    v_dot2c_f32_bf16 v45, s71, v126
    v_dot2c_f32_bf16 v45, s71, v127
    v_add_u32 v3, s60, v11
    ds_read_b64_tr_b16 v[128:129], v3 offset:0
    ds_read_b64_tr_b16 v[130:131], v3 offset:512
    ds_read_b64_tr_b16 v[132:133], v3 offset:8192
    ds_read_b64_tr_b16 v[134:135], v3 offset:8704
    v_add_u32 v3, s60, v47
    ds_read_b64_tr_b16 v[120:121], v3 offset:0
    ds_read_b64_tr_b16 v[122:123], v3 offset:512
    ds_read_b64_tr_b16 v[124:125], v3 offset:8192
    ds_read_b64_tr_b16 v[126:127], v3 offset:8704
    s_waitcnt lgkmcnt(0)
    v_dot2c_f32_bf16 v42, s71, v128
    v_dot2c_f32_bf16 v42, s71, v129
    v_dot2c_f32_bf16 v42, s71, v130
    v_dot2c_f32_bf16 v42, s71, v131
    v_dot2c_f32_bf16 v4, s71, v132
    v_dot2c_f32_bf16 v4, s71, v133
    v_dot2c_f32_bf16 v4, s71, v134
    v_dot2c_f32_bf16 v4, s71, v135
    v_dot2c_f32_bf16 v43, s71, v120
    v_dot2c_f32_bf16 v43, s71, v121
    v_dot2c_f32_bf16 v43, s71, v122
    v_dot2c_f32_bf16 v43, s71, v123
    v_dot2c_f32_bf16 v5, s71, v124
    v_dot2c_f32_bf16 v5, s71, v125
    v_dot2c_f32_bf16 v5, s71, v126
    v_dot2c_f32_bf16 v5, s71, v127
    s_nop 2
    v_permlane32_swap_b32 v40, v44
    v_permlane32_swap_b32 v41, v45
    v_permlane32_swap_b32 v42, v4
    v_permlane32_swap_b32 v43, v5
    s_nop 0
    v_add_f32 v40, v40, v44
    v_add_f32 v41, v41, v45
    v_add_f32 v42, v42, v4
    v_add_f32 v43, v43, v5
    v_mov_b32 v44, v40
    v_mov_b32 v45, v41
    v_mov_b32 v4, v42
    v_mov_b32 v5, v43
    s_nop 1
    v_permlane16_swap_b32 v40, v44
    v_permlane16_swap_b32 v41, v45
    v_permlane16_swap_b32 v42, v4
    v_permlane16_swap_b32 v43, v5
    s_nop 0
    v_add_f32 v40, v40, v44
    v_add_f32 v41, v41, v45
    v_add_f32 v42, v42, v4
    v_add_f32 v43, v43, v5
L_ncsAP:
    s_mov_b32 exec_lo, 0xffff
    s_mov_b32 exec_hi, 0xffff
    buffer_store_dwordx4 v[40:43], v46, s[16:19], s1 offen sc1
    s_mov_b64 exec, -1
    s_nop 0
    s_waitcnt lgkmcnt(6)
    v_mfma_f32_16x16x32_bf16 v[56:59], v[16:19], v[136:139], v[56:59]
    ds_read_b64_tr_b16 v[32:33], v9 offset:32768
    v_mfma_f32_16x16x32_bf16 v[60:63], v[16:19], v[140:143], v[60:63]
    ds_read_b64_tr_b16 v[34:35], v9 offset:33280
    s_waitcnt lgkmcnt(6)
    v_mfma_f32_16x16x32_bf16 v[72:75], v[20:23], v[136:139], v[72:75]
    ds_read_b64_tr_b16 v[36:37], v10 offset:32768
    v_mfma_f32_16x16x32_bf16 v[76:79], v[20:23], v[140:143], v[76:79]
    ds_read_b64_tr_b16 v[38:39], v10 offset:33280
    s_waitcnt lgkmcnt(6)
    v_mfma_f32_16x16x32_bf16 v[88:91], v[24:27], v[136:139], v[88:91]
    ds_read_b64_tr_b16 v[16:17], v11 offset:32768
    v_mfma_f32_16x16x32_bf16 v[92:95], v[24:27], v[140:143], v[92:95]
    ds_read_b64_tr_b16 v[18:19], v11 offset:33280
    s_waitcnt lgkmcnt(6)
    v_mfma_f32_16x16x32_bf16 v[104:107], v[28:31], v[136:139], v[104:107]
    ds_read_b64_tr_b16 v[20:21], v47 offset:32768
    v_mfma_f32_16x16x32_bf16 v[108:111], v[28:31], v[140:143], v[108:111]
    ds_read_b64_tr_b16 v[22:23], v47 offset:33280
    s_waitcnt lgkmcnt(6)
    v_mfma_f32_16x16x32_bf16 v[48:51], v[32:35], v[144:147], v[48:51]
    ds_read_b64_tr_b16 v[24:25], v9 offset:40960
    v_mfma_f32_16x16x32_bf16 v[52:55], v[32:35], v[148:151], v[52:55]
    ds_read_b64_tr_b16 v[26:27], v9 offset:41472
    s_waitcnt lgkmcnt(6)
    v_mfma_f32_16x16x32_bf16 v[64:67], v[36:39], v[144:147], v[64:67]
    ds_read_b64_tr_b16 v[28:29], v10 offset:40960
    v_mfma_f32_16x16x32_bf16 v[68:71], v[36:39], v[148:151], v[68:71]
    ds_read_b64_tr_b16 v[30:31], v10 offset:41472
    s_waitcnt lgkmcnt(6)
    v_mfma_f32_16x16x32_bf16 v[80:83], v[16:19], v[144:147], v[80:83]
    ds_read_b64_tr_b16 v[32:33], v11 offset:40960
    v_mfma_f32_16x16x32_bf16 v[84:87], v[16:19], v[148:151], v[84:87]
    ds_read_b64_tr_b16 v[34:35], v11 offset:41472
    s_waitcnt lgkmcnt(6)
    v_mfma_f32_16x16x32_bf16 v[96:99], v[20:23], v[144:147], v[96:99]
    ds_read_b64_tr_b16 v[36:37], v47 offset:40960
    v_mfma_f32_16x16x32_bf16 v[100:103], v[20:23], v[148:151], v[100:103]
    ds_read_b64_tr_b16 v[38:39], v47 offset:41472
    s_waitcnt lgkmcnt(6)
    v_mfma_f32_16x16x32_bf16 v[56:59], v[24:27], v[144:147], v[56:59]
    ds_read_b64_tr_b16 v[16:17], v9 offset:36864
    v_mfma_f32_16x16x32_bf16 v[60:63], v[24:27], v[148:151], v[60:63]
    ds_read_b64_tr_b16 v[18:19], v9 offset:37376
    s_waitcnt lgkmcnt(6)
    v_mfma_f32_16x16x32_bf16 v[72:75], v[28:31], v[144:147], v[72:75]
    ds_read_b64_tr_b16 v[20:21], v10 offset:36864
    v_mfma_f32_16x16x32_bf16 v[76:79], v[28:31], v[148:151], v[76:79]
    ds_read_b64_tr_b16 v[22:23], v10 offset:37376
    s_waitcnt lgkmcnt(6)
    v_mfma_f32_16x16x32_bf16 v[88:91], v[32:35], v[144:147], v[88:91]
    ds_read_b64_tr_b16 v[24:25], v11 offset:36864
    v_mfma_f32_16x16x32_bf16 v[92:95], v[32:35], v[148:151], v[92:95]
    ds_read_b64_tr_b16 v[26:27], v11 offset:37376
    s_waitcnt lgkmcnt(6)
    v_mfma_f32_16x16x32_bf16 v[104:107], v[36:39], v[144:147], v[104:107]
    ds_read_b64_tr_b16 v[28:29], v47 offset:36864
    v_mfma_f32_16x16x32_bf16 v[108:111], v[36:39], v[148:151], v[108:111]
    ds_read_b64_tr_b16 v[30:31], v47 offset:37376
    s_waitcnt lgkmcnt(6)
    v_mfma_f32_16x16x32_bf16 v[48:51], v[16:19], v[152:155], v[48:51]
    ds_read_b64_tr_b16 v[32:33], v9 offset:45056
    v_mfma_f32_16x16x32_bf16 v[52:55], v[16:19], v[156:159], v[52:55]
    ds_read_b64_tr_b16 v[34:35], v9 offset:45568
    s_waitcnt lgkmcnt(6)
    v_mfma_f32_16x16x32_bf16 v[64:67], v[20:23], v[152:155], v[64:67]
    ds_read_b64_tr_b16 v[36:37], v10 offset:45056
    v_mfma_f32_16x16x32_bf16 v[68:71], v[20:23], v[156:159], v[68:71]
    ds_read_b64_tr_b16 v[38:39], v10 offset:45568
    s_waitcnt lgkmcnt(6)
    v_mfma_f32_16x16x32_bf16 v[80:83], v[24:27], v[152:155], v[80:83]
    ds_read_b64_tr_b16 v[16:17], v11 offset:45056
    v_mfma_f32_16x16x32_bf16 v[84:87], v[24:27], v[156:159], v[84:87]
    ds_read_b64_tr_b16 v[18:19], v11 offset:45568
    s_waitcnt lgkmcnt(6)
    v_mfma_f32_16x16x32_bf16 v[96:99], v[28:31], v[152:155], v[96:99]
    ds_read_b64_tr_b16 v[20:21], v47 offset:45056
    v_mfma_f32_16x16x32_bf16 v[100:103], v[28:31], v[156:159], v[100:103]
    ds_read_b64_tr_b16 v[22:23], v47 offset:45568
    v_add_u32 v9, 0x10000, v9
    v_add_u32 v10, 0x10000, v10
    v_add_u32 v11, 0x10000, v11
    v_add_u32 v47, 0x10000, v47
    s_waitcnt vmcnt(7)
    s_waitcnt vmcnt(5)
    s_barrier
    s_cmp_lg_u32 s3, 0
    s_cbranch_scc1 L_w0_10AP
    s_mov_b64 exec, 1
    buffer_store_dwordx2 v[6:7], off, s[16:19], s57 sc1
    s_mov_b64 exec, -1
L_w0_10AP:
    s_add_u32 m0, s59, 0
    s_add_u32 s58, s58, 229376
    s_cmp_eq_u32 s33, 4
    s_cselect_b32 s52, 1835008, 0
    s_sub_u32 s58, s58, s52
    buffer_load_dwordx4 v8, s[20:23], s58 offen offset:0 lds
    s_add_u32 m0, s59, 8192
    s_nop 0
    buffer_load_dwordx4 v8, s[24:27], s58 offen offset:0 lds
    s_add_u32 m0, s59, 16256
    s_nop 0
    buffer_load_dwordx4 v8, s[20:23], s58 offen offset:128 lds
    s_add_u32 m0, s59, 24448
    s_nop 0
    buffer_load_dwordx4 v8, s[24:27], s58 offen offset:128 lds
    s_and_b32 s52, s4, 6
    s_add_u32 s52, s52, s4
    s_sub_u32 s53, s7, s52
    s_add_u32 s53, s53, 16
    s_lshl_b32 s53, s53, 11
    s_lshl_b32 s52, s52, 11
    s_add_u32 s52, s52, 17825792
    s_mov_b32 s64, -1
    s_mov_b32 s65, 0xffff
    v_and_b32 v142, 0xf0, v1
    v_lshl_add_u32 v142, v142, 3, s52
    v_bfe_u32 v3, v1, 8, 1
    v_lshl_add_u32 v142, v3, 12, v142
    v_lshrrev_b32 v3, 9, v1
    v_mad_u32_u24 v142, v3, s53, v142
    s_waitcnt lgkmcnt(6)
    v_mfma_f32_16x16x32_bf16 v[56:59], v[32:35], v[152:155], v[56:59]
    ds_read_b64_tr_b16 v[24:25], v9 offset:0
    v_mfma_f32_16x16x32_bf16 v[60:63], v[32:35], v[156:159], v[60:63]
    ds_read_b64_tr_b16 v[26:27], v9 offset:512
    s_waitcnt lgkmcnt(6)
    v_mfma_f32_16x16x32_bf16 v[72:75], v[36:39], v[152:155], v[72:75]
    ds_read_b64_tr_b16 v[28:29], v10 offset:0
    v_mfma_f32_16x16x32_bf16 v[76:79], v[36:39], v[156:159], v[76:79]
    ds_read_b64_tr_b16 v[30:31], v10 offset:512
    s_waitcnt lgkmcnt(6)
    v_mfma_f32_16x16x32_bf16 v[88:91], v[16:19], v[152:155], v[88:91]
    ds_read_b64_tr_b16 v[32:33], v11 offset:0
    v_mfma_f32_16x16x32_bf16 v[92:95], v[16:19], v[156:159], v[92:95]
    ds_read_b64_tr_b16 v[34:35], v11 offset:512
    s_waitcnt lgkmcnt(6)
    v_mfma_f32_16x16x32_bf16 v[104:107], v[20:23], v[152:155], v[104:107]
    ds_read_b64_tr_b16 v[36:37], v47 offset:0
    v_mfma_f32_16x16x32_bf16 v[108:111], v[20:23], v[156:159], v[108:111]
    ds_read_b64_tr_b16 v[38:39], v47 offset:512
    s_waitcnt lgkmcnt(6)
    v_mfma_f32_16x16x32_bf16 v[48:51], v[24:27], v[160:163], v[48:51]
    ds_read_b64_tr_b16 v[16:17], v9 offset:8192
    v_mfma_f32_16x16x32_bf16 v[52:55], v[24:27], v[164:167], v[52:55]
    ds_read_b64_tr_b16 v[18:19], v9 offset:8704
    s_waitcnt lgkmcnt(6)
    v_mfma_f32_16x16x32_bf16 v[64:67], v[28:31], v[160:163], v[64:67]
    ds_read_b64_tr_b16 v[20:21], v10 offset:8192
    v_mfma_f32_16x16x32_bf16 v[68:71], v[28:31], v[164:167], v[68:71]
    ds_read_b64_tr_b16 v[22:23], v10 offset:8704
    s_waitcnt lgkmcnt(6)
    v_mfma_f32_16x16x32_bf16 v[80:83], v[32:35], v[160:163], v[80:83]
    ds_read_b64_tr_b16 v[24:25], v11 offset:8192
    v_mfma_f32_16x16x32_bf16 v[84:87], v[32:35], v[164:167], v[84:87]
    ds_read_b64_tr_b16 v[26:27], v11 offset:8704
    s_waitcnt lgkmcnt(6)
    v_mfma_f32_16x16x32_bf16 v[96:99], v[36:39], v[160:163], v[96:99]
    ds_read_b64_tr_b16 v[28:29], v47 offset:8192
    v_mfma_f32_16x16x32_bf16 v[100:103], v[36:39], v[164:167], v[100:103]
    ds_read_b64_tr_b16 v[30:31], v47 offset:8704
    s_waitcnt lgkmcnt(6)
    v_mfma_f32_16x16x32_bf16 v[56:59], v[16:19], v[160:163], v[56:59]
    ds_read_b64_tr_b16 v[32:33], v9 offset:4096
    v_mfma_f32_16x16x32_bf16 v[60:63], v[16:19], v[164:167], v[60:63]
    ds_read_b64_tr_b16 v[34:35], v9 offset:4608
    s_waitcnt lgkmcnt(6)
    v_mfma_f32_16x16x32_bf16 v[72:75], v[20:23], v[160:163], v[72:75]
    ds_read_b64_tr_b16 v[36:37], v10 offset:4096
    v_mfma_f32_16x16x32_bf16 v[76:79], v[20:23], v[164:167], v[76:79]
    ds_read_b64_tr_b16 v[38:39], v10 offset:4608
    s_waitcnt lgkmcnt(6)
    v_mfma_f32_16x16x32_bf16 v[88:91], v[24:27], v[160:163], v[88:91]
    ds_read_b64_tr_b16 v[16:17], v11 offset:4096
    v_mfma_f32_16x16x32_bf16 v[92:95], v[24:27], v[164:167], v[92:95]
    ds_read_b64_tr_b16 v[18:19], v11 offset:4608
    s_waitcnt lgkmcnt(6)
    v_mfma_f32_16x16x32_bf16 v[104:107], v[28:31], v[160:163], v[104:107]
    ds_read_b64_tr_b16 v[20:21], v47 offset:4096
    v_mfma_f32_16x16x32_bf16 v[108:111], v[28:31], v[164:167], v[108:111]
    ds_read_b64_tr_b16 v[22:23], v47 offset:4608
    s_waitcnt lgkmcnt(6)
    v_mfma_f32_16x16x32_bf16 v[48:51], v[32:35], v[168:171], v[48:51]
    ds_read_b64_tr_b16 v[24:25], v9 offset:12288
    v_mfma_f32_16x16x32_bf16 v[52:55], v[32:35], v[172:175], v[52:55]
    ds_read_b64_tr_b16 v[26:27], v9 offset:12800
    s_waitcnt lgkmcnt(6)
    v_mfma_f32_16x16x32_bf16 v[64:67], v[36:39], v[168:171], v[64:67]
    ds_read_b64_tr_b16 v[28:29], v10 offset:12288
    v_mfma_f32_16x16x32_bf16 v[68:71], v[36:39], v[172:175], v[68:71]
    ds_read_b64_tr_b16 v[30:31], v10 offset:12800
    s_waitcnt lgkmcnt(6)
    v_mfma_f32_16x16x32_bf16 v[80:83], v[16:19], v[168:171], v[80:83]
    ds_read_b64_tr_b16 v[32:33], v11 offset:12288
    v_mfma_f32_16x16x32_bf16 v[84:87], v[16:19], v[172:175], v[84:87]
    ds_read_b64_tr_b16 v[34:35], v11 offset:12800
    s_waitcnt lgkmcnt(6)
    v_mfma_f32_16x16x32_bf16 v[96:99], v[20:23], v[168:171], v[96:99]
    ds_read_b64_tr_b16 v[36:37], v47 offset:12288
    v_mfma_f32_16x16x32_bf16 v[100:103], v[20:23], v[172:175], v[100:103]
    ds_read_b64_tr_b16 v[38:39], v47 offset:12800
    s_waitcnt vmcnt(5)
    s_waitcnt vmcnt(4)
    s_barrier
    s_cmp_lg_u32 s3, 0
    s_cbranch_scc1 L_w0_11AP
    s_add_u32 s52, s57, 32768
    s_mov_b64 exec, 1
    buffer_store_dwordx2 v[6:7], off, s[16:19], s52 sc1
    s_mov_b64 exec, -1
L_w0_11AP:
    s_add_u32 m0, s59, 32768
    s_add_u32 s58, s58, 229376
    buffer_load_dwordx4 v8, s[20:23], s58 offen offset:0 lds
    s_add_u32 m0, s59, 40960
    s_nop 0
    buffer_load_dwordx4 v8, s[24:27], s58 offen offset:0 lds
    s_add_u32 m0, s59, 49024
    s_nop 0
    buffer_load_dwordx4 v8, s[20:23], s58 offen offset:128 lds
    s_add_u32 m0, s59, 57216
    s_nop 0
    buffer_load_dwordx4 v8, s[24:27], s58 offen offset:128 lds
    s_waitcnt lgkmcnt(6)
    v_mfma_f32_16x16x32_bf16 v[56:59], v[24:27], v[168:171], v[56:59]
    ds_read_b64_tr_b16 v[16:17], v9 offset:32768
    v_mfma_f32_16x16x32_bf16 v[60:63], v[24:27], v[172:175], v[60:63]
    ds_read_b64_tr_b16 v[18:19], v9 offset:33280
    s_waitcnt lgkmcnt(6)
    v_mfma_f32_16x16x32_bf16 v[72:75], v[28:31], v[168:171], v[72:75]
    ds_read_b64_tr_b16 v[20:21], v10 offset:32768
    v_mfma_f32_16x16x32_bf16 v[76:79], v[28:31], v[172:175], v[76:79]
    ds_read_b64_tr_b16 v[22:23], v10 offset:33280
    s_waitcnt lgkmcnt(6)
    v_mfma_f32_16x16x32_bf16 v[88:91], v[32:35], v[168:171], v[88:91]
    ds_read_b64_tr_b16 v[24:25], v11 offset:32768
    v_mfma_f32_16x16x32_bf16 v[92:95], v[32:35], v[172:175], v[92:95]
    ds_read_b64_tr_b16 v[26:27], v11 offset:33280
    s_waitcnt lgkmcnt(6)
    v_mfma_f32_16x16x32_bf16 v[104:107], v[36:39], v[168:171], v[104:107]
    ds_read_b64_tr_b16 v[28:29], v47 offset:32768
    v_mfma_f32_16x16x32_bf16 v[108:111], v[36:39], v[172:175], v[108:111]
    ds_read_b64_tr_b16 v[30:31], v47 offset:33280
    s_waitcnt lgkmcnt(6)
    v_mfma_f32_16x16x32_bf16 v[48:51], v[16:19], v[176:179], v[48:51]
    ds_read_b64_tr_b16 v[32:33], v9 offset:40960
    v_mfma_f32_16x16x32_bf16 v[52:55], v[16:19], v[180:183], v[52:55]
    ds_read_b64_tr_b16 v[34:35], v9 offset:41472
    s_waitcnt lgkmcnt(6)
    v_mfma_f32_16x16x32_bf16 v[64:67], v[20:23], v[176:179], v[64:67]
    ds_read_b64_tr_b16 v[36:37], v10 offset:40960
    v_mfma_f32_16x16x32_bf16 v[68:71], v[20:23], v[180:183], v[68:71]
    ds_read_b64_tr_b16 v[38:39], v10 offset:41472
    s_waitcnt lgkmcnt(6)
    v_mfma_f32_16x16x32_bf16 v[80:83], v[24:27], v[176:179], v[80:83]
    ds_read_b64_tr_b16 v[16:17], v11 offset:40960
    v_mfma_f32_16x16x32_bf16 v[84:87], v[24:27], v[180:183], v[84:87]
    ds_read_b64_tr_b16 v[18:19], v11 offset:41472
    s_waitcnt lgkmcnt(6)
    v_mfma_f32_16x16x32_bf16 v[96:99], v[28:31], v[176:179], v[96:99]
    ds_read_b64_tr_b16 v[20:21], v47 offset:40960
    v_mfma_f32_16x16x32_bf16 v[100:103], v[28:31], v[180:183], v[100:103]
    ds_read_b64_tr_b16 v[22:23], v47 offset:41472
    s_waitcnt lgkmcnt(6)
    v_mfma_f32_16x16x32_bf16 v[56:59], v[32:35], v[176:179], v[56:59]
    ds_read_b64_tr_b16 v[24:25], v9 offset:36864
    v_mfma_f32_16x16x32_bf16 v[60:63], v[32:35], v[180:183], v[60:63]
    ds_read_b64_tr_b16 v[26:27], v9 offset:37376
    s_waitcnt lgkmcnt(6)
    v_mfma_f32_16x16x32_bf16 v[72:75], v[36:39], v[176:179], v[72:75]
    ds_read_b64_tr_b16 v[28:29], v10 offset:36864
    v_mfma_f32_16x16x32_bf16 v[76:79], v[36:39], v[180:183], v[76:79]
    ds_read_b64_tr_b16 v[30:31], v10 offset:37376
    s_waitcnt lgkmcnt(6)
    v_mfma_f32_16x16x32_bf16 v[88:91], v[16:19], v[176:179], v[88:91]
    ds_read_b64_tr_b16 v[32:33], v11 offset:36864
    v_mfma_f32_16x16x32_bf16 v[92:95], v[16:19], v[180:183], v[92:95]
    ds_read_b64_tr_b16 v[34:35], v11 offset:37376
    s_waitcnt lgkmcnt(6)
    v_mfma_f32_16x16x32_bf16 v[104:107], v[20:23], v[176:179], v[104:107]
    ds_read_b64_tr_b16 v[36:37], v47 offset:36864
    v_mfma_f32_16x16x32_bf16 v[108:111], v[20:23], v[180:183], v[108:111]
    ds_read_b64_tr_b16 v[38:39], v47 offset:37376
    s_waitcnt lgkmcnt(6)
    v_mfma_f32_16x16x32_bf16 v[48:51], v[24:27], v[184:187], v[48:51]
    ds_read_b64_tr_b16 v[16:17], v9 offset:45056
    v_mfma_f32_16x16x32_bf16 v[52:55], v[24:27], v[188:191], v[52:55]
    ds_read_b64_tr_b16 v[18:19], v9 offset:45568
    s_waitcnt lgkmcnt(6)
    v_mfma_f32_16x16x32_bf16 v[64:67], v[28:31], v[184:187], v[64:67]
    ds_read_b64_tr_b16 v[20:21], v10 offset:45056
    v_mfma_f32_16x16x32_bf16 v[68:71], v[28:31], v[188:191], v[68:71]
    ds_read_b64_tr_b16 v[22:23], v10 offset:45568
    s_waitcnt lgkmcnt(6)
    v_mfma_f32_16x16x32_bf16 v[80:83], v[32:35], v[184:187], v[80:83]
    ds_read_b64_tr_b16 v[24:25], v11 offset:45056
    v_mfma_f32_16x16x32_bf16 v[84:87], v[32:35], v[188:191], v[84:87]
    ds_read_b64_tr_b16 v[26:27], v11 offset:45568
    s_waitcnt lgkmcnt(6)
    v_mfma_f32_16x16x32_bf16 v[96:99], v[36:39], v[184:187], v[96:99]
    ds_read_b64_tr_b16 v[28:29], v47 offset:45056
    v_mfma_f32_16x16x32_bf16 v[100:103], v[36:39], v[188:191], v[100:103]
    ds_read_b64_tr_b16 v[30:31], v47 offset:45568
    v_add_u32 v9, 0xffff0000, v9
    v_add_u32 v10, 0xffff0000, v10
    v_add_u32 v11, 0xffff0000, v11
    v_add_u32 v47, 0xffff0000, v47
    s_waitcnt vmcnt(4)
    s_barrier
    s_add_u32 m0, s59, 65536
    s_add_u32 s58, s58, 229376
    s_cmp_eq_u32 s33, 2
    s_cselect_b32 s52, 1835008, 0
    s_sub_u32 s58, s58, s52
    buffer_load_dwordx4 v8, s[20:23], s58 offen offset:0 lds
    s_add_u32 m0, s59, 73728
    s_nop 0
    buffer_load_dwordx4 v8, s[24:27], s58 offen offset:0 lds
    s_add_u32 m0, s59, 81792
    s_nop 0
    buffer_load_dwordx4 v8, s[20:23], s58 offen offset:128 lds
    s_add_u32 m0, s59, 89984
    s_nop 0
    buffer_load_dwordx4 v8, s[24:27], s58 offen offset:128 lds
    s_waitcnt lgkmcnt(6)
    v_mfma_f32_16x16x32_bf16 v[56:59], v[16:19], v[184:187], v[56:59]
    ds_read_b64_tr_b16 v[32:33], v9 offset:0
    v_mfma_f32_16x16x32_bf16 v[60:63], v[16:19], v[188:191], v[60:63]
    ds_read_b64_tr_b16 v[34:35], v9 offset:512
    s_waitcnt lgkmcnt(6)
    v_mfma_f32_16x16x32_bf16 v[72:75], v[20:23], v[184:187], v[72:75]
    ds_read_b64_tr_b16 v[36:37], v10 offset:0
    v_mfma_f32_16x16x32_bf16 v[76:79], v[20:23], v[188:191], v[76:79]
    ds_read_b64_tr_b16 v[38:39], v10 offset:512
    s_waitcnt lgkmcnt(6)
    v_mfma_f32_16x16x32_bf16 v[88:91], v[24:27], v[184:187], v[88:91]
    ds_read_b64_tr_b16 v[16:17], v11 offset:0
    v_mfma_f32_16x16x32_bf16 v[92:95], v[24:27], v[188:191], v[92:95]
    ds_read_b64_tr_b16 v[18:19], v11 offset:512
    s_waitcnt lgkmcnt(6)
    v_mfma_f32_16x16x32_bf16 v[104:107], v[28:31], v[184:187], v[104:107]
    ds_read_b64_tr_b16 v[20:21], v47 offset:0
    v_mfma_f32_16x16x32_bf16 v[108:111], v[28:31], v[188:191], v[108:111]
    ds_read_b64_tr_b16 v[22:23], v47 offset:512
    s_waitcnt lgkmcnt(6)
    v_mfma_f32_16x16x32_bf16 v[48:51], v[32:35], v[192:195], v[48:51]
    ds_read_b64_tr_b16 v[24:25], v9 offset:8192
    v_mfma_f32_16x16x32_bf16 v[52:55], v[32:35], v[196:199], v[52:55]
    ds_read_b64_tr_b16 v[26:27], v9 offset:8704
    s_waitcnt lgkmcnt(6)
    v_mfma_f32_16x16x32_bf16 v[64:67], v[36:39], v[192:195], v[64:67]
    ds_read_b64_tr_b16 v[28:29], v10 offset:8192
    v_mfma_f32_16x16x32_bf16 v[68:71], v[36:39], v[196:199], v[68:71]
    ds_read_b64_tr_b16 v[30:31], v10 offset:8704
    s_waitcnt lgkmcnt(6)
    v_mfma_f32_16x16x32_bf16 v[80:83], v[16:19], v[192:195], v[80:83]
    ds_read_b64_tr_b16 v[32:33], v11 offset:8192
    v_mfma_f32_16x16x32_bf16 v[84:87], v[16:19], v[196:199], v[84:87]
    ds_read_b64_tr_b16 v[34:35], v11 offset:8704
    s_waitcnt lgkmcnt(6)
    v_mfma_f32_16x16x32_bf16 v[96:99], v[20:23], v[192:195], v[96:99]
    ds_read_b64_tr_b16 v[36:37], v47 offset:8192
    v_mfma_f32_16x16x32_bf16 v[100:103], v[20:23], v[196:199], v[100:103]
    ds_read_b64_tr_b16 v[38:39], v47 offset:8704
    s_waitcnt lgkmcnt(6)
    v_mfma_f32_16x16x32_bf16 v[56:59], v[24:27], v[192:195], v[56:59]
    ds_read_b64_tr_b16 v[16:17], v9 offset:4096
    v_mfma_f32_16x16x32_bf16 v[60:63], v[24:27], v[196:199], v[60:63]
    ds_read_b64_tr_b16 v[18:19], v9 offset:4608
    s_waitcnt lgkmcnt(6)
    v_mfma_f32_16x16x32_bf16 v[72:75], v[28:31], v[192:195], v[72:75]
    ds_read_b64_tr_b16 v[20:21], v10 offset:4096
    v_mfma_f32_16x16x32_bf16 v[76:79], v[28:31], v[196:199], v[76:79]
    ds_read_b64_tr_b16 v[22:23], v10 offset:4608
    s_waitcnt lgkmcnt(6)
    v_mfma_f32_16x16x32_bf16 v[88:91], v[32:35], v[192:195], v[88:91]
    ds_read_b64_tr_b16 v[24:25], v11 offset:4096
    v_mfma_f32_16x16x32_bf16 v[92:95], v[32:35], v[196:199], v[92:95]
    ds_read_b64_tr_b16 v[26:27], v11 offset:4608
    s_waitcnt lgkmcnt(6)
    v_mfma_f32_16x16x32_bf16 v[104:107], v[36:39], v[192:195], v[104:107]
    ds_read_b64_tr_b16 v[28:29], v47 offset:4096
    v_mfma_f32_16x16x32_bf16 v[108:111], v[36:39], v[196:199], v[108:111]
    ds_read_b64_tr_b16 v[30:31], v47 offset:4608
    s_waitcnt lgkmcnt(6)
    v_mfma_f32_16x16x32_bf16 v[48:51], v[16:19], v[200:203], v[48:51]
    ds_read_b64_tr_b16 v[32:33], v9 offset:12288
    v_mfma_f32_16x16x32_bf16 v[52:55], v[16:19], v[204:207], v[52:55]
    ds_read_b64_tr_b16 v[34:35], v9 offset:12800
    s_waitcnt lgkmcnt(6)
    v_mfma_f32_16x16x32_bf16 v[64:67], v[20:23], v[200:203], v[64:67]
    ds_read_b64_tr_b16 v[36:37], v10 offset:12288
    v_mfma_f32_16x16x32_bf16 v[68:71], v[20:23], v[204:207], v[68:71]
    ds_read_b64_tr_b16 v[38:39], v10 offset:12800
    s_waitcnt lgkmcnt(6)
    v_mfma_f32_16x16x32_bf16 v[80:83], v[24:27], v[200:203], v[80:83]
    ds_read_b64_tr_b16 v[16:17], v11 offset:12288
    v_mfma_f32_16x16x32_bf16 v[84:87], v[24:27], v[204:207], v[84:87]
    ds_read_b64_tr_b16 v[18:19], v11 offset:12800
    s_waitcnt lgkmcnt(6)
    v_mfma_f32_16x16x32_bf16 v[96:99], v[28:31], v[200:203], v[96:99]
    ds_read_b64_tr_b16 v[20:21], v47 offset:12288
    v_mfma_f32_16x16x32_bf16 v[100:103], v[28:31], v[204:207], v[100:103]
    ds_read_b64_tr_b16 v[22:23], v47 offset:12800
    s_waitcnt vmcnt(4)
    s_barrier
    s_add_u32 m0, s59, 98304
    s_add_u32 s58, s58, 229376
    buffer_load_dwordx4 v8, s[20:23], s58 offen offset:0 lds
    s_add_u32 m0, s59, 106496
    s_nop 0
    buffer_load_dwordx4 v8, s[24:27], s58 offen offset:0 lds
    s_add_u32 m0, s59, 114560
    s_nop 0
    buffer_load_dwordx4 v8, s[20:23], s58 offen offset:128 lds
    s_add_u32 m0, s59, 122752
    s_nop 0
    buffer_load_dwordx4 v8, s[24:27], s58 offen offset:128 lds
    s_waitcnt lgkmcnt(6)
    v_mfma_f32_16x16x32_bf16 v[56:59], v[32:35], v[200:203], v[56:59]
    ds_read_b64_tr_b16 v[24:25], v9 offset:32768
    v_mfma_f32_16x16x32_bf16 v[60:63], v[32:35], v[204:207], v[60:63]
    ds_read_b64_tr_b16 v[26:27], v9 offset:33280
    s_waitcnt lgkmcnt(6)
    v_mfma_f32_16x16x32_bf16 v[72:75], v[36:39], v[200:203], v[72:75]
    ds_read_b64_tr_b16 v[28:29], v10 offset:32768
    v_mfma_f32_16x16x32_bf16 v[76:79], v[36:39], v[204:207], v[76:79]
    ds_read_b64_tr_b16 v[30:31], v10 offset:33280
    s_waitcnt lgkmcnt(6)
    v_mfma_f32_16x16x32_bf16 v[88:91], v[16:19], v[200:203], v[88:91]
    ds_read_b64_tr_b16 v[32:33], v11 offset:32768
    v_mfma_f32_16x16x32_bf16 v[92:95], v[16:19], v[204:207], v[92:95]
    ds_read_b64_tr_b16 v[34:35], v11 offset:33280
    s_waitcnt lgkmcnt(6)
    v_mfma_f32_16x16x32_bf16 v[104:107], v[20:23], v[200:203], v[104:107]
    ds_read_b64_tr_b16 v[36:37], v47 offset:32768
    v_mfma_f32_16x16x32_bf16 v[108:111], v[20:23], v[204:207], v[108:111]
    ds_read_b64_tr_b16 v[38:39], v47 offset:33280
    s_waitcnt lgkmcnt(6)
    v_mfma_f32_16x16x32_bf16 v[48:51], v[24:27], v[208:211], v[48:51]
    ds_read_b64_tr_b16 v[16:17], v9 offset:40960
    v_mfma_f32_16x16x32_bf16 v[52:55], v[24:27], v[212:215], v[52:55]
    ds_read_b64_tr_b16 v[18:19], v9 offset:41472
    s_waitcnt lgkmcnt(6)
    v_mfma_f32_16x16x32_bf16 v[64:67], v[28:31], v[208:211], v[64:67]
    ds_read_b64_tr_b16 v[20:21], v10 offset:40960
    v_mfma_f32_16x16x32_bf16 v[68:71], v[28:31], v[212:215], v[68:71]
    ds_read_b64_tr_b16 v[22:23], v10 offset:41472
    s_waitcnt lgkmcnt(6)
    v_mfma_f32_16x16x32_bf16 v[80:83], v[32:35], v[208:211], v[80:83]
    ds_read_b64_tr_b16 v[24:25], v11 offset:40960
    v_mfma_f32_16x16x32_bf16 v[84:87], v[32:35], v[212:215], v[84:87]
    ds_read_b64_tr_b16 v[26:27], v11 offset:41472
    s_waitcnt lgkmcnt(6)
    v_mfma_f32_16x16x32_bf16 v[96:99], v[36:39], v[208:211], v[96:99]
    ds_read_b64_tr_b16 v[28:29], v47 offset:40960
    v_mfma_f32_16x16x32_bf16 v[100:103], v[36:39], v[212:215], v[100:103]
    ds_read_b64_tr_b16 v[30:31], v47 offset:41472
    s_waitcnt lgkmcnt(6)
    v_mfma_f32_16x16x32_bf16 v[56:59], v[16:19], v[208:211], v[56:59]
    ds_read_b64_tr_b16 v[32:33], v9 offset:36864
    v_mfma_f32_16x16x32_bf16 v[60:63], v[16:19], v[212:215], v[60:63]
    ds_read_b64_tr_b16 v[34:35], v9 offset:37376
    s_waitcnt lgkmcnt(6)
    v_mfma_f32_16x16x32_bf16 v[72:75], v[20:23], v[208:211], v[72:75]
    ds_read_b64_tr_b16 v[36:37], v10 offset:36864
    v_mfma_f32_16x16x32_bf16 v[76:79], v[20:23], v[212:215], v[76:79]
    ds_read_b64_tr_b16 v[38:39], v10 offset:37376
    s_waitcnt lgkmcnt(6)
    v_mfma_f32_16x16x32_bf16 v[88:91], v[24:27], v[208:211], v[88:91]
    ds_read_b64_tr_b16 v[16:17], v11 offset:36864
    v_mfma_f32_16x16x32_bf16 v[92:95], v[24:27], v[212:215], v[92:95]
    ds_read_b64_tr_b16 v[18:19], v11 offset:37376
    s_waitcnt lgkmcnt(6)
    v_mfma_f32_16x16x32_bf16 v[104:107], v[28:31], v[208:211], v[104:107]
    ds_read_b64_tr_b16 v[20:21], v47 offset:36864
    v_mfma_f32_16x16x32_bf16 v[108:111], v[28:31], v[212:215], v[108:111]
    ds_read_b64_tr_b16 v[22:23], v47 offset:37376
    s_waitcnt lgkmcnt(6)
    v_mfma_f32_16x16x32_bf16 v[48:51], v[32:35], v[216:219], v[48:51]
    ds_read_b64_tr_b16 v[24:25], v9 offset:45056
    v_mfma_f32_16x16x32_bf16 v[52:55], v[32:35], v[220:223], v[52:55]
    ds_read_b64_tr_b16 v[26:27], v9 offset:45568
    s_waitcnt lgkmcnt(6)
    v_mfma_f32_16x16x32_bf16 v[64:67], v[36:39], v[216:219], v[64:67]
    ds_read_b64_tr_b16 v[28:29], v10 offset:45056
    v_mfma_f32_16x16x32_bf16 v[68:71], v[36:39], v[220:223], v[68:71]
    ds_read_b64_tr_b16 v[30:31], v10 offset:45568
    s_waitcnt lgkmcnt(6)
    v_mfma_f32_16x16x32_bf16 v[80:83], v[16:19], v[216:219], v[80:83]
    ds_read_b64_tr_b16 v[32:33], v11 offset:45056
    v_mfma_f32_16x16x32_bf16 v[84:87], v[16:19], v[220:223], v[84:87]
    ds_read_b64_tr_b16 v[34:35], v11 offset:45568
    s_waitcnt lgkmcnt(6)
    v_mfma_f32_16x16x32_bf16 v[96:99], v[20:23], v[216:219], v[96:99]
    ds_read_b64_tr_b16 v[36:37], v47 offset:45056
    v_mfma_f32_16x16x32_bf16 v[100:103], v[20:23], v[220:223], v[100:103]
    ds_read_b64_tr_b16 v[38:39], v47 offset:45568
    v_add_u32 v9, 0x10000, v9
    v_add_u32 v10, 0x10000, v10
    v_add_u32 v11, 0x10000, v11
    v_add_u32 v47, 0x10000, v47
    s_waitcnt vmcnt(4)
    s_barrier
    s_cmp_lg_u32 s3, 0
    s_cbranch_scc1 L_w0_14AP
    s_mov_b64 exec, s[64:65]
    buffer_load_dwordx2 v[140:141], v142, s[16:19], 0 offen sc1
    s_mov_b64 exec, -1
L_w0_14AP:
    v_lshrrev_b32 v3, 9, v1
    v_lshlrev_b32 v8, 8, v3
    v_and_b32 v3, 0xf0, v1
    v_add_u32 v8, v3, v8
    v_add_u32 v8, 2097152, v8
    v_mov_b32 v5, 0x3f803f80
    v_bfe_u32 v3, v1, 4, 6
    v_and_b32 v3, 27, v3
    v_cmp_eq_u32 vcc, 16, v3
    s_nop 1
    v_cndmask_b32 v5, 0, v5, vcc
    v_mov_b32 v164, v5
    v_mov_b32 v165, v5
    v_mov_b32 v166, v5
    v_mov_b32 v167, v5
    v_mov_b32 v168, v5
    v_mov_b32 v169, v5
    v_mov_b32 v170, v5
    v_mov_b32 v171, v5
    v_mov_b32 v176, v5
    v_mov_b32 v177, v5
    v_mov_b32 v178, v5
    v_mov_b32 v179, v5
    v_mov_b32 v180, v5
    v_mov_b32 v181, v5
    v_mov_b32 v182, v5
    v_mov_b32 v183, v5
    s_waitcnt lgkmcnt(6)
    v_mfma_f32_16x16x32_bf16 v[56:59], v[24:27], v[216:219], v[56:59]
    ds_read_b64_tr_b16 v[16:17], v9 offset:0
    v_mfma_f32_16x16x32_bf16 v[60:63], v[24:27], v[220:223], v[60:63]
    ds_read_b64_tr_b16 v[18:19], v9 offset:512
    s_waitcnt lgkmcnt(6)
    v_mfma_f32_16x16x32_bf16 v[72:75], v[28:31], v[216:219], v[72:75]
    ds_read_b64_tr_b16 v[20:21], v10 offset:0
    v_mfma_f32_16x16x32_bf16 v[76:79], v[28:31], v[220:223], v[76:79]
    ds_read_b64_tr_b16 v[22:23], v10 offset:512
    s_waitcnt lgkmcnt(6)
    v_mfma_f32_16x16x32_bf16 v[88:91], v[32:35], v[216:219], v[88:91]
    ds_read_b64_tr_b16 v[24:25], v11 offset:0
    v_mfma_f32_16x16x32_bf16 v[92:95], v[32:35], v[220:223], v[92:95]
    ds_read_b64_tr_b16 v[26:27], v11 offset:512
    s_waitcnt lgkmcnt(6)
    v_mfma_f32_16x16x32_bf16 v[104:107], v[36:39], v[216:219], v[104:107]
    ds_read_b64_tr_b16 v[28:29], v47 offset:0
    v_mfma_f32_16x16x32_bf16 v[108:111], v[36:39], v[220:223], v[108:111]
    ds_read_b64_tr_b16 v[30:31], v47 offset:512
    s_waitcnt lgkmcnt(6)
    v_mfma_f32_16x16x32_bf16 v[48:51], v[16:19], v[224:227], v[48:51]
    ds_read_b64_tr_b16 v[32:33], v9 offset:8192
    v_mfma_f32_16x16x32_bf16 v[52:55], v[16:19], v[228:231], v[52:55]
    ds_read_b64_tr_b16 v[34:35], v9 offset:8704
    s_waitcnt lgkmcnt(6)
    v_mfma_f32_16x16x32_bf16 v[64:67], v[20:23], v[224:227], v[64:67]
    ds_read_b64_tr_b16 v[36:37], v10 offset:8192
    v_mfma_f32_16x16x32_bf16 v[68:71], v[20:23], v[228:231], v[68:71]
    ds_read_b64_tr_b16 v[38:39], v10 offset:8704
    s_waitcnt lgkmcnt(6)
    v_mfma_f32_16x16x32_bf16 v[80:83], v[24:27], v[224:227], v[80:83]
    ds_read_b64_tr_b16 v[16:17], v11 offset:8192
    v_mfma_f32_16x16x32_bf16 v[84:87], v[24:27], v[228:231], v[84:87]
    ds_read_b64_tr_b16 v[18:19], v11 offset:8704
    s_waitcnt lgkmcnt(6)
    v_mfma_f32_16x16x32_bf16 v[96:99], v[28:31], v[224:227], v[96:99]
    ds_read_b64_tr_b16 v[20:21], v47 offset:8192
    v_mfma_f32_16x16x32_bf16 v[100:103], v[28:31], v[228:231], v[100:103]
    ds_read_b64_tr_b16 v[22:23], v47 offset:8704
    s_waitcnt lgkmcnt(6)
    v_mfma_f32_16x16x32_bf16 v[56:59], v[32:35], v[224:227], v[56:59]
    ds_read_b64_tr_b16 v[24:25], v9 offset:4096
    v_mfma_f32_16x16x32_bf16 v[60:63], v[32:35], v[228:231], v[60:63]
    ds_read_b64_tr_b16 v[26:27], v9 offset:4608
    s_waitcnt lgkmcnt(6)
    v_mfma_f32_16x16x32_bf16 v[72:75], v[36:39], v[224:227], v[72:75]
    ds_read_b64_tr_b16 v[28:29], v10 offset:4096
    v_mfma_f32_16x16x32_bf16 v[76:79], v[36:39], v[228:231], v[76:79]
    ds_read_b64_tr_b16 v[30:31], v10 offset:4608
    s_waitcnt lgkmcnt(6)
    v_mfma_f32_16x16x32_bf16 v[88:91], v[16:19], v[224:227], v[88:91]
    ds_read_b64_tr_b16 v[32:33], v11 offset:4096
    v_mfma_f32_16x16x32_bf16 v[92:95], v[16:19], v[228:231], v[92:95]
    ds_read_b64_tr_b16 v[34:35], v11 offset:4608
    s_waitcnt lgkmcnt(6)
    v_mfma_f32_16x16x32_bf16 v[104:107], v[20:23], v[224:227], v[104:107]
    ds_read_b64_tr_b16 v[36:37], v47 offset:4096
    v_mfma_f32_16x16x32_bf16 v[108:111], v[20:23], v[228:231], v[108:111]
    ds_read_b64_tr_b16 v[38:39], v47 offset:4608
    s_waitcnt lgkmcnt(6)
    v_mfma_f32_16x16x32_bf16 v[48:51], v[24:27], v[232:235], v[48:51]
    ds_read_b64_tr_b16 v[16:17], v9 offset:12288
    v_mfma_f32_16x16x32_bf16 v[52:55], v[24:27], v[236:239], v[52:55]
    ds_read_b64_tr_b16 v[18:19], v9 offset:12800
    s_waitcnt lgkmcnt(6)
    v_mfma_f32_16x16x32_bf16 v[64:67], v[28:31], v[232:235], v[64:67]
    ds_read_b64_tr_b16 v[20:21], v10 offset:12288
    v_mfma_f32_16x16x32_bf16 v[68:71], v[28:31], v[236:239], v[68:71]
    ds_read_b64_tr_b16 v[22:23], v10 offset:12800
    s_waitcnt lgkmcnt(6)
    v_mfma_f32_16x16x32_bf16 v[80:83], v[32:35], v[232:235], v[80:83]
    ds_read_b64_tr_b16 v[24:25], v11 offset:12288
    v_mfma_f32_16x16x32_bf16 v[84:87], v[32:35], v[236:239], v[84:87]
    ds_read_b64_tr_b16 v[26:27], v11 offset:12800
    s_waitcnt lgkmcnt(6)
    v_mfma_f32_16x16x32_bf16 v[96:99], v[36:39], v[232:235], v[96:99]
    ds_read_b64_tr_b16 v[28:29], v47 offset:12288
    v_mfma_f32_16x16x32_bf16 v[100:103], v[36:39], v[236:239], v[100:103]
    ds_read_b64_tr_b16 v[30:31], v47 offset:12800
    s_cmp_lg_u32 s3, 0
    s_cbranch_scc1 L_w0_cAP
    s_mov_b32 s50, 131072
    s_waitcnt vmcnt(0)
    s_branch L_pollQAP_w
L_pollQAP:
    s_mov_b64 exec, s[64:65]
    buffer_load_dwordx2 v[140:141], v142, s[16:19], 0 offen sc1
    s_mov_b64 exec, -1
    s_waitcnt vmcnt(0)
L_pollQAP_w:
    v_cmp_eq_u64 vcc, s[48:49], v[140:141]
    s_sub_u32 s50, s50, 1
    s_cbranch_scc1 L_pollQAP_x
    s_and_b64 vcc, vcc, s[64:65]
    s_cmp_eq_u64 vcc, s[64:65]
    s_cbranch_scc0 L_pollQAP
L_pollQAP_x:
L_w0_cAP:
    s_waitcnt vmcnt(0)
    s_barrier
    v_and_b32 v44, 0x300, v1
    v_mad_u32_u24 v44, v44, 3, v1
    buffer_load_dwordx4 v[192:195], v44, s[16:19], s0 offen offset:0 sc1
    buffer_load_dwordx4 v[196:199], v44, s[16:19], s0 offen offset:512 sc1
    buffer_load_dwordx4 v[160:163], v1, s[16:19], s79 offen sc1
    buffer_load_dwordx4 v[128:131], v1, s[16:19], s86 offen offset:0 sc1
    buffer_load_dwordx4 v[132:135], v1, s[16:19], s86 offen offset:1024 sc1
    s_waitcnt lgkmcnt(6)
    v_mfma_f32_16x16x32_bf16 v[56:59], v[16:19], v[232:235], v[56:59]
    ds_read_b64_tr_b16 v[32:33], v9 offset:32768
    v_mfma_f32_16x16x32_bf16 v[60:63], v[16:19], v[236:239], v[60:63]
    ds_read_b64_tr_b16 v[34:35], v9 offset:33280
    s_mov_b64 exec, s[82:83]
    buffer_load_dwordx4 v[164:167], v8, s[16:19], s79 offen sc1
    buffer_load_dwordx4 v[168:171], v8, s[16:19], s79 offen offset:512 sc1
    s_mov_b64 exec, -1
    s_waitcnt lgkmcnt(6)
    v_mfma_f32_16x16x32_bf16 v[72:75], v[20:23], v[232:235], v[72:75]
    ds_read_b64_tr_b16 v[36:37], v10 offset:32768
    v_mfma_f32_16x16x32_bf16 v[76:79], v[20:23], v[236:239], v[76:79]
    ds_read_b64_tr_b16 v[38:39], v10 offset:33280
    buffer_load_dwordx4 v[136:139], v1, s[16:19], s87 offen offset:0 sc1
    s_waitcnt lgkmcnt(6)
    v_mfma_f32_16x16x32_bf16 v[88:91], v[24:27], v[232:235], v[88:91]
    ds_read_b64_tr_b16 v[16:17], v11 offset:32768
    v_mfma_f32_16x16x32_bf16 v[92:95], v[24:27], v[236:239], v[92:95]
    ds_read_b64_tr_b16 v[18:19], v11 offset:33280
    buffer_load_dwordx4 v[140:143], v1, s[16:19], s87 offen offset:1024 sc1
    s_waitcnt lgkmcnt(6)
    v_mfma_f32_16x16x32_bf16 v[104:107], v[28:31], v[232:235], v[104:107]
    ds_read_b64_tr_b16 v[20:21], v47 offset:32768
    v_mfma_f32_16x16x32_bf16 v[108:111], v[28:31], v[236:239], v[108:111]
    ds_read_b64_tr_b16 v[22:23], v47 offset:33280
    buffer_load_dwordx4 v[144:147], v1, s[16:19], s88 offen offset:0 sc1
    s_waitcnt lgkmcnt(6)
    v_mfma_f32_16x16x32_bf16 v[48:51], v[32:35], v[240:243], v[48:51]
    ds_read_b64_tr_b16 v[24:25], v9 offset:40960
    v_mfma_f32_16x16x32_bf16 v[52:55], v[32:35], v[244:247], v[52:55]
    ds_read_b64_tr_b16 v[26:27], v9 offset:41472
    buffer_load_dwordx4 v[148:151], v1, s[16:19], s88 offen offset:1024 sc1
    s_waitcnt lgkmcnt(6)
    v_mfma_f32_16x16x32_bf16 v[64:67], v[36:39], v[240:243], v[64:67]
    ds_read_b64_tr_b16 v[28:29], v10 offset:40960
    v_mfma_f32_16x16x32_bf16 v[68:71], v[36:39], v[244:247], v[68:71]
    ds_read_b64_tr_b16 v[30:31], v10 offset:41472
    buffer_load_dwordx4 v[152:155], v1, s[16:19], s89 offen offset:0 sc1
    s_waitcnt lgkmcnt(6)
    v_mfma_f32_16x16x32_bf16 v[80:83], v[16:19], v[240:243], v[80:83]
    ds_read_b64_tr_b16 v[32:33], v11 offset:40960
    v_mfma_f32_16x16x32_bf16 v[84:87], v[16:19], v[244:247], v[84:87]
    ds_read_b64_tr_b16 v[34:35], v11 offset:41472
    buffer_load_dwordx4 v[156:159], v1, s[16:19], s89 offen offset:1024 sc1
    s_waitcnt lgkmcnt(6)
    v_mfma_f32_16x16x32_bf16 v[96:99], v[20:23], v[240:243], v[96:99]
    ds_read_b64_tr_b16 v[36:37], v47 offset:40960
    v_mfma_f32_16x16x32_bf16 v[100:103], v[20:23], v[244:247], v[100:103]
    ds_read_b64_tr_b16 v[38:39], v47 offset:41472
    buffer_load_dwordx4 v[172:175], v1, s[16:19], s79 offen offset:1024 sc1
    s_waitcnt lgkmcnt(6)
    v_mfma_f32_16x16x32_bf16 v[56:59], v[24:27], v[240:243], v[56:59]
    ds_read_b64_tr_b16 v[16:17], v9 offset:36864
    v_mfma_f32_16x16x32_bf16 v[60:63], v[24:27], v[244:247], v[60:63]
    ds_read_b64_tr_b16 v[18:19], v9 offset:37376
    s_mov_b64 exec, s[82:83]
    buffer_load_dwordx4 v[176:179], v8, s[16:19], s79 offen offset:1024 sc1
    buffer_load_dwordx4 v[180:183], v8, s[16:19], s79 offen offset:1536 sc1
    s_mov_b64 exec, -1
    s_waitcnt lgkmcnt(6)
    v_mfma_f32_16x16x32_bf16 v[72:75], v[28:31], v[240:243], v[72:75]
    ds_read_b64_tr_b16 v[20:21], v10 offset:36864
    v_mfma_f32_16x16x32_bf16 v[76:79], v[28:31], v[244:247], v[76:79]
    ds_read_b64_tr_b16 v[22:23], v10 offset:37376
    s_waitcnt lgkmcnt(6)
    v_mfma_f32_16x16x32_bf16 v[88:91], v[32:35], v[240:243], v[88:91]
    ds_read_b64_tr_b16 v[24:25], v11 offset:36864
    v_mfma_f32_16x16x32_bf16 v[92:95], v[32:35], v[244:247], v[92:95]
    ds_read_b64_tr_b16 v[26:27], v11 offset:37376
    s_waitcnt lgkmcnt(6)
    v_mfma_f32_16x16x32_bf16 v[104:107], v[36:39], v[240:243], v[104:107]
    ds_read_b64_tr_b16 v[28:29], v47 offset:36864
    v_mfma_f32_16x16x32_bf16 v[108:111], v[36:39], v[244:247], v[108:111]
    ds_read_b64_tr_b16 v[30:31], v47 offset:37376
    s_waitcnt lgkmcnt(6)
    v_mfma_f32_16x16x32_bf16 v[48:51], v[16:19], v[248:251], v[48:51]
    ds_read_b64_tr_b16 v[32:33], v9 offset:45056
    v_mfma_f32_16x16x32_bf16 v[52:55], v[16:19], v[252:255], v[52:55]
    ds_read_b64_tr_b16 v[34:35], v9 offset:45568
    s_waitcnt lgkmcnt(6)
    v_mfma_f32_16x16x32_bf16 v[64:67], v[20:23], v[248:251], v[64:67]
    ds_read_b64_tr_b16 v[36:37], v10 offset:45056
    v_mfma_f32_16x16x32_bf16 v[68:71], v[20:23], v[252:255], v[68:71]
    ds_read_b64_tr_b16 v[38:39], v10 offset:45568
    v_mov_b32 v220, v5
    v_mov_b32 v221, v5
    v_mov_b32 v222, v5
    v_mov_b32 v223, v5
    v_mov_b32 v224, v5
    v_mov_b32 v225, v5
    v_mov_b32 v226, v5
    v_mov_b32 v227, v5
    s_waitcnt lgkmcnt(6)
    v_mfma_f32_16x16x32_bf16 v[80:83], v[24:27], v[248:251], v[80:83]
    ds_read_b64_tr_b16 v[16:17], v11 offset:45056
    v_mfma_f32_16x16x32_bf16 v[84:87], v[24:27], v[252:255], v[84:87]
    ds_read_b64_tr_b16 v[18:19], v11 offset:45568
    v_mov_b32 v232, v5
    v_mov_b32 v233, v5
    v_mov_b32 v234, v5
    v_mov_b32 v235, v5
    v_mov_b32 v236, v5
    v_mov_b32 v237, v5
    v_mov_b32 v238, v5
    v_mov_b32 v239, v5
    s_waitcnt lgkmcnt(6)
    v_mfma_f32_16x16x32_bf16 v[96:99], v[28:31], v[248:251], v[96:99]
    ds_read_b64_tr_b16 v[20:21], v47 offset:45056
    v_mfma_f32_16x16x32_bf16 v[100:103], v[28:31], v[252:255], v[100:103]
    ds_read_b64_tr_b16 v[22:23], v47 offset:45568
    s_waitcnt vmcnt(14)
    v_add_f32 v40, v192, v196
    v_add_f32 v41, v193, v197
    v_add_f32 v42, v194, v198
    v_add_f32 v43, v195, v199
    s_lshl_b32 s52, s32, 2
    s_add_u32 s52, s52, 151552
    v_add_u32 v4, s52, v1
    v_cvt_pk_bf16_f32 v3, v40, v40
    v_lshlrev_b32 v3, 16, v3
    v_sub_f32 v5, v40, v3
    v_cvt_pk_bf16_f32 v3, v3, v5
    ds_write_b32 v4, v3 offset:0
    v_cvt_pk_bf16_f32 v3, v41, v41
    v_lshlrev_b32 v3, 16, v3
    v_sub_f32 v5, v41, v3
    v_cvt_pk_bf16_f32 v3, v3, v5
    ds_write_b32 v4, v3 offset:1024
    v_cvt_pk_bf16_f32 v3, v42, v42
    v_lshlrev_b32 v3, 16, v3
    v_sub_f32 v5, v42, v3
    v_cvt_pk_bf16_f32 v3, v3, v5
    ds_write_b32 v4, v3 offset:2048
    v_cvt_pk_bf16_f32 v3, v43, v43
    v_lshlrev_b32 v3, 16, v3
    v_sub_f32 v5, v43, v3
    v_cvt_pk_bf16_f32 v3, v3, v5
    ds_write_b32 v4, v3 offset:3072
    v_mov_b32 v184, 0
    v_mov_b32 v185, 0
    v_mov_b32 v186, v12
    v_mov_b32 v187, v12
    v_mov_b32 v188, 0
    v_mov_b32 v189, 0
    v_mov_b32 v190, v14
    v_mov_b32 v191, v14
    v_mov_b32 v192, 0
    v_mov_b32 v193, 0
    v_mul_f32 v44, v13, v13
    v_mul_f32 v45, v15, v15
    s_waitcnt lgkmcnt(0)
    s_barrier
    v_add_u32 v4, 151552, v1
    ds_read_b128 v[112:115], v4 offset:0
    ds_read_b128 v[116:119], v4 offset:1024
    ds_read_b128 v[120:123], v4 offset:2048
    ds_read_b128 v[124:127], v4 offset:3072
    v_mfma_f32_16x16x32_bf16 v[56:59], v[32:35], v[248:251], v[56:59]
    v_mfma_f32_16x16x32_bf16 v[60:63], v[32:35], v[252:255], v[60:63]
    v_mfma_f32_16x16x32_bf16 v[72:75], v[36:39], v[248:251], v[72:75]
    v_mfma_f32_16x16x32_bf16 v[76:79], v[36:39], v[252:255], v[76:79]
    v_mfma_f32_16x16x32_bf16 v[88:91], v[16:19], v[248:251], v[88:91]
    v_mfma_f32_16x16x32_bf16 v[92:95], v[16:19], v[252:255], v[92:95]
    v_mfma_f32_16x16x32_bf16 v[104:107], v[20:23], v[248:251], v[104:107]
    v_mfma_f32_16x16x32_bf16 v[108:111], v[20:23], v[252:255], v[108:111]
    s_waitcnt lgkmcnt(3)
    v_mfma_f32_16x16x32_bf16 v[48:51], v[112:115], v[186:189], v[48:51]
    v_mfma_f32_16x16x32_bf16 v[52:55], v[112:115], v[190:193], v[52:55]
    v_mfma_f32_16x16x32_bf16 v[56:59], v[112:115], v[184:187], v[56:59]
    v_mfma_f32_16x16x32_bf16 v[60:63], v[112:115], v[188:191], v[60:63]
    s_waitcnt lgkmcnt(2)
    v_mfma_f32_16x16x32_bf16 v[64:67], v[116:119], v[186:189], v[64:67]
    v_mfma_f32_16x16x32_bf16 v[68:71], v[116:119], v[190:193], v[68:71]
    v_mfma_f32_16x16x32_bf16 v[72:75], v[116:119], v[184:187], v[72:75]
    v_mfma_f32_16x16x32_bf16 v[76:79], v[116:119], v[188:191], v[76:79]
    s_nop 1
    v_max_f32 v48, 0, v48
    v_max_f32 v49, 0, v49
    v_max_f32 v50, 0, v50
    v_max_f32 v51, 0, v51
    s_waitcnt lgkmcnt(1)
    v_mfma_f32_16x16x32_bf16 v[80:83], v[120:123], v[186:189], v[80:83]
    v_max_f32 v52, 0, v52
    v_max_f32 v53, 0, v53
    v_max_f32 v54, 0, v54
    v_max_f32 v55, 0, v55
    v_mfma_f32_16x16x32_bf16 v[84:87], v[120:123], v[190:193], v[84:87]
    v_mul_f32 v56, v44, v56
    v_mul_f32 v57, v44, v57
    v_mul_f32 v58, v44, v58
    v_mul_f32 v59, v44, v59
    v_mfma_f32_16x16x32_bf16 v[88:91], v[120:123], v[184:187], v[88:91]
    v_mul_f32 v60, v45, v60
    v_mul_f32 v61, v45, v61
    v_mul_f32 v62, v45, v62
    v_mul_f32 v63, v45, v63
    v_mfma_f32_16x16x32_bf16 v[92:95], v[120:123], v[188:191], v[92:95]
    v_mul_f32 v48, v48, v56
    v_mul_f32 v49, v49, v57
    v_mul_f32 v50, v50, v58
    v_mul_f32 v51, v51, v59
    v_mul_f32 v52, v52, v60
    v_mul_f32 v53, v53, v61
    v_mul_f32 v54, v54, v62
    v_mul_f32 v55, v55, v63
    v_cvt_pk_bf16_f32 v200, v48, v49
    v_cvt_pk_bf16_f32 v201, v50, v51
    v_cvt_pk_bf16_f32 v202, v52, v53
    v_cvt_pk_bf16_f32 v203, v54, v55
    v_max_f32 v64, 0, v64
    v_max_f32 v65, 0, v65
    v_permlane32_swap_b32 v200, v202
    v_permlane32_swap_b32 v201, v203
    buffer_store_dwordx4 v[200:203], v46, s[16:19], s77 offen offset:0 sc1
    v_max_f32 v66, 0, v66
    v_max_f32 v67, 0, v67
    s_waitcnt lgkmcnt(0)
    v_mfma_f32_16x16x32_bf16 v[96:99], v[124:127], v[186:189], v[96:99]
    v_max_f32 v68, 0, v68
    v_max_f32 v69, 0, v69
    v_max_f32 v70, 0, v70
    v_max_f32 v71, 0, v71
    v_mfma_f32_16x16x32_bf16 v[100:103], v[124:127], v[190:193], v[100:103]
    v_mul_f32 v72, v44, v72
    v_mul_f32 v73, v44, v73
    v_mul_f32 v74, v44, v74
    v_mul_f32 v75, v44, v75
    v_mfma_f32_16x16x32_bf16 v[104:107], v[124:127], v[184:187], v[104:107]
    v_mul_f32 v76, v45, v76
    v_mul_f32 v77, v45, v77
    v_mul_f32 v78, v45, v78
    v_mul_f32 v79, v45, v79
    v_mfma_f32_16x16x32_bf16 v[108:111], v[124:127], v[188:191], v[108:111]
    v_mul_f32 v64, v64, v72
    v_mul_f32 v65, v65, v73
    v_mul_f32 v66, v66, v74
    v_mul_f32 v67, v67, v75
    v_mul_f32 v68, v68, v76
    v_mul_f32 v69, v69, v77
    v_mul_f32 v70, v70, v78
    v_mul_f32 v71, v71, v79
    v_cvt_pk_bf16_f32 v204, v64, v65
    v_cvt_pk_bf16_f32 v205, v66, v67
    v_cvt_pk_bf16_f32 v206, v68, v69
    v_cvt_pk_bf16_f32 v207, v70, v71
    v_max_f32 v80, 0, v80
    v_max_f32 v81, 0, v81
    v_permlane32_swap_b32 v204, v206
    v_permlane32_swap_b32 v205, v207
    buffer_store_dwordx4 v[204:207], v46, s[16:19], s77 offen offset:1024 sc1
    v_max_f32 v82, 0, v82
    v_max_f32 v83, 0, v83
    v_max_f32 v84, 0, v84
    v_max_f32 v85, 0, v85
    v_max_f32 v86, 0, v86
    v_max_f32 v87, 0, v87
    v_mul_f32 v88, v44, v88
    v_mul_f32 v89, v44, v89
    v_mul_f32 v90, v44, v90
    v_mul_f32 v91, v44, v91
    v_mul_f32 v92, v45, v92
    v_mul_f32 v93, v45, v93
    v_mul_f32 v94, v45, v94
    v_mul_f32 v95, v45, v95
    v_mul_f32 v80, v80, v88
    v_mul_f32 v81, v81, v89
    v_mul_f32 v82, v82, v90
    v_mul_f32 v83, v83, v91
    v_mul_f32 v84, v84, v92
    v_mul_f32 v85, v85, v93
    v_mul_f32 v86, v86, v94
    v_mul_f32 v87, v87, v95
    v_cvt_pk_bf16_f32 v208, v80, v81
    v_cvt_pk_bf16_f32 v209, v82, v83
    v_cvt_pk_bf16_f32 v210, v84, v85
    v_cvt_pk_bf16_f32 v211, v86, v87
    v_max_f32 v96, 0, v96
    v_max_f32 v97, 0, v97
    v_permlane32_swap_b32 v208, v210
    v_permlane32_swap_b32 v209, v211
    buffer_store_dwordx4 v[208:211], v46, s[16:19], s77 offen offset:2048 sc1
    v_max_f32 v98, 0, v98
    v_max_f32 v99, 0, v99
    v_max_f32 v100, 0, v100
    v_max_f32 v101, 0, v101
    v_max_f32 v102, 0, v102
    v_max_f32 v103, 0, v103
    v_mul_f32 v104, v44, v104
    v_mul_f32 v105, v44, v105
    v_mul_f32 v106, v44, v106
    v_mul_f32 v107, v44, v107
    v_mul_f32 v108, v45, v108
    v_mul_f32 v109, v45, v109
    v_mul_f32 v110, v45, v110
    v_mul_f32 v111, v45, v111
    v_mul_f32 v96, v96, v104
    v_mul_f32 v97, v97, v105
    v_mul_f32 v98, v98, v106
    v_mul_f32 v99, v99, v107
    v_mul_f32 v100, v100, v108
    v_mul_f32 v101, v101, v109
    v_mul_f32 v102, v102, v110
    v_mul_f32 v103, v103, v111
    v_cvt_pk_bf16_f32 v212, v96, v97
    v_cvt_pk_bf16_f32 v213, v98, v99
    v_cvt_pk_bf16_f32 v214, v100, v101
    v_cvt_pk_bf16_f32 v215, v102, v103
    s_nop 1
    v_permlane32_swap_b32 v212, v214
    v_permlane32_swap_b32 v213, v215
    buffer_store_dwordx4 v[212:215], v46, s[16:19], s77 offen offset:3072 sc1
    s_setprio 1
    s_waitcnt vmcnt(7)
    s_branch L_Ax
L_AR:
    s_setprio 0
    s_waitcnt vmcnt(4)
    s_barrier
    s_add_u32 m0, s56, 65536
    s_add_u32 s54, s54, 128
    s_cmp_eq_u32 s33, 6
    s_cselect_b32 s52, 1024, 0
    s_sub_u32 s54, s54, s52
    buffer_load_dwordx4 v44, s[8:11], s54 offen lds
    s_add_u32 s55, s54, 14336
    buffer_load_dwordx4 v45, s[8:11], s54 offen offset:1024 lds
    buffer_load_dwordx4 v44, s[8:11], s55 offen offset:2048 lds
    buffer_load_dwordx4 v45, s[8:11], s55 offen offset:3072 lds
    ds_read_b128 v[128:131], v12 offset:0
    ds_read_b128 v[132:135], v12 offset:2048
    ds_read_b128 v[136:139], v13 offset:0
    ds_read_b128 v[140:143], v13 offset:2048
    ds_read_b64_tr_b16 v[16:17], v46 offset:16384
    ds_read_b64_tr_b16 v[18:19], v46 offset:16896
    ds_read_b64_tr_b16 v[20:21], v46 offset:24576
    ds_read_b64_tr_b16 v[22:23], v46 offset:25088
    ds_read_b64_tr_b16 v[24:25], v6 offset:16384
    ds_read_b64_tr_b16 v[26:27], v6 offset:16896
    ds_read_b64_tr_b16 v[28:29], v6 offset:24576
    ds_read_b64_tr_b16 v[30:31], v6 offset:25088
    ds_read_b64_tr_b16 v[32:33], v46 offset:20480
    ds_read_b64_tr_b16 v[34:35], v46 offset:20992
    ds_read_b64_tr_b16 v[36:37], v46 offset:28672
    ds_read_b64_tr_b16 v[38:39], v46 offset:29184
    ds_read_b64_tr_b16 v[48:49], v6 offset:20480
    ds_read_b64_tr_b16 v[50:51], v6 offset:20992
    ds_read_b64_tr_b16 v[52:53], v6 offset:28672
    ds_read_b64_tr_b16 v[54:55], v6 offset:29184
    ds_read_b64_tr_b16 v[88:89], v7 offset:16384
    ds_read_b64_tr_b16 v[90:91], v7 offset:16896
    ds_read_b64_tr_b16 v[92:93], v7 offset:24576
    ds_read_b64_tr_b16 v[94:95], v7 offset:25088
    s_waitcnt lgkmcnt(0)
    s_waitcnt vmcnt(4)
    s_barrier
    s_add_u32 m0, s56, 98304
    s_add_u32 s54, s54, 128
    buffer_load_dwordx4 v44, s[8:11], s54 offen lds
    s_add_u32 s55, s54, 14336
    buffer_load_dwordx4 v45, s[8:11], s54 offen offset:1024 lds
    buffer_load_dwordx4 v44, s[8:11], s55 offen offset:2048 lds
    buffer_load_dwordx4 v45, s[8:11], s55 offen offset:3072 lds
    ds_read_b128 v[144:147], v12 offset:32768
    ds_read_b128 v[148:151], v12 offset:34816
    ds_read_b128 v[152:155], v13 offset:32768
    ds_read_b128 v[156:159], v13 offset:34816
    ds_read_b64_tr_b16 v[56:57], v46 offset:49152
    ds_read_b64_tr_b16 v[58:59], v46 offset:49664
    ds_read_b64_tr_b16 v[60:61], v46 offset:57344
    ds_read_b64_tr_b16 v[62:63], v46 offset:57856
    ds_read_b64_tr_b16 v[64:65], v6 offset:49152
    ds_read_b64_tr_b16 v[66:67], v6 offset:49664
    ds_read_b64_tr_b16 v[68:69], v6 offset:57344
    ds_read_b64_tr_b16 v[70:71], v6 offset:57856
    v_dot2c_f32_bf16 v40, s71, v88
    v_dot2c_f32_bf16 v41, s71, v92
    v_dot2c_f32_bf16 v40, s71, v89
    v_dot2c_f32_bf16 v41, s71, v93
    v_dot2c_f32_bf16 v40, s71, v90
    v_dot2c_f32_bf16 v41, s71, v94
    v_dot2c_f32_bf16 v40, s71, v91
    v_dot2c_f32_bf16 v41, s71, v95
    v_mfma_f32_16x16x32_bf16 v[96:99], v[16:19], v[128:131], 0
    v_mfma_f32_16x16x32_bf16 v[100:103], v[16:19], v[132:135], 0
    ds_read_b64_tr_b16 v[72:73], v46 offset:53248
    ds_read_b64_tr_b16 v[74:75], v46 offset:53760
    ds_read_b64_tr_b16 v[76:77], v46 offset:61440
    ds_read_b64_tr_b16 v[78:79], v46 offset:61952
    v_mfma_f32_16x16x32_bf16 v[112:115], v[20:23], v[128:131], 0
    v_mfma_f32_16x16x32_bf16 v[116:119], v[20:23], v[132:135], 0
    ds_read_b64_tr_b16 v[80:81], v6 offset:53248
    ds_read_b64_tr_b16 v[82:83], v6 offset:53760
    ds_read_b64_tr_b16 v[84:85], v6 offset:61440
    ds_read_b64_tr_b16 v[86:87], v6 offset:61952
    v_mfma_f32_16x16x32_bf16 v[104:107], v[24:27], v[128:131], 0
    v_mfma_f32_16x16x32_bf16 v[108:111], v[24:27], v[132:135], 0
    ds_read_b64_tr_b16 v[88:89], v7 offset:49152
    ds_read_b64_tr_b16 v[90:91], v7 offset:49664
    ds_read_b64_tr_b16 v[92:93], v7 offset:57344
    ds_read_b64_tr_b16 v[94:95], v7 offset:57856
    v_mfma_f32_16x16x32_bf16 v[120:123], v[28:31], v[128:131], 0
    v_mfma_f32_16x16x32_bf16 v[124:127], v[28:31], v[132:135], 0
    v_mfma_f32_16x16x32_bf16 v[96:99], v[32:35], v[136:139], v[96:99]
    v_mfma_f32_16x16x32_bf16 v[100:103], v[32:35], v[140:143], v[100:103]
    v_mfma_f32_16x16x32_bf16 v[112:115], v[36:39], v[136:139], v[112:115]
    v_mfma_f32_16x16x32_bf16 v[116:119], v[36:39], v[140:143], v[116:119]
    v_mfma_f32_16x16x32_bf16 v[104:107], v[48:51], v[136:139], v[104:107]
    v_mfma_f32_16x16x32_bf16 v[108:111], v[48:51], v[140:143], v[108:111]
    v_mfma_f32_16x16x32_bf16 v[120:123], v[52:55], v[136:139], v[120:123]
    v_mfma_f32_16x16x32_bf16 v[124:127], v[52:55], v[140:143], v[124:127]
    v_add_u32 v12, 0x10000, v12
    v_add_u32 v13, 0x10000, v13
    v_add_u32 v46, 0x10000, v46
    v_add_u32 v6, 0x10000, v6
    v_add_u32 v7, 0x10000, v7
    s_waitcnt lgkmcnt(0)
    s_waitcnt vmcnt(4)
    s_barrier
    s_add_u32 m0, s56, 0
    s_add_u32 s54, s54, 128
    s_cmp_eq_u32 s33, 4
    s_cselect_b32 s52, 1024, 0
    s_sub_u32 s54, s54, s52
    buffer_load_dwordx4 v44, s[8:11], s54 offen lds
    s_add_u32 s55, s54, 14336
    buffer_load_dwordx4 v45, s[8:11], s54 offen offset:1024 lds
    buffer_load_dwordx4 v44, s[8:11], s55 offen offset:2048 lds
    buffer_load_dwordx4 v45, s[8:11], s55 offen offset:3072 lds
    ds_read_b128 v[160:163], v12 offset:0
    ds_read_b128 v[164:167], v12 offset:2048
    ds_read_b128 v[168:171], v13 offset:0
    ds_read_b128 v[172:175], v13 offset:2048
    ds_read_b64_tr_b16 v[16:17], v46 offset:16384
    ds_read_b64_tr_b16 v[18:19], v46 offset:16896
    ds_read_b64_tr_b16 v[20:21], v46 offset:24576
    ds_read_b64_tr_b16 v[22:23], v46 offset:25088
    ds_read_b64_tr_b16 v[24:25], v6 offset:16384
    ds_read_b64_tr_b16 v[26:27], v6 offset:16896
    ds_read_b64_tr_b16 v[28:29], v6 offset:24576
    ds_read_b64_tr_b16 v[30:31], v6 offset:25088
    v_dot2c_f32_bf16 v40, s71, v88
    v_dot2c_f32_bf16 v41, s71, v92
    v_dot2c_f32_bf16 v40, s71, v89
    v_dot2c_f32_bf16 v41, s71, v93
    v_dot2c_f32_bf16 v40, s71, v90
    v_dot2c_f32_bf16 v41, s71, v94
    v_dot2c_f32_bf16 v40, s71, v91
    v_dot2c_f32_bf16 v41, s71, v95
    v_mfma_f32_16x16x32_bf16 v[96:99], v[56:59], v[144:147], v[96:99]
    v_mfma_f32_16x16x32_bf16 v[100:103], v[56:59], v[148:151], v[100:103]
    ds_read_b64_tr_b16 v[32:33], v46 offset:20480
    ds_read_b64_tr_b16 v[34:35], v46 offset:20992
    ds_read_b64_tr_b16 v[36:37], v46 offset:28672
    ds_read_b64_tr_b16 v[38:39], v46 offset:29184
    v_mfma_f32_16x16x32_bf16 v[112:115], v[60:63], v[144:147], v[112:115]
    v_mfma_f32_16x16x32_bf16 v[116:119], v[60:63], v[148:151], v[116:119]
    ds_read_b64_tr_b16 v[48:49], v6 offset:20480
    ds_read_b64_tr_b16 v[50:51], v6 offset:20992
    ds_read_b64_tr_b16 v[52:53], v6 offset:28672
    ds_read_b64_tr_b16 v[54:55], v6 offset:29184
    v_mfma_f32_16x16x32_bf16 v[104:107], v[64:67], v[144:147], v[104:107]
    v_mfma_f32_16x16x32_bf16 v[108:111], v[64:67], v[148:151], v[108:111]
    ds_read_b64_tr_b16 v[88:89], v7 offset:16384
    ds_read_b64_tr_b16 v[90:91], v7 offset:16896
    ds_read_b64_tr_b16 v[92:93], v7 offset:24576
    ds_read_b64_tr_b16 v[94:95], v7 offset:25088
    v_mfma_f32_16x16x32_bf16 v[120:123], v[68:71], v[144:147], v[120:123]
    v_mfma_f32_16x16x32_bf16 v[124:127], v[68:71], v[148:151], v[124:127]
    v_mfma_f32_16x16x32_bf16 v[96:99], v[72:75], v[152:155], v[96:99]
    v_mfma_f32_16x16x32_bf16 v[100:103], v[72:75], v[156:159], v[100:103]
    v_mfma_f32_16x16x32_bf16 v[112:115], v[76:79], v[152:155], v[112:115]
    v_mfma_f32_16x16x32_bf16 v[116:119], v[76:79], v[156:159], v[116:119]
    v_mfma_f32_16x16x32_bf16 v[104:107], v[80:83], v[152:155], v[104:107]
    v_mfma_f32_16x16x32_bf16 v[108:111], v[80:83], v[156:159], v[108:111]
    v_mfma_f32_16x16x32_bf16 v[120:123], v[84:87], v[152:155], v[120:123]
    v_mfma_f32_16x16x32_bf16 v[124:127], v[84:87], v[156:159], v[124:127]
    s_waitcnt lgkmcnt(0)
    s_waitcnt vmcnt(4)
    s_barrier
    s_add_u32 m0, s56, 32768
    s_add_u32 s54, s54, 128
    buffer_load_dwordx4 v44, s[8:11], s54 offen lds
    s_add_u32 s55, s54, 14336
    buffer_load_dwordx4 v45, s[8:11], s54 offen offset:1024 lds
    buffer_load_dwordx4 v44, s[8:11], s55 offen offset:2048 lds
    buffer_load_dwordx4 v45, s[8:11], s55 offen offset:3072 lds
    ds_read_b128 v[176:179], v12 offset:32768
    ds_read_b128 v[180:183], v12 offset:34816
    ds_read_b128 v[184:187], v13 offset:32768
    ds_read_b128 v[188:191], v13 offset:34816
    ds_read_b64_tr_b16 v[56:57], v46 offset:49152
    ds_read_b64_tr_b16 v[58:59], v46 offset:49664
    ds_read_b64_tr_b16 v[60:61], v46 offset:57344
    ds_read_b64_tr_b16 v[62:63], v46 offset:57856
    ds_read_b64_tr_b16 v[64:65], v6 offset:49152
    ds_read_b64_tr_b16 v[66:67], v6 offset:49664
    ds_read_b64_tr_b16 v[68:69], v6 offset:57344
    ds_read_b64_tr_b16 v[70:71], v6 offset:57856
    v_dot2c_f32_bf16 v40, s71, v88
    v_dot2c_f32_bf16 v41, s71, v92
    v_dot2c_f32_bf16 v40, s71, v89
    v_dot2c_f32_bf16 v41, s71, v93
    v_dot2c_f32_bf16 v40, s71, v90
    v_dot2c_f32_bf16 v41, s71, v94
    v_dot2c_f32_bf16 v40, s71, v91
    v_dot2c_f32_bf16 v41, s71, v95
    v_mfma_f32_16x16x32_bf16 v[96:99], v[16:19], v[160:163], v[96:99]
    v_mfma_f32_16x16x32_bf16 v[100:103], v[16:19], v[164:167], v[100:103]
    ds_read_b64_tr_b16 v[72:73], v46 offset:53248
    ds_read_b64_tr_b16 v[74:75], v46 offset:53760
    ds_read_b64_tr_b16 v[76:77], v46 offset:61440
    ds_read_b64_tr_b16 v[78:79], v46 offset:61952
    v_mfma_f32_16x16x32_bf16 v[112:115], v[20:23], v[160:163], v[112:115]
    v_mfma_f32_16x16x32_bf16 v[116:119], v[20:23], v[164:167], v[116:119]
    ds_read_b64_tr_b16 v[80:81], v6 offset:53248
    ds_read_b64_tr_b16 v[82:83], v6 offset:53760
    ds_read_b64_tr_b16 v[84:85], v6 offset:61440
    ds_read_b64_tr_b16 v[86:87], v6 offset:61952
    v_mfma_f32_16x16x32_bf16 v[104:107], v[24:27], v[160:163], v[104:107]
    v_mfma_f32_16x16x32_bf16 v[108:111], v[24:27], v[164:167], v[108:111]
    ds_read_b64_tr_b16 v[88:89], v7 offset:49152
    ds_read_b64_tr_b16 v[90:91], v7 offset:49664
    ds_read_b64_tr_b16 v[92:93], v7 offset:57344
    ds_read_b64_tr_b16 v[94:95], v7 offset:57856
    v_mfma_f32_16x16x32_bf16 v[120:123], v[28:31], v[160:163], v[120:123]
    v_mfma_f32_16x16x32_bf16 v[124:127], v[28:31], v[164:167], v[124:127]
    v_mfma_f32_16x16x32_bf16 v[96:99], v[32:35], v[168:171], v[96:99]
    v_mfma_f32_16x16x32_bf16 v[100:103], v[32:35], v[172:175], v[100:103]
    v_mfma_f32_16x16x32_bf16 v[112:115], v[36:39], v[168:171], v[112:115]
    v_mfma_f32_16x16x32_bf16 v[116:119], v[36:39], v[172:175], v[116:119]
    v_mfma_f32_16x16x32_bf16 v[104:107], v[48:51], v[168:171], v[104:107]
    v_mfma_f32_16x16x32_bf16 v[108:111], v[48:51], v[172:175], v[108:111]
    v_mfma_f32_16x16x32_bf16 v[120:123], v[52:55], v[168:171], v[120:123]
    v_mfma_f32_16x16x32_bf16 v[124:127], v[52:55], v[172:175], v[124:127]
    v_add_u32 v12, 0xffff0000, v12
    v_add_u32 v13, 0xffff0000, v13
    v_add_u32 v46, 0xffff0000, v46
    v_add_u32 v6, 0xffff0000, v6
    v_add_u32 v7, 0xffff0000, v7
    s_waitcnt lgkmcnt(0)
    s_waitcnt vmcnt(4)
    s_barrier
    s_add_u32 m0, s56, 65536
    s_add_u32 s54, s54, 128
    s_cmp_eq_u32 s33, 2
    s_cselect_b32 s52, 1024, 0
    s_sub_u32 s54, s54, s52
    buffer_load_dwordx4 v44, s[8:11], s54 offen lds
    s_add_u32 s55, s54, 14336
    buffer_load_dwordx4 v45, s[8:11], s54 offen offset:1024 lds
    buffer_load_dwordx4 v44, s[8:11], s55 offen offset:2048 lds
    buffer_load_dwordx4 v45, s[8:11], s55 offen offset:3072 lds
    ds_read_b128 v[192:195], v12 offset:0
    ds_read_b128 v[196:199], v12 offset:2048
    ds_read_b128 v[200:203], v13 offset:0
    ds_read_b128 v[204:207], v13 offset:2048
    ds_read_b64_tr_b16 v[16:17], v46 offset:16384
    ds_read_b64_tr_b16 v[18:19], v46 offset:16896
    ds_read_b64_tr_b16 v[20:21], v46 offset:24576
    ds_read_b64_tr_b16 v[22:23], v46 offset:25088
    ds_read_b64_tr_b16 v[24:25], v6 offset:16384
    ds_read_b64_tr_b16 v[26:27], v6 offset:16896
    ds_read_b64_tr_b16 v[28:29], v6 offset:24576
    ds_read_b64_tr_b16 v[30:31], v6 offset:25088
    v_dot2c_f32_bf16 v40, s71, v88
    v_dot2c_f32_bf16 v41, s71, v92
    v_dot2c_f32_bf16 v40, s71, v89
    v_dot2c_f32_bf16 v41, s71, v93
    v_dot2c_f32_bf16 v40, s71, v90
    v_dot2c_f32_bf16 v41, s71, v94
    v_dot2c_f32_bf16 v40, s71, v91
    v_dot2c_f32_bf16 v41, s71, v95
    v_mfma_f32_16x16x32_bf16 v[96:99], v[56:59], v[176:179], v[96:99]
    v_mfma_f32_16x16x32_bf16 v[100:103], v[56:59], v[180:183], v[100:103]
    ds_read_b64_tr_b16 v[32:33], v46 offset:20480
    ds_read_b64_tr_b16 v[34:35], v46 offset:20992
    ds_read_b64_tr_b16 v[36:37], v46 offset:28672
    ds_read_b64_tr_b16 v[38:39], v46 offset:29184
    v_mfma_f32_16x16x32_bf16 v[112:115], v[60:63], v[176:179], v[112:115]
    v_mfma_f32_16x16x32_bf16 v[116:119], v[60:63], v[180:183], v[116:119]
    ds_read_b64_tr_b16 v[48:49], v6 offset:20480
    ds_read_b64_tr_b16 v[50:51], v6 offset:20992
    ds_read_b64_tr_b16 v[52:53], v6 offset:28672
    ds_read_b64_tr_b16 v[54:55], v6 offset:29184
    v_mfma_f32_16x16x32_bf16 v[104:107], v[64:67], v[176:179], v[104:107]
    v_mfma_f32_16x16x32_bf16 v[108:111], v[64:67], v[180:183], v[108:111]
    ds_read_b64_tr_b16 v[88:89], v7 offset:16384
    ds_read_b64_tr_b16 v[90:91], v7 offset:16896
    ds_read_b64_tr_b16 v[92:93], v7 offset:24576
    ds_read_b64_tr_b16 v[94:95], v7 offset:25088
    v_mfma_f32_16x16x32_bf16 v[120:123], v[68:71], v[176:179], v[120:123]
    v_mfma_f32_16x16x32_bf16 v[124:127], v[68:71], v[180:183], v[124:127]
    v_mfma_f32_16x16x32_bf16 v[96:99], v[72:75], v[184:187], v[96:99]
    v_mfma_f32_16x16x32_bf16 v[100:103], v[72:75], v[188:191], v[100:103]
    v_mfma_f32_16x16x32_bf16 v[112:115], v[76:79], v[184:187], v[112:115]
    v_mfma_f32_16x16x32_bf16 v[116:119], v[76:79], v[188:191], v[116:119]
    v_mfma_f32_16x16x32_bf16 v[104:107], v[80:83], v[184:187], v[104:107]
    v_mfma_f32_16x16x32_bf16 v[108:111], v[80:83], v[188:191], v[108:111]
    v_mfma_f32_16x16x32_bf16 v[120:123], v[84:87], v[184:187], v[120:123]
    v_mfma_f32_16x16x32_bf16 v[124:127], v[84:87], v[188:191], v[124:127]
    s_waitcnt lgkmcnt(0)
    s_waitcnt vmcnt(4)
    s_barrier
    s_load_dwordx2 s[48:49], s[44:45], 0
    s_add_u32 m0, s56, 98304
    s_add_u32 s54, s54, 128
    buffer_load_dwordx4 v44, s[8:11], s54 offen lds
    s_add_u32 s55, s54, 14336
    buffer_load_dwordx4 v45, s[8:11], s54 offen offset:1024 lds
    buffer_load_dwordx4 v44, s[8:11], s55 offen offset:2048 lds
    buffer_load_dwordx4 v45, s[8:11], s55 offen offset:3072 lds
    ds_read_b128 v[208:211], v12 offset:32768
    ds_read_b128 v[212:215], v12 offset:34816
    ds_read_b128 v[216:219], v13 offset:32768
    ds_read_b128 v[220:223], v13 offset:34816
    ds_read_b64_tr_b16 v[56:57], v46 offset:49152
    ds_read_b64_tr_b16 v[58:59], v46 offset:49664
    ds_read_b64_tr_b16 v[60:61], v46 offset:57344
    ds_read_b64_tr_b16 v[62:63], v46 offset:57856
    ds_read_b64_tr_b16 v[64:65], v6 offset:49152
    ds_read_b64_tr_b16 v[66:67], v6 offset:49664
    ds_read_b64_tr_b16 v[68:69], v6 offset:57344
    ds_read_b64_tr_b16 v[70:71], v6 offset:57856
    v_dot2c_f32_bf16 v40, s71, v88
    v_dot2c_f32_bf16 v41, s71, v92
    v_dot2c_f32_bf16 v40, s71, v89
    v_dot2c_f32_bf16 v41, s71, v93
    v_dot2c_f32_bf16 v40, s71, v90
    v_dot2c_f32_bf16 v41, s71, v94
    v_dot2c_f32_bf16 v40, s71, v91
    v_dot2c_f32_bf16 v41, s71, v95
    v_mfma_f32_16x16x32_bf16 v[96:99], v[16:19], v[192:195], v[96:99]
    v_mfma_f32_16x16x32_bf16 v[100:103], v[16:19], v[196:199], v[100:103]
    ds_read_b64_tr_b16 v[72:73], v46 offset:53248
    ds_read_b64_tr_b16 v[74:75], v46 offset:53760
    ds_read_b64_tr_b16 v[76:77], v46 offset:61440
    ds_read_b64_tr_b16 v[78:79], v46 offset:61952
    v_mfma_f32_16x16x32_bf16 v[112:115], v[20:23], v[192:195], v[112:115]
    v_mfma_f32_16x16x32_bf16 v[116:119], v[20:23], v[196:199], v[116:119]
    ds_read_b64_tr_b16 v[80:81], v6 offset:53248
    ds_read_b64_tr_b16 v[82:83], v6 offset:53760
    ds_read_b64_tr_b16 v[84:85], v6 offset:61440
    ds_read_b64_tr_b16 v[86:87], v6 offset:61952
    v_mfma_f32_16x16x32_bf16 v[104:107], v[24:27], v[192:195], v[104:107]
    v_mfma_f32_16x16x32_bf16 v[108:111], v[24:27], v[196:199], v[108:111]
    ds_read_b64_tr_b16 v[88:89], v7 offset:49152
    ds_read_b64_tr_b16 v[90:91], v7 offset:49664
    ds_read_b64_tr_b16 v[92:93], v7 offset:57344
    ds_read_b64_tr_b16 v[94:95], v7 offset:57856
    v_mfma_f32_16x16x32_bf16 v[120:123], v[28:31], v[192:195], v[120:123]
    v_mfma_f32_16x16x32_bf16 v[124:127], v[28:31], v[196:199], v[124:127]
    v_mfma_f32_16x16x32_bf16 v[96:99], v[32:35], v[200:203], v[96:99]
    v_mfma_f32_16x16x32_bf16 v[100:103], v[32:35], v[204:207], v[100:103]
    v_mfma_f32_16x16x32_bf16 v[112:115], v[36:39], v[200:203], v[112:115]
    v_mfma_f32_16x16x32_bf16 v[116:119], v[36:39], v[204:207], v[116:119]
    v_mfma_f32_16x16x32_bf16 v[104:107], v[48:51], v[200:203], v[104:107]
    v_mfma_f32_16x16x32_bf16 v[108:111], v[48:51], v[204:207], v[108:111]
    v_mfma_f32_16x16x32_bf16 v[120:123], v[52:55], v[200:203], v[120:123]
    v_mfma_f32_16x16x32_bf16 v[124:127], v[52:55], v[204:207], v[124:127]
    v_add_u32 v12, 0x10000, v12
    v_add_u32 v13, 0x10000, v13
    v_add_u32 v46, 0x10000, v46
    v_add_u32 v6, 0x10000, v6
    v_add_u32 v7, 0x10000, v7
    s_waitcnt lgkmcnt(0)
    s_waitcnt vmcnt(4)
    s_barrier
    s_add_u32 m0, s59, 0
    s_nop 0
    buffer_load_dwordx4 v8, s[20:23], s58 offen offset:0 lds
    s_add_u32 m0, s59, 8192
    s_nop 0
    buffer_load_dwordx4 v8, s[24:27], s58 offen offset:0 lds
    s_add_u32 m0, s59, 16256
    s_nop 0
    buffer_load_dwordx4 v8, s[20:23], s58 offen offset:128 lds
    s_add_u32 m0, s59, 24448
    s_nop 0
    buffer_load_dwordx4 v8, s[24:27], s58 offen offset:128 lds
    ds_read_b128 v[224:227], v12 offset:0
    ds_read_b128 v[228:231], v12 offset:2048
    ds_read_b128 v[232:235], v13 offset:0
    ds_read_b128 v[236:239], v13 offset:2048
    ds_read_b64_tr_b16 v[16:17], v46 offset:16384
    ds_read_b64_tr_b16 v[18:19], v46 offset:16896
    ds_read_b64_tr_b16 v[20:21], v46 offset:24576
    ds_read_b64_tr_b16 v[22:23], v46 offset:25088
    ds_read_b64_tr_b16 v[24:25], v6 offset:16384
    ds_read_b64_tr_b16 v[26:27], v6 offset:16896
    ds_read_b64_tr_b16 v[28:29], v6 offset:24576
    ds_read_b64_tr_b16 v[30:31], v6 offset:25088
    v_dot2c_f32_bf16 v40, s71, v88
    v_dot2c_f32_bf16 v41, s71, v92
    v_dot2c_f32_bf16 v40, s71, v89
    v_dot2c_f32_bf16 v41, s71, v93
    v_dot2c_f32_bf16 v40, s71, v90
    v_dot2c_f32_bf16 v41, s71, v94
    v_dot2c_f32_bf16 v40, s71, v91
    v_dot2c_f32_bf16 v41, s71, v95
    v_mfma_f32_16x16x32_bf16 v[96:99], v[56:59], v[208:211], v[96:99]
    v_mfma_f32_16x16x32_bf16 v[100:103], v[56:59], v[212:215], v[100:103]
    ds_read_b64_tr_b16 v[32:33], v46 offset:20480
    ds_read_b64_tr_b16 v[34:35], v46 offset:20992
    ds_read_b64_tr_b16 v[36:37], v46 offset:28672
    ds_read_b64_tr_b16 v[38:39], v46 offset:29184
    v_mfma_f32_16x16x32_bf16 v[112:115], v[60:63], v[208:211], v[112:115]
    v_mfma_f32_16x16x32_bf16 v[116:119], v[60:63], v[212:215], v[116:119]
    ds_read_b64_tr_b16 v[48:49], v6 offset:20480
    ds_read_b64_tr_b16 v[50:51], v6 offset:20992
    ds_read_b64_tr_b16 v[52:53], v6 offset:28672
    ds_read_b64_tr_b16 v[54:55], v6 offset:29184
    v_mfma_f32_16x16x32_bf16 v[104:107], v[64:67], v[208:211], v[104:107]
    v_mfma_f32_16x16x32_bf16 v[108:111], v[64:67], v[212:215], v[108:111]
    ds_read_b64_tr_b16 v[88:89], v7 offset:16384
    ds_read_b64_tr_b16 v[90:91], v7 offset:16896
    ds_read_b64_tr_b16 v[92:93], v7 offset:24576
    ds_read_b64_tr_b16 v[94:95], v7 offset:25088
    v_mfma_f32_16x16x32_bf16 v[120:123], v[68:71], v[208:211], v[120:123]
    v_mfma_f32_16x16x32_bf16 v[124:127], v[68:71], v[212:215], v[124:127]
    v_mfma_f32_16x16x32_bf16 v[96:99], v[72:75], v[216:219], v[96:99]
    v_mfma_f32_16x16x32_bf16 v[100:103], v[72:75], v[220:223], v[100:103]
    v_mfma_f32_16x16x32_bf16 v[112:115], v[76:79], v[216:219], v[112:115]
    v_mfma_f32_16x16x32_bf16 v[116:119], v[76:79], v[220:223], v[116:119]
    v_mfma_f32_16x16x32_bf16 v[104:107], v[80:83], v[216:219], v[104:107]
    v_mfma_f32_16x16x32_bf16 v[108:111], v[80:83], v[220:223], v[108:111]
    v_mfma_f32_16x16x32_bf16 v[120:123], v[84:87], v[216:219], v[120:123]
    v_mfma_f32_16x16x32_bf16 v[124:127], v[84:87], v[220:223], v[124:127]
    s_waitcnt lgkmcnt(0)
    s_waitcnt vmcnt(4)
    s_barrier
    s_add_u32 m0, s59, 32768
    s_add_u32 s58, s58, 229376
    buffer_load_dwordx4 v8, s[20:23], s58 offen offset:0 lds
    s_add_u32 m0, s59, 40960
    s_nop 0
    buffer_load_dwordx4 v8, s[24:27], s58 offen offset:0 lds
    s_add_u32 m0, s59, 49024
    s_nop 0
    buffer_load_dwordx4 v8, s[20:23], s58 offen offset:128 lds
    s_add_u32 m0, s59, 57216
    s_nop 0
    buffer_load_dwordx4 v8, s[24:27], s58 offen offset:128 lds
    ds_read_b128 v[240:243], v12 offset:32768
    ds_read_b128 v[244:247], v12 offset:34816
    ds_read_b128 v[248:251], v13 offset:32768
    ds_read_b128 v[252:255], v13 offset:34816
    ds_read_b64_tr_b16 v[56:57], v46 offset:49152
    ds_read_b64_tr_b16 v[58:59], v46 offset:49664
    ds_read_b64_tr_b16 v[60:61], v46 offset:57344
    ds_read_b64_tr_b16 v[62:63], v46 offset:57856
    ds_read_b64_tr_b16 v[64:65], v6 offset:49152
    ds_read_b64_tr_b16 v[66:67], v6 offset:49664
    ds_read_b64_tr_b16 v[68:69], v6 offset:57344
    ds_read_b64_tr_b16 v[70:71], v6 offset:57856
    v_dot2c_f32_bf16 v40, s71, v88
    v_dot2c_f32_bf16 v41, s71, v92
    v_dot2c_f32_bf16 v40, s71, v89
    v_dot2c_f32_bf16 v41, s71, v93
    v_dot2c_f32_bf16 v40, s71, v90
    v_dot2c_f32_bf16 v41, s71, v94
    v_dot2c_f32_bf16 v40, s71, v91
    v_dot2c_f32_bf16 v41, s71, v95
    v_mfma_f32_16x16x32_bf16 v[96:99], v[16:19], v[224:227], v[96:99]
    v_mfma_f32_16x16x32_bf16 v[100:103], v[16:19], v[228:231], v[100:103]
    ds_read_b64_tr_b16 v[72:73], v46 offset:53248
    ds_read_b64_tr_b16 v[74:75], v46 offset:53760
    ds_read_b64_tr_b16 v[76:77], v46 offset:61440
    ds_read_b64_tr_b16 v[78:79], v46 offset:61952
    v_mfma_f32_16x16x32_bf16 v[112:115], v[20:23], v[224:227], v[112:115]
    v_mfma_f32_16x16x32_bf16 v[116:119], v[20:23], v[228:231], v[116:119]
    ds_read_b64_tr_b16 v[80:81], v6 offset:53248
    ds_read_b64_tr_b16 v[82:83], v6 offset:53760
    ds_read_b64_tr_b16 v[84:85], v6 offset:61440
    ds_read_b64_tr_b16 v[86:87], v6 offset:61952
    v_mfma_f32_16x16x32_bf16 v[104:107], v[24:27], v[224:227], v[104:107]
    v_mfma_f32_16x16x32_bf16 v[108:111], v[24:27], v[228:231], v[108:111]
    ds_read_b64_tr_b16 v[88:89], v7 offset:49152
    ds_read_b64_tr_b16 v[90:91], v7 offset:49664
    ds_read_b64_tr_b16 v[92:93], v7 offset:57344
    ds_read_b64_tr_b16 v[94:95], v7 offset:57856
    v_mfma_f32_16x16x32_bf16 v[120:123], v[28:31], v[224:227], v[120:123]
    v_mfma_f32_16x16x32_bf16 v[124:127], v[28:31], v[228:231], v[124:127]
    v_mfma_f32_16x16x32_bf16 v[96:99], v[32:35], v[232:235], v[96:99]
    v_mfma_f32_16x16x32_bf16 v[100:103], v[32:35], v[236:239], v[100:103]
    v_mfma_f32_16x16x32_bf16 v[112:115], v[36:39], v[232:235], v[112:115]
    v_mfma_f32_16x16x32_bf16 v[116:119], v[36:39], v[236:239], v[116:119]
    v_mfma_f32_16x16x32_bf16 v[104:107], v[48:51], v[232:235], v[104:107]
    v_mfma_f32_16x16x32_bf16 v[108:111], v[48:51], v[236:239], v[108:111]
    v_mfma_f32_16x16x32_bf16 v[120:123], v[52:55], v[232:235], v[120:123]
    v_mfma_f32_16x16x32_bf16 v[124:127], v[52:55], v[236:239], v[124:127]
    s_cmp_lg_u32 s48, 0
    s_cbranch_scc1 L_tokAR_x
    s_mov_b32 s50, 131072
L_tokAR:
    buffer_load_dwordx2 v[44:45], off, s[44:47], 0 sc1
    s_waitcnt vmcnt(0)
    v_readfirstlane_b32 s48, v44
    v_readfirstlane_b32 s49, v45
    s_sub_u32 s50, s50, 1
    s_cbranch_scc1 L_tokAR_x
    s_cmp_eq_u32 s48, 0
    s_cbranch_scc1 L_tokAR
L_tokAR_x:
    s_waitcnt lgkmcnt(0)
    v_dot2c_f32_bf16 v40, s71, v88
    v_dot2c_f32_bf16 v41, s71, v92
    v_dot2c_f32_bf16 v40, s71, v89
    v_dot2c_f32_bf16 v41, s71, v93
    v_dot2c_f32_bf16 v40, s71, v90
    v_dot2c_f32_bf16 v41, s71, v94
    v_dot2c_f32_bf16 v40, s71, v91
    v_dot2c_f32_bf16 v41, s71, v95
    s_lshl_b32 s52, s32, 2
    s_add_u32 s52, s52, 151552
    v_add_u32 v4, s52, v1
    v_cvt_pk_bf16_f32 v3, v40, v40
    v_lshlrev_b32 v3, 16, v3
    v_sub_f32 v5, v40, v3
    v_cvt_pk_bf16_f32 v3, v3, v5
    ds_write_b32 v4, v3 offset:0
    v_cvt_pk_bf16_f32 v3, v41, v41
    v_lshlrev_b32 v3, 16, v3
    v_sub_f32 v5, v41, v3
    v_cvt_pk_bf16_f32 v3, v3, v5
    ds_write_b32 v4, v3 offset:1024
    s_waitcnt lgkmcnt(0)
    s_waitcnt vmcnt(4)
    s_barrier
    s_setprio 0
    v_mfma_f32_16x16x32_bf16 v[96:99], v[56:59], v[240:243], v[96:99]
    v_mfma_f32_16x16x32_bf16 v[100:103], v[56:59], v[244:247], v[100:103]
    s_lshl_b32 s52, s32, 9
    s_add_u32 s52, s52, 159744
    v_bfe_u32 v3, v1, 4, 4
    v_lshl_add_u32 v3, v3, 3, s52
    ds_read_b64 v[12:13], v3
    ds_read_b64 v[14:15], v3 offset:128
    v_add_u32 v4, 151552, v1
    ds_read_b128 v[28:31], v4 offset:0
    ds_read_b128 v[32:35], v4 offset:1024
    v_mfma_f32_16x16x32_bf16 v[112:115], v[60:63], v[240:243], v[112:115]
    v_mfma_f32_16x16x32_bf16 v[116:119], v[60:63], v[244:247], v[116:119]
    ds_read_b64_tr_b16 v[16:17], v9 offset:0
    ds_read_b64_tr_b16 v[18:19], v9 offset:512
    ds_read_b64_tr_b16 v[20:21], v10 offset:0
    ds_read_b64_tr_b16 v[22:23], v10 offset:512
    ds_read_b64_tr_b16 v[24:25], v11 offset:0
    ds_read_b64_tr_b16 v[26:27], v11 offset:512
    v_mfma_f32_16x16x32_bf16 v[104:107], v[64:67], v[240:243], v[104:107]
    v_mfma_f32_16x16x32_bf16 v[108:111], v[64:67], v[244:247], v[108:111]
    s_waitcnt lgkmcnt(8)
    v_mov_b32 v88, 0
    v_mov_b32 v89, 0
    v_mov_b32 v90, v12
    v_mov_b32 v91, v12
    v_mov_b32 v92, 0
    v_mov_b32 v93, 0
    v_mov_b32 v48, 0
    v_mov_b32 v49, 0
    v_mov_b32 v50, v14
    v_mov_b32 v51, v14
    v_mov_b32 v52, 0
    v_mov_b32 v53, 0
    v_mul_f32 v44, 0x3eb8aa3b, v13
    v_mul_f32 v45, 0x3eb8aa3b, v15
    v_mov_b32 v6, s48
    v_mov_b32 v7, s49
    v_mfma_f32_16x16x32_bf16 v[120:123], v[68:71], v[240:243], v[120:123]
    v_mfma_f32_16x16x32_bf16 v[124:127], v[68:71], v[244:247], v[124:127]
    v_mfma_f32_16x16x32_bf16 v[96:99], v[72:75], v[248:251], v[96:99]
    v_mfma_f32_16x16x32_bf16 v[100:103], v[72:75], v[252:255], v[100:103]
    v_mfma_f32_16x16x32_bf16 v[112:115], v[76:79], v[248:251], v[112:115]
    v_mfma_f32_16x16x32_bf16 v[116:119], v[76:79], v[252:255], v[116:119]
    v_mfma_f32_16x16x32_bf16 v[104:107], v[80:83], v[248:251], v[104:107]
    v_mfma_f32_16x16x32_bf16 v[108:111], v[80:83], v[252:255], v[108:111]
    v_mfma_f32_16x16x32_bf16 v[120:123], v[84:87], v[248:251], v[120:123]
    v_mfma_f32_16x16x32_bf16 v[124:127], v[84:87], v[252:255], v[124:127]
    s_waitcnt lgkmcnt(7)
    v_mfma_f32_16x16x32_bf16 v[96:99], v[28:31], v[90:93], v[96:99]
    v_mfma_f32_16x16x32_bf16 v[100:103], v[28:31], v[50:53], v[100:103]
    v_mfma_f32_16x16x32_bf16 v[104:107], v[28:31], v[88:91], v[104:107]
    v_mfma_f32_16x16x32_bf16 v[108:111], v[28:31], v[48:51], v[108:111]
    s_waitcnt lgkmcnt(6)
    v_mfma_f32_16x16x32_bf16 v[112:115], v[32:35], v[90:93], v[112:115]
    v_mfma_f32_16x16x32_bf16 v[116:119], v[32:35], v[50:53], v[116:119]
    v_mfma_f32_16x16x32_bf16 v[120:123], v[32:35], v[88:91], v[120:123]
    v_mfma_f32_16x16x32_bf16 v[124:127], v[32:35], v[48:51], v[124:127]
    s_add_u32 m0, s59, 65536
    s_add_u32 s58, s58, 229376
    s_cmp_eq_u32 s33, 6
    s_cselect_b32 s52, 1835008, 0
    s_sub_u32 s58, s58, s52
    buffer_load_dwordx4 v8, s[20:23], s58 offen offset:0 lds
    s_add_u32 m0, s59, 73728
    s_nop 0
    buffer_load_dwordx4 v8, s[24:27], s58 offen offset:0 lds
    s_add_u32 m0, s59, 81792
    s_nop 0
    buffer_load_dwordx4 v8, s[20:23], s58 offen offset:128 lds
    s_add_u32 m0, s59, 89984
    s_nop 0
    buffer_load_dwordx4 v8, s[24:27], s58 offen offset:128 lds
    v_lshrrev_b32 v46, 1, v1
    v_xor_b32 v46, v46, v1
    v_and_b32 v46, 0x100, v46
    v_mul_u32_u24 v46, 3, v46
    v_xor_b32 v46, v46, v1
    v_lshrrev_b32 v5, 1, v1
    v_xor_b32 v5, v5, v1
    v_and_b32 v5, 64, v5
    v_mul_u32_u24 v5, 3, v5
    v_xor_b32 v5, v5, v46
    v_mul_f32 v112, v13, v112
    v_mul_f32 v113, v13, v113
    v_mul_f32 v114, v13, v114
    v_mul_f32 v115, v13, v115
    v_mul_f32 v116, v15, v116
    v_mul_f32 v117, v15, v117
    v_mul_f32 v118, v15, v118
    v_mul_f32 v119, v15, v119
    v_mul_f32 v120, v13, v120
    v_mul_f32 v121, v13, v121
    v_mul_f32 v122, v13, v122
    v_mul_f32 v123, v13, v123
    v_mul_f32 v124, v15, v124
    v_mul_f32 v125, v15, v125
    v_mul_f32 v126, v15, v126
    v_mul_f32 v127, v15, v127
    v_cvt_pk_bf16_f32 v112, v112, v113
    v_cvt_pk_bf16_f32 v113, v114, v115
    v_cvt_pk_bf16_f32 v114, v116, v117
    v_cvt_pk_bf16_f32 v115, v118, v119
    v_cvt_pk_bf16_f32 v116, v120, v121
    v_cvt_pk_bf16_f32 v117, v122, v123
    v_cvt_pk_bf16_f32 v118, v124, v125
    v_cvt_pk_bf16_f32 v119, v126, v127
    v_permlane32_swap_b32 v112, v114
    v_permlane32_swap_b32 v113, v115
    v_permlane32_swap_b32 v116, v118
    v_permlane32_swap_b32 v117, v119
    s_add_u32 s52, s74, 2097152
    s_add_u32 s53, s74, 2162688
    buffer_store_dwordx4 v[112:115], v5, s[16:19], s52 offen sc1
    buffer_store_dwordx4 v[116:119], v5, s[16:19], s53 offen sc1
    s_waitcnt lgkmcnt(4)
    v_mfma_f32_16x16x32_bf16 v[48:51], v[16:19], v[128:131], 0
    ds_read_b64_tr_b16 v[28:29], v9 offset:8192
    v_mfma_f32_16x16x32_bf16 v[52:55], v[16:19], v[132:135], 0
    ds_read_b64_tr_b16 v[30:31], v9 offset:8704
    v_mul_f32 v96, v44, v96
    v_mul_f32 v97, v44, v97
    v_mul_f32 v98, v44, v98
    v_mul_f32 v99, v44, v99
    s_waitcnt lgkmcnt(4)
    v_mfma_f32_16x16x32_bf16 v[64:67], v[20:23], v[128:131], 0
    ds_read_b64_tr_b16 v[32:33], v10 offset:8192
    v_mfma_f32_16x16x32_bf16 v[68:71], v[20:23], v[132:135], 0
    ds_read_b64_tr_b16 v[34:35], v10 offset:8704
    v_mul_f32 v100, v45, v100
    v_mul_f32 v101, v45, v101
    v_mul_f32 v102, v45, v102
    v_mul_f32 v103, v45, v103
    s_waitcnt lgkmcnt(4)
    v_mfma_f32_16x16x32_bf16 v[80:83], v[24:27], v[128:131], 0
    ds_read_b64_tr_b16 v[36:37], v11 offset:8192
    v_mfma_f32_16x16x32_bf16 v[84:87], v[24:27], v[132:135], 0
    ds_read_b64_tr_b16 v[38:39], v11 offset:8704
    v_mul_f32 v104, v44, v104
    v_mul_f32 v105, v44, v105
    v_mul_f32 v106, v44, v106
    v_mul_f32 v107, v44, v107
    s_waitcnt lgkmcnt(4)
    v_mfma_f32_16x16x32_bf16 v[56:59], v[28:31], v[128:131], 0
    ds_read_b64_tr_b16 v[16:17], v9 offset:4096
    v_mfma_f32_16x16x32_bf16 v[60:63], v[28:31], v[132:135], 0
    ds_read_b64_tr_b16 v[18:19], v9 offset:4608
    v_mul_f32 v108, v45, v108
    v_mul_f32 v109, v45, v109
    v_mul_f32 v110, v45, v110
    v_mul_f32 v111, v45, v111
    s_waitcnt lgkmcnt(4)
    v_mfma_f32_16x16x32_bf16 v[72:75], v[32:35], v[128:131], 0
    ds_read_b64_tr_b16 v[20:21], v10 offset:4096
    v_mfma_f32_16x16x32_bf16 v[76:79], v[32:35], v[132:135], 0
    ds_read_b64_tr_b16 v[22:23], v10 offset:4608
    v_cvt_pk_bf16_f32 v96, v96, v97
    v_cvt_pk_bf16_f32 v97, v98, v99
    v_cvt_pk_bf16_f32 v98, v100, v101
    v_cvt_pk_bf16_f32 v99, v102, v103
    s_waitcnt lgkmcnt(4)
    v_mfma_f32_16x16x32_bf16 v[88:91], v[36:39], v[128:131], 0
    ds_read_b64_tr_b16 v[24:25], v11 offset:4096
    v_mfma_f32_16x16x32_bf16 v[92:95], v[36:39], v[132:135], 0
    ds_read_b64_tr_b16 v[26:27], v11 offset:4608
    v_cvt_pk_bf16_f32 v100, v104, v105
    v_cvt_pk_bf16_f32 v101, v106, v107
    v_cvt_pk_bf16_f32 v102, v108, v109
    v_cvt_pk_bf16_f32 v103, v110, v111
    s_waitcnt lgkmcnt(4)
    v_mfma_f32_16x16x32_bf16 v[48:51], v[16:19], v[136:139], v[48:51]
    ds_read_b64_tr_b16 v[28:29], v9 offset:12288
    v_mfma_f32_16x16x32_bf16 v[52:55], v[16:19], v[140:143], v[52:55]
    ds_read_b64_tr_b16 v[30:31], v9 offset:12800
    v_permlane32_swap_b32 v96, v98
    v_permlane32_swap_b32 v97, v99
    v_permlane32_swap_b32 v100, v102
    v_permlane32_swap_b32 v101, v103
    s_waitcnt lgkmcnt(4)
    v_mfma_f32_16x16x32_bf16 v[64:67], v[20:23], v[136:139], v[64:67]
    ds_read_b64_tr_b16 v[32:33], v10 offset:12288
    v_mfma_f32_16x16x32_bf16 v[68:71], v[20:23], v[140:143], v[68:71]
    ds_read_b64_tr_b16 v[34:35], v10 offset:12800
    s_add_u32 s52, s74, 0
    s_add_u32 s53, s74, 65536
    buffer_store_dwordx4 v[96:99], v46, s[16:19], s52 offen sc1
    buffer_store_dwordx4 v[100:103], v46, s[16:19], s53 offen sc1
    s_waitcnt lgkmcnt(4)
    v_mfma_f32_16x16x32_bf16 v[80:83], v[24:27], v[136:139], v[80:83]
    ds_read_b64_tr_b16 v[36:37], v11 offset:12288
    v_mfma_f32_16x16x32_bf16 v[84:87], v[24:27], v[140:143], v[84:87]
    ds_read_b64_tr_b16 v[38:39], v11 offset:12800
    s_waitcnt vmcnt(8)
    s_barrier
    s_add_u32 m0, s59, 98304
    s_add_u32 s58, s58, 229376
    buffer_load_dwordx4 v8, s[20:23], s58 offen offset:0 lds
    s_add_u32 m0, s59, 106496
    s_nop 0
    buffer_load_dwordx4 v8, s[24:27], s58 offen offset:0 lds
    s_add_u32 m0, s59, 114560
    s_nop 0
    buffer_load_dwordx4 v8, s[20:23], s58 offen offset:128 lds
    s_add_u32 m0, s59, 122752
    s_nop 0
    buffer_load_dwordx4 v8, s[24:27], s58 offen offset:128 lds
    s_cmp_lg_u32 s32, 0
    s_cbranch_scc1 L_ncsAR
    v_mov_b32 v40, 0
    v_mov_b32 v44, 0
    v_mov_b32 v41, 0
    v_mov_b32 v45, 0
    v_mov_b32 v42, 0
    v_mov_b32 v4, 0
    v_add_u32 v3, s60, v9
    ds_read_b64_tr_b16 v[128:129], v3 offset:0
    ds_read_b64_tr_b16 v[130:131], v3 offset:512
    ds_read_b64_tr_b16 v[132:133], v3 offset:8192
    ds_read_b64_tr_b16 v[134:135], v3 offset:8704
    v_add_u32 v3, s60, v10
    ds_read_b64_tr_b16 v[120:121], v3 offset:0
    ds_read_b64_tr_b16 v[122:123], v3 offset:512
    ds_read_b64_tr_b16 v[124:125], v3 offset:8192
    ds_read_b64_tr_b16 v[126:127], v3 offset:8704
    s_waitcnt lgkmcnt(0)
    v_dot2c_f32_bf16 v40, s71, v128
    v_dot2c_f32_bf16 v40, s71, v129
    v_dot2c_f32_bf16 v40, s71, v130
    v_dot2c_f32_bf16 v40, s71, v131
    v_dot2c_f32_bf16 v44, s71, v132
    v_dot2c_f32_bf16 v44, s71, v133
    v_dot2c_f32_bf16 v44, s71, v134
    v_dot2c_f32_bf16 v44, s71, v135
    v_dot2c_f32_bf16 v41, s71, v120
    v_dot2c_f32_bf16 v41, s71, v121
    v_dot2c_f32_bf16 v41, s71, v122
    v_dot2c_f32_bf16 v41, s71, v123
    v_dot2c_f32_bf16 v45, s71, v124
    v_dot2c_f32_bf16 v45, s71, v125
    v_dot2c_f32_bf16 v45, s71, v126
    v_dot2c_f32_bf16 v45, s71, v127
    v_add_u32 v3, s60, v11
    ds_read_b64_tr_b16 v[128:129], v3 offset:0
    ds_read_b64_tr_b16 v[130:131], v3 offset:512
    ds_read_b64_tr_b16 v[132:133], v3 offset:8192
    ds_read_b64_tr_b16 v[134:135], v3 offset:8704
    s_waitcnt lgkmcnt(0)
    v_dot2c_f32_bf16 v42, s71, v128
    v_dot2c_f32_bf16 v42, s71, v129
    v_dot2c_f32_bf16 v42, s71, v130
    v_dot2c_f32_bf16 v42, s71, v131
    v_dot2c_f32_bf16 v4, s71, v132
    v_dot2c_f32_bf16 v4, s71, v133
    v_dot2c_f32_bf16 v4, s71, v134
    v_dot2c_f32_bf16 v4, s71, v135
    s_nop 2
    v_permlane32_swap_b32 v40, v44
    v_permlane32_swap_b32 v41, v45
    v_permlane32_swap_b32 v42, v4
    s_nop 0
    v_add_f32 v40, v40, v44
    v_add_f32 v41, v41, v45
    v_add_f32 v42, v42, v4
    v_mov_b32 v44, v40
    v_mov_b32 v45, v41
    v_mov_b32 v4, v42
    s_nop 1
    v_permlane16_swap_b32 v40, v44
    v_permlane16_swap_b32 v41, v45
    v_permlane16_swap_b32 v42, v4
    s_nop 0
    v_add_f32 v40, v40, v44
    v_add_f32 v41, v41, v45
    v_add_f32 v42, v42, v4
L_ncsAR:
    s_mov_b32 exec_lo, 0xffff
    s_mov_b32 exec_hi, 0xffff
    buffer_store_dwordx4 v[40:43], v46, s[16:19], s1 offen sc1
    s_mov_b64 exec, -1
    s_nop 0
    s_waitcnt lgkmcnt(4)
    v_mfma_f32_16x16x32_bf16 v[56:59], v[28:31], v[136:139], v[56:59]
    ds_read_b64_tr_b16 v[16:17], v9 offset:32768
    v_mfma_f32_16x16x32_bf16 v[60:63], v[28:31], v[140:143], v[60:63]
    ds_read_b64_tr_b16 v[18:19], v9 offset:33280
    s_waitcnt lgkmcnt(4)
    v_mfma_f32_16x16x32_bf16 v[72:75], v[32:35], v[136:139], v[72:75]
    ds_read_b64_tr_b16 v[20:21], v10 offset:32768
    v_mfma_f32_16x16x32_bf16 v[76:79], v[32:35], v[140:143], v[76:79]
    ds_read_b64_tr_b16 v[22:23], v10 offset:33280
    s_waitcnt lgkmcnt(4)
    v_mfma_f32_16x16x32_bf16 v[88:91], v[36:39], v[136:139], v[88:91]
    ds_read_b64_tr_b16 v[24:25], v11 offset:32768
    v_mfma_f32_16x16x32_bf16 v[92:95], v[36:39], v[140:143], v[92:95]
    ds_read_b64_tr_b16 v[26:27], v11 offset:33280
    s_waitcnt lgkmcnt(4)
    v_mfma_f32_16x16x32_bf16 v[48:51], v[16:19], v[144:147], v[48:51]
    ds_read_b64_tr_b16 v[28:29], v9 offset:40960
    v_mfma_f32_16x16x32_bf16 v[52:55], v[16:19], v[148:151], v[52:55]
    ds_read_b64_tr_b16 v[30:31], v9 offset:41472
    s_waitcnt lgkmcnt(4)
    v_mfma_f32_16x16x32_bf16 v[64:67], v[20:23], v[144:147], v[64:67]
    ds_read_b64_tr_b16 v[32:33], v10 offset:40960
    v_mfma_f32_16x16x32_bf16 v[68:71], v[20:23], v[148:151], v[68:71]
    ds_read_b64_tr_b16 v[34:35], v10 offset:41472
    s_waitcnt lgkmcnt(4)
    v_mfma_f32_16x16x32_bf16 v[80:83], v[24:27], v[144:147], v[80:83]
    ds_read_b64_tr_b16 v[36:37], v11 offset:40960
    v_mfma_f32_16x16x32_bf16 v[84:87], v[24:27], v[148:151], v[84:87]
    ds_read_b64_tr_b16 v[38:39], v11 offset:41472
    s_waitcnt lgkmcnt(4)
    v_mfma_f32_16x16x32_bf16 v[56:59], v[28:31], v[144:147], v[56:59]
    ds_read_b64_tr_b16 v[16:17], v9 offset:36864
    v_mfma_f32_16x16x32_bf16 v[60:63], v[28:31], v[148:151], v[60:63]
    ds_read_b64_tr_b16 v[18:19], v9 offset:37376
    s_waitcnt lgkmcnt(4)
    v_mfma_f32_16x16x32_bf16 v[72:75], v[32:35], v[144:147], v[72:75]
    ds_read_b64_tr_b16 v[20:21], v10 offset:36864
    v_mfma_f32_16x16x32_bf16 v[76:79], v[32:35], v[148:151], v[76:79]
    ds_read_b64_tr_b16 v[22:23], v10 offset:37376
    s_waitcnt lgkmcnt(4)
    v_mfma_f32_16x16x32_bf16 v[88:91], v[36:39], v[144:147], v[88:91]
    ds_read_b64_tr_b16 v[24:25], v11 offset:36864
    v_mfma_f32_16x16x32_bf16 v[92:95], v[36:39], v[148:151], v[92:95]
    ds_read_b64_tr_b16 v[26:27], v11 offset:37376
    s_waitcnt lgkmcnt(4)
    v_mfma_f32_16x16x32_bf16 v[48:51], v[16:19], v[152:155], v[48:51]
    ds_read_b64_tr_b16 v[28:29], v9 offset:45056
    v_mfma_f32_16x16x32_bf16 v[52:55], v[16:19], v[156:159], v[52:55]
    ds_read_b64_tr_b16 v[30:31], v9 offset:45568
    s_waitcnt lgkmcnt(4)
    v_mfma_f32_16x16x32_bf16 v[64:67], v[20:23], v[152:155], v[64:67]
    ds_read_b64_tr_b16 v[32:33], v10 offset:45056
    v_mfma_f32_16x16x32_bf16 v[68:71], v[20:23], v[156:159], v[68:71]
    ds_read_b64_tr_b16 v[34:35], v10 offset:45568
    s_waitcnt lgkmcnt(4)
    v_mfma_f32_16x16x32_bf16 v[80:83], v[24:27], v[152:155], v[80:83]
    ds_read_b64_tr_b16 v[36:37], v11 offset:45056
    v_mfma_f32_16x16x32_bf16 v[84:87], v[24:27], v[156:159], v[84:87]
    ds_read_b64_tr_b16 v[38:39], v11 offset:45568
    v_add_u32 v9, 0x10000, v9
    v_add_u32 v10, 0x10000, v10
    v_add_u32 v11, 0x10000, v11
    s_waitcnt vmcnt(9)
    s_waitcnt vmcnt(5)
    s_barrier
    s_cmp_lg_u32 s3, 0
    s_cbranch_scc1 L_w0_10AR
    s_mov_b64 exec, 1
    buffer_store_dwordx2 v[6:7], off, s[16:19], s57 sc1
    s_mov_b64 exec, -1
L_w0_10AR:
    s_add_u32 m0, s59, 0
    s_add_u32 s58, s58, 229376
    s_cmp_eq_u32 s33, 4
    s_cselect_b32 s52, 1835008, 0
    s_sub_u32 s58, s58, s52
    buffer_load_dwordx4 v8, s[20:23], s58 offen offset:0 lds
    s_add_u32 m0, s59, 8192
    s_nop 0
    buffer_load_dwordx4 v8, s[24:27], s58 offen offset:0 lds
    s_add_u32 m0, s59, 16256
    s_nop 0
    buffer_load_dwordx4 v8, s[20:23], s58 offen offset:128 lds
    s_add_u32 m0, s59, 24448
    s_nop 0
    buffer_load_dwordx4 v8, s[24:27], s58 offen offset:128 lds
    s_and_b32 s52, s4, 6
    s_add_u32 s52, s52, s4
    s_sub_u32 s53, s7, s52
    s_add_u32 s53, s53, 16
    s_lshl_b32 s53, s53, 11
    s_lshl_b32 s52, s52, 11
    s_add_u32 s52, s52, 17825792
    s_mov_b32 s64, -1
    s_mov_b32 s65, 0xffff
    v_and_b32 v142, 0xf0, v1
    v_lshl_add_u32 v142, v142, 3, s52
    v_bfe_u32 v3, v1, 8, 1
    v_lshl_add_u32 v142, v3, 12, v142
    v_lshrrev_b32 v3, 9, v1
    v_mad_u32_u24 v142, v3, s53, v142
    s_waitcnt lgkmcnt(4)
    v_mfma_f32_16x16x32_bf16 v[56:59], v[28:31], v[152:155], v[56:59]
    ds_read_b64_tr_b16 v[16:17], v9 offset:0
    v_mfma_f32_16x16x32_bf16 v[60:63], v[28:31], v[156:159], v[60:63]
    ds_read_b64_tr_b16 v[18:19], v9 offset:512
    s_waitcnt lgkmcnt(4)
    v_mfma_f32_16x16x32_bf16 v[72:75], v[32:35], v[152:155], v[72:75]
    ds_read_b64_tr_b16 v[20:21], v10 offset:0
    v_mfma_f32_16x16x32_bf16 v[76:79], v[32:35], v[156:159], v[76:79]
    ds_read_b64_tr_b16 v[22:23], v10 offset:512
    s_waitcnt lgkmcnt(4)
    v_mfma_f32_16x16x32_bf16 v[88:91], v[36:39], v[152:155], v[88:91]
    ds_read_b64_tr_b16 v[24:25], v11 offset:0
    v_mfma_f32_16x16x32_bf16 v[92:95], v[36:39], v[156:159], v[92:95]
    ds_read_b64_tr_b16 v[26:27], v11 offset:512
    s_waitcnt lgkmcnt(4)
    v_mfma_f32_16x16x32_bf16 v[48:51], v[16:19], v[160:163], v[48:51]
    ds_read_b64_tr_b16 v[28:29], v9 offset:8192
    v_mfma_f32_16x16x32_bf16 v[52:55], v[16:19], v[164:167], v[52:55]
    ds_read_b64_tr_b16 v[30:31], v9 offset:8704
    s_waitcnt lgkmcnt(4)
    v_mfma_f32_16x16x32_bf16 v[64:67], v[20:23], v[160:163], v[64:67]
    ds_read_b64_tr_b16 v[32:33], v10 offset:8192
    v_mfma_f32_16x16x32_bf16 v[68:71], v[20:23], v[164:167], v[68:71]
    ds_read_b64_tr_b16 v[34:35], v10 offset:8704
    s_waitcnt lgkmcnt(4)
    v_mfma_f32_16x16x32_bf16 v[80:83], v[24:27], v[160:163], v[80:83]
    ds_read_b64_tr_b16 v[36:37], v11 offset:8192
    v_mfma_f32_16x16x32_bf16 v[84:87], v[24:27], v[164:167], v[84:87]
    ds_read_b64_tr_b16 v[38:39], v11 offset:8704
    s_waitcnt lgkmcnt(4)
    v_mfma_f32_16x16x32_bf16 v[56:59], v[28:31], v[160:163], v[56:59]
    ds_read_b64_tr_b16 v[16:17], v9 offset:4096
    v_mfma_f32_16x16x32_bf16 v[60:63], v[28:31], v[164:167], v[60:63]
    ds_read_b64_tr_b16 v[18:19], v9 offset:4608
    s_waitcnt lgkmcnt(4)
    v_mfma_f32_16x16x32_bf16 v[72:75], v[32:35], v[160:163], v[72:75]
    ds_read_b64_tr_b16 v[20:21], v10 offset:4096
    v_mfma_f32_16x16x32_bf16 v[76:79], v[32:35], v[164:167], v[76:79]
    ds_read_b64_tr_b16 v[22:23], v10 offset:4608
    s_waitcnt lgkmcnt(4)
    v_mfma_f32_16x16x32_bf16 v[88:91], v[36:39], v[160:163], v[88:91]
    ds_read_b64_tr_b16 v[24:25], v11 offset:4096
    v_mfma_f32_16x16x32_bf16 v[92:95], v[36:39], v[164:167], v[92:95]
    ds_read_b64_tr_b16 v[26:27], v11 offset:4608
    s_waitcnt lgkmcnt(4)
    v_mfma_f32_16x16x32_bf16 v[48:51], v[16:19], v[168:171], v[48:51]
    ds_read_b64_tr_b16 v[28:29], v9 offset:12288
    v_mfma_f32_16x16x32_bf16 v[52:55], v[16:19], v[172:175], v[52:55]
    ds_read_b64_tr_b16 v[30:31], v9 offset:12800
    s_waitcnt lgkmcnt(4)
    v_mfma_f32_16x16x32_bf16 v[64:67], v[20:23], v[168:171], v[64:67]
    ds_read_b64_tr_b16 v[32:33], v10 offset:12288
    v_mfma_f32_16x16x32_bf16 v[68:71], v[20:23], v[172:175], v[68:71]
    ds_read_b64_tr_b16 v[34:35], v10 offset:12800
    s_waitcnt lgkmcnt(4)
    v_mfma_f32_16x16x32_bf16 v[80:83], v[24:27], v[168:171], v[80:83]
    ds_read_b64_tr_b16 v[36:37], v11 offset:12288
    v_mfma_f32_16x16x32_bf16 v[84:87], v[24:27], v[172:175], v[84:87]
    ds_read_b64_tr_b16 v[38:39], v11 offset:12800
    s_waitcnt vmcnt(5)
    s_waitcnt vmcnt(4)
    s_barrier
    s_cmp_lg_u32 s3, 0
    s_cbranch_scc1 L_w0_11AR
    s_add_u32 s52, s57, 32768
    s_mov_b64 exec, 1
    buffer_store_dwordx2 v[6:7], off, s[16:19], s52 sc1
    s_mov_b64 exec, -1
L_w0_11AR:
    s_add_u32 m0, s59, 32768
    s_add_u32 s58, s58, 229376
    buffer_load_dwordx4 v8, s[20:23], s58 offen offset:0 lds
    s_add_u32 m0, s59, 40960
    s_nop 0
    buffer_load_dwordx4 v8, s[24:27], s58 offen offset:0 lds
    s_add_u32 m0, s59, 49024
    s_nop 0
    buffer_load_dwordx4 v8, s[20:23], s58 offen offset:128 lds
    s_add_u32 m0, s59, 57216
    s_nop 0
    buffer_load_dwordx4 v8, s[24:27], s58 offen offset:128 lds
    s_waitcnt lgkmcnt(4)
    v_mfma_f32_16x16x32_bf16 v[56:59], v[28:31], v[168:171], v[56:59]
    ds_read_b64_tr_b16 v[16:17], v9 offset:32768
    v_mfma_f32_16x16x32_bf16 v[60:63], v[28:31], v[172:175], v[60:63]
    ds_read_b64_tr_b16 v[18:19], v9 offset:33280
    s_waitcnt lgkmcnt(4)
    v_mfma_f32_16x16x32_bf16 v[72:75], v[32:35], v[168:171], v[72:75]
    ds_read_b64_tr_b16 v[20:21], v10 offset:32768
    v_mfma_f32_16x16x32_bf16 v[76:79], v[32:35], v[172:175], v[76:79]
    ds_read_b64_tr_b16 v[22:23], v10 offset:33280
    s_waitcnt lgkmcnt(4)
    v_mfma_f32_16x16x32_bf16 v[88:91], v[36:39], v[168:171], v[88:91]
    ds_read_b64_tr_b16 v[24:25], v11 offset:32768
    v_mfma_f32_16x16x32_bf16 v[92:95], v[36:39], v[172:175], v[92:95]
    ds_read_b64_tr_b16 v[26:27], v11 offset:33280
    s_waitcnt lgkmcnt(4)
    v_mfma_f32_16x16x32_bf16 v[48:51], v[16:19], v[176:179], v[48:51]
    ds_read_b64_tr_b16 v[28:29], v9 offset:40960
    v_mfma_f32_16x16x32_bf16 v[52:55], v[16:19], v[180:183], v[52:55]
    ds_read_b64_tr_b16 v[30:31], v9 offset:41472
    s_waitcnt lgkmcnt(4)
    v_mfma_f32_16x16x32_bf16 v[64:67], v[20:23], v[176:179], v[64:67]
    ds_read_b64_tr_b16 v[32:33], v10 offset:40960
    v_mfma_f32_16x16x32_bf16 v[68:71], v[20:23], v[180:183], v[68:71]
    ds_read_b64_tr_b16 v[34:35], v10 offset:41472
    s_waitcnt lgkmcnt(4)
    v_mfma_f32_16x16x32_bf16 v[80:83], v[24:27], v[176:179], v[80:83]
    ds_read_b64_tr_b16 v[36:37], v11 offset:40960
    v_mfma_f32_16x16x32_bf16 v[84:87], v[24:27], v[180:183], v[84:87]
    ds_read_b64_tr_b16 v[38:39], v11 offset:41472
    s_waitcnt lgkmcnt(4)
    v_mfma_f32_16x16x32_bf16 v[56:59], v[28:31], v[176:179], v[56:59]
    ds_read_b64_tr_b16 v[16:17], v9 offset:36864
    v_mfma_f32_16x16x32_bf16 v[60:63], v[28:31], v[180:183], v[60:63]
    ds_read_b64_tr_b16 v[18:19], v9 offset:37376
    s_waitcnt lgkmcnt(4)
    v_mfma_f32_16x16x32_bf16 v[72:75], v[32:35], v[176:179], v[72:75]
    ds_read_b64_tr_b16 v[20:21], v10 offset:36864
    v_mfma_f32_16x16x32_bf16 v[76:79], v[32:35], v[180:183], v[76:79]
    ds_read_b64_tr_b16 v[22:23], v10 offset:37376
    s_waitcnt lgkmcnt(4)
    v_mfma_f32_16x16x32_bf16 v[88:91], v[36:39], v[176:179], v[88:91]
    ds_read_b64_tr_b16 v[24:25], v11 offset:36864
    v_mfma_f32_16x16x32_bf16 v[92:95], v[36:39], v[180:183], v[92:95]
    ds_read_b64_tr_b16 v[26:27], v11 offset:37376
    s_waitcnt lgkmcnt(4)
    v_mfma_f32_16x16x32_bf16 v[48:51], v[16:19], v[184:187], v[48:51]
    ds_read_b64_tr_b16 v[28:29], v9 offset:45056
    v_mfma_f32_16x16x32_bf16 v[52:55], v[16:19], v[188:191], v[52:55]
    ds_read_b64_tr_b16 v[30:31], v9 offset:45568
    s_waitcnt lgkmcnt(4)
    v_mfma_f32_16x16x32_bf16 v[64:67], v[20:23], v[184:187], v[64:67]
    ds_read_b64_tr_b16 v[32:33], v10 offset:45056
    v_mfma_f32_16x16x32_bf16 v[68:71], v[20:23], v[188:191], v[68:71]
    ds_read_b64_tr_b16 v[34:35], v10 offset:45568
    s_waitcnt lgkmcnt(4)
    v_mfma_f32_16x16x32_bf16 v[80:83], v[24:27], v[184:187], v[80:83]
    ds_read_b64_tr_b16 v[36:37], v11 offset:45056
    v_mfma_f32_16x16x32_bf16 v[84:87], v[24:27], v[188:191], v[84:87]
    ds_read_b64_tr_b16 v[38:39], v11 offset:45568
    v_add_u32 v9, 0xffff0000, v9
    v_add_u32 v10, 0xffff0000, v10
    v_add_u32 v11, 0xffff0000, v11
    s_waitcnt vmcnt(4)
    s_barrier
    s_add_u32 m0, s59, 65536
    s_add_u32 s58, s58, 229376
    s_cmp_eq_u32 s33, 2
    s_cselect_b32 s52, 1835008, 0
    s_sub_u32 s58, s58, s52
    buffer_load_dwordx4 v8, s[20:23], s58 offen offset:0 lds
    s_add_u32 m0, s59, 73728
    s_nop 0
    buffer_load_dwordx4 v8, s[24:27], s58 offen offset:0 lds
    s_add_u32 m0, s59, 81792
    s_nop 0
    buffer_load_dwordx4 v8, s[20:23], s58 offen offset:128 lds
    s_add_u32 m0, s59, 89984
    s_nop 0
    buffer_load_dwordx4 v8, s[24:27], s58 offen offset:128 lds
    s_waitcnt lgkmcnt(4)
    v_mfma_f32_16x16x32_bf16 v[56:59], v[28:31], v[184:187], v[56:59]
    ds_read_b64_tr_b16 v[16:17], v9 offset:0
    v_mfma_f32_16x16x32_bf16 v[60:63], v[28:31], v[188:191], v[60:63]
    ds_read_b64_tr_b16 v[18:19], v9 offset:512
    s_waitcnt lgkmcnt(4)
    v_mfma_f32_16x16x32_bf16 v[72:75], v[32:35], v[184:187], v[72:75]
    ds_read_b64_tr_b16 v[20:21], v10 offset:0
    v_mfma_f32_16x16x32_bf16 v[76:79], v[32:35], v[188:191], v[76:79]
    ds_read_b64_tr_b16 v[22:23], v10 offset:512
    s_waitcnt lgkmcnt(4)
    v_mfma_f32_16x16x32_bf16 v[88:91], v[36:39], v[184:187], v[88:91]
    ds_read_b64_tr_b16 v[24:25], v11 offset:0
    v_mfma_f32_16x16x32_bf16 v[92:95], v[36:39], v[188:191], v[92:95]
    ds_read_b64_tr_b16 v[26:27], v11 offset:512
    s_waitcnt lgkmcnt(4)
    v_mfma_f32_16x16x32_bf16 v[48:51], v[16:19], v[192:195], v[48:51]
    ds_read_b64_tr_b16 v[28:29], v9 offset:8192
    v_mfma_f32_16x16x32_bf16 v[52:55], v[16:19], v[196:199], v[52:55]
    ds_read_b64_tr_b16 v[30:31], v9 offset:8704
    s_waitcnt lgkmcnt(4)
    v_mfma_f32_16x16x32_bf16 v[64:67], v[20:23], v[192:195], v[64:67]
    ds_read_b64_tr_b16 v[32:33], v10 offset:8192
    v_mfma_f32_16x16x32_bf16 v[68:71], v[20:23], v[196:199], v[68:71]
    ds_read_b64_tr_b16 v[34:35], v10 offset:8704
    s_waitcnt lgkmcnt(4)
    v_mfma_f32_16x16x32_bf16 v[80:83], v[24:27], v[192:195], v[80:83]
    ds_read_b64_tr_b16 v[36:37], v11 offset:8192
    v_mfma_f32_16x16x32_bf16 v[84:87], v[24:27], v[196:199], v[84:87]
    ds_read_b64_tr_b16 v[38:39], v11 offset:8704
    s_waitcnt lgkmcnt(4)
    v_mfma_f32_16x16x32_bf16 v[56:59], v[28:31], v[192:195], v[56:59]
    ds_read_b64_tr_b16 v[16:17], v9 offset:4096
    v_mfma_f32_16x16x32_bf16 v[60:63], v[28:31], v[196:199], v[60:63]
    ds_read_b64_tr_b16 v[18:19], v9 offset:4608
    s_waitcnt lgkmcnt(4)
    v_mfma_f32_16x16x32_bf16 v[72:75], v[32:35], v[192:195], v[72:75]
    ds_read_b64_tr_b16 v[20:21], v10 offset:4096
    v_mfma_f32_16x16x32_bf16 v[76:79], v[32:35], v[196:199], v[76:79]
    ds_read_b64_tr_b16 v[22:23], v10 offset:4608
    s_waitcnt lgkmcnt(4)
    v_mfma_f32_16x16x32_bf16 v[88:91], v[36:39], v[192:195], v[88:91]
    ds_read_b64_tr_b16 v[24:25], v11 offset:4096
    v_mfma_f32_16x16x32_bf16 v[92:95], v[36:39], v[196:199], v[92:95]
    ds_read_b64_tr_b16 v[26:27], v11 offset:4608
    s_waitcnt lgkmcnt(4)
    v_mfma_f32_16x16x32_bf16 v[48:51], v[16:19], v[200:203], v[48:51]
    ds_read_b64_tr_b16 v[28:29], v9 offset:12288
    v_mfma_f32_16x16x32_bf16 v[52:55], v[16:19], v[204:207], v[52:55]
    ds_read_b64_tr_b16 v[30:31], v9 offset:12800
    s_waitcnt lgkmcnt(4)
    v_mfma_f32_16x16x32_bf16 v[64:67], v[20:23], v[200:203], v[64:67]
    ds_read_b64_tr_b16 v[32:33], v10 offset:12288
    v_mfma_f32_16x16x32_bf16 v[68:71], v[20:23], v[204:207], v[68:71]
    ds_read_b64_tr_b16 v[34:35], v10 offset:12800
    s_waitcnt lgkmcnt(4)
    v_mfma_f32_16x16x32_bf16 v[80:83], v[24:27], v[200:203], v[80:83]
    ds_read_b64_tr_b16 v[36:37], v11 offset:12288
    v_mfma_f32_16x16x32_bf16 v[84:87], v[24:27], v[204:207], v[84:87]
    ds_read_b64_tr_b16 v[38:39], v11 offset:12800
    s_waitcnt vmcnt(4)
    s_barrier
    s_add_u32 m0, s59, 98304
    s_add_u32 s58, s58, 229376
    buffer_load_dwordx4 v8, s[20:23], s58 offen offset:0 lds
    s_add_u32 m0, s59, 106496
    s_nop 0
    buffer_load_dwordx4 v8, s[24:27], s58 offen offset:0 lds
    s_add_u32 m0, s59, 114560
    s_nop 0
    buffer_load_dwordx4 v8, s[20:23], s58 offen offset:128 lds
    s_add_u32 m0, s59, 122752
    s_nop 0
    buffer_load_dwordx4 v8, s[24:27], s58 offen offset:128 lds
    s_waitcnt lgkmcnt(4)
    v_mfma_f32_16x16x32_bf16 v[56:59], v[28:31], v[200:203], v[56:59]
    ds_read_b64_tr_b16 v[16:17], v9 offset:32768
    v_mfma_f32_16x16x32_bf16 v[60:63], v[28:31], v[204:207], v[60:63]
    ds_read_b64_tr_b16 v[18:19], v9 offset:33280
    s_waitcnt lgkmcnt(4)
    v_mfma_f32_16x16x32_bf16 v[72:75], v[32:35], v[200:203], v[72:75]
    ds_read_b64_tr_b16 v[20:21], v10 offset:32768
    v_mfma_f32_16x16x32_bf16 v[76:79], v[32:35], v[204:207], v[76:79]
    ds_read_b64_tr_b16 v[22:23], v10 offset:33280
    s_waitcnt lgkmcnt(4)
    v_mfma_f32_16x16x32_bf16 v[88:91], v[36:39], v[200:203], v[88:91]
    ds_read_b64_tr_b16 v[24:25], v11 offset:32768
    v_mfma_f32_16x16x32_bf16 v[92:95], v[36:39], v[204:207], v[92:95]
    ds_read_b64_tr_b16 v[26:27], v11 offset:33280
    s_waitcnt lgkmcnt(4)
    v_mfma_f32_16x16x32_bf16 v[48:51], v[16:19], v[208:211], v[48:51]
    ds_read_b64_tr_b16 v[28:29], v9 offset:40960
    v_mfma_f32_16x16x32_bf16 v[52:55], v[16:19], v[212:215], v[52:55]
    ds_read_b64_tr_b16 v[30:31], v9 offset:41472
    s_waitcnt lgkmcnt(4)
    v_mfma_f32_16x16x32_bf16 v[64:67], v[20:23], v[208:211], v[64:67]
    ds_read_b64_tr_b16 v[32:33], v10 offset:40960
    v_mfma_f32_16x16x32_bf16 v[68:71], v[20:23], v[212:215], v[68:71]
    ds_read_b64_tr_b16 v[34:35], v10 offset:41472
    s_waitcnt lgkmcnt(4)
    v_mfma_f32_16x16x32_bf16 v[80:83], v[24:27], v[208:211], v[80:83]
    ds_read_b64_tr_b16 v[36:37], v11 offset:40960
    v_mfma_f32_16x16x32_bf16 v[84:87], v[24:27], v[212:215], v[84:87]
    ds_read_b64_tr_b16 v[38:39], v11 offset:41472
    s_waitcnt lgkmcnt(4)
    v_mfma_f32_16x16x32_bf16 v[56:59], v[28:31], v[208:211], v[56:59]
    ds_read_b64_tr_b16 v[16:17], v9 offset:36864
    v_mfma_f32_16x16x32_bf16 v[60:63], v[28:31], v[212:215], v[60:63]
    ds_read_b64_tr_b16 v[18:19], v9 offset:37376
    s_waitcnt lgkmcnt(4)
    v_mfma_f32_16x16x32_bf16 v[72:75], v[32:35], v[208:211], v[72:75]
    ds_read_b64_tr_b16 v[20:21], v10 offset:36864
    v_mfma_f32_16x16x32_bf16 v[76:79], v[32:35], v[212:215], v[76:79]
    ds_read_b64_tr_b16 v[22:23], v10 offset:37376
    s_waitcnt lgkmcnt(4)
    v_mfma_f32_16x16x32_bf16 v[88:91], v[36:39], v[208:211], v[88:91]
    ds_read_b64_tr_b16 v[24:25], v11 offset:36864
    v_mfma_f32_16x16x32_bf16 v[92:95], v[36:39], v[212:215], v[92:95]
    ds_read_b64_tr_b16 v[26:27], v11 offset:37376
    s_waitcnt lgkmcnt(4)
    v_mfma_f32_16x16x32_bf16 v[48:51], v[16:19], v[216:219], v[48:51]
    ds_read_b64_tr_b16 v[28:29], v9 offset:45056
    v_mfma_f32_16x16x32_bf16 v[52:55], v[16:19], v[220:223], v[52:55]
    ds_read_b64_tr_b16 v[30:31], v9 offset:45568
    s_waitcnt lgkmcnt(4)
    v_mfma_f32_16x16x32_bf16 v[64:67], v[20:23], v[216:219], v[64:67]
    ds_read_b64_tr_b16 v[32:33], v10 offset:45056
    v_mfma_f32_16x16x32_bf16 v[68:71], v[20:23], v[220:223], v[68:71]
    ds_read_b64_tr_b16 v[34:35], v10 offset:45568
    s_waitcnt lgkmcnt(4)
    v_mfma_f32_16x16x32_bf16 v[80:83], v[24:27], v[216:219], v[80:83]
    ds_read_b64_tr_b16 v[36:37], v11 offset:45056
    v_mfma_f32_16x16x32_bf16 v[84:87], v[24:27], v[220:223], v[84:87]
    ds_read_b64_tr_b16 v[38:39], v11 offset:45568
    v_add_u32 v9, 0x10000, v9
    v_add_u32 v10, 0x10000, v10
    v_add_u32 v11, 0x10000, v11
    s_waitcnt vmcnt(4)
    s_barrier
    s_cmp_lg_u32 s3, 0
    s_cbranch_scc1 L_w0_14AR
    s_mov_b64 exec, s[64:65]
    buffer_load_dwordx2 v[140:141], v142, s[16:19], 0 offen sc1
    s_mov_b64 exec, -1
L_w0_14AR:
    v_lshrrev_b32 v3, 9, v1
    v_lshlrev_b32 v8, 8, v3
    v_and_b32 v3, 0xf0, v1
    v_add_u32 v8, v3, v8
    v_add_u32 v8, 2097152, v8
    v_mov_b32 v5, 0x3f803f80
    v_bfe_u32 v3, v1, 4, 6
    v_and_b32 v3, 27, v3
    v_cmp_eq_u32 vcc, 16, v3
    s_nop 1
    v_cndmask_b32 v5, 0, v5, vcc
    v_mov_b32 v164, v5
    v_mov_b32 v165, v5
    v_mov_b32 v166, v5
    v_mov_b32 v167, v5
    v_mov_b32 v168, v5
    v_mov_b32 v169, v5
    v_mov_b32 v170, v5
    v_mov_b32 v171, v5
    v_mov_b32 v176, v5
    v_mov_b32 v177, v5
    v_mov_b32 v178, v5
    v_mov_b32 v179, v5
    v_mov_b32 v180, v5
    v_mov_b32 v181, v5
    v_mov_b32 v182, v5
    v_mov_b32 v183, v5
    s_waitcnt lgkmcnt(4)
    v_mfma_f32_16x16x32_bf16 v[56:59], v[28:31], v[216:219], v[56:59]
    ds_read_b64_tr_b16 v[16:17], v9 offset:0
    v_mfma_f32_16x16x32_bf16 v[60:63], v[28:31], v[220:223], v[60:63]
    ds_read_b64_tr_b16 v[18:19], v9 offset:512
    s_waitcnt lgkmcnt(4)
    v_mfma_f32_16x16x32_bf16 v[72:75], v[32:35], v[216:219], v[72:75]
    ds_read_b64_tr_b16 v[20:21], v10 offset:0
    v_mfma_f32_16x16x32_bf16 v[76:79], v[32:35], v[220:223], v[76:79]
    ds_read_b64_tr_b16 v[22:23], v10 offset:512
    s_waitcnt lgkmcnt(4)
    v_mfma_f32_16x16x32_bf16 v[88:91], v[36:39], v[216:219], v[88:91]
    ds_read_b64_tr_b16 v[24:25], v11 offset:0
    v_mfma_f32_16x16x32_bf16 v[92:95], v[36:39], v[220:223], v[92:95]
    ds_read_b64_tr_b16 v[26:27], v11 offset:512
    s_waitcnt lgkmcnt(4)
    v_mfma_f32_16x16x32_bf16 v[48:51], v[16:19], v[224:227], v[48:51]
    ds_read_b64_tr_b16 v[28:29], v9 offset:8192
    v_mfma_f32_16x16x32_bf16 v[52:55], v[16:19], v[228:231], v[52:55]
    ds_read_b64_tr_b16 v[30:31], v9 offset:8704
    s_waitcnt lgkmcnt(4)
    v_mfma_f32_16x16x32_bf16 v[64:67], v[20:23], v[224:227], v[64:67]
    ds_read_b64_tr_b16 v[32:33], v10 offset:8192
    v_mfma_f32_16x16x32_bf16 v[68:71], v[20:23], v[228:231], v[68:71]
    ds_read_b64_tr_b16 v[34:35], v10 offset:8704
    s_waitcnt lgkmcnt(4)
    v_mfma_f32_16x16x32_bf16 v[80:83], v[24:27], v[224:227], v[80:83]
    ds_read_b64_tr_b16 v[36:37], v11 offset:8192
    v_mfma_f32_16x16x32_bf16 v[84:87], v[24:27], v[228:231], v[84:87]
    ds_read_b64_tr_b16 v[38:39], v11 offset:8704
    s_waitcnt lgkmcnt(4)
    v_mfma_f32_16x16x32_bf16 v[56:59], v[28:31], v[224:227], v[56:59]
    ds_read_b64_tr_b16 v[16:17], v9 offset:4096
    v_mfma_f32_16x16x32_bf16 v[60:63], v[28:31], v[228:231], v[60:63]
    ds_read_b64_tr_b16 v[18:19], v9 offset:4608
    s_waitcnt lgkmcnt(4)
    v_mfma_f32_16x16x32_bf16 v[72:75], v[32:35], v[224:227], v[72:75]
    ds_read_b64_tr_b16 v[20:21], v10 offset:4096
    v_mfma_f32_16x16x32_bf16 v[76:79], v[32:35], v[228:231], v[76:79]
    ds_read_b64_tr_b16 v[22:23], v10 offset:4608
    s_waitcnt lgkmcnt(4)
    v_mfma_f32_16x16x32_bf16 v[88:91], v[36:39], v[224:227], v[88:91]
    ds_read_b64_tr_b16 v[24:25], v11 offset:4096
    v_mfma_f32_16x16x32_bf16 v[92:95], v[36:39], v[228:231], v[92:95]
    ds_read_b64_tr_b16 v[26:27], v11 offset:4608
    s_waitcnt lgkmcnt(4)
    v_mfma_f32_16x16x32_bf16 v[48:51], v[16:19], v[232:235], v[48:51]
    ds_read_b64_tr_b16 v[28:29], v9 offset:12288
    v_mfma_f32_16x16x32_bf16 v[52:55], v[16:19], v[236:239], v[52:55]
    ds_read_b64_tr_b16 v[30:31], v9 offset:12800
    s_waitcnt lgkmcnt(4)
    v_mfma_f32_16x16x32_bf16 v[64:67], v[20:23], v[232:235], v[64:67]
    ds_read_b64_tr_b16 v[32:33], v10 offset:12288
    v_mfma_f32_16x16x32_bf16 v[68:71], v[20:23], v[236:239], v[68:71]
    ds_read_b64_tr_b16 v[34:35], v10 offset:12800
    s_waitcnt lgkmcnt(4)
    v_mfma_f32_16x16x32_bf16 v[80:83], v[24:27], v[232:235], v[80:83]
    ds_read_b64_tr_b16 v[36:37], v11 offset:12288
    v_mfma_f32_16x16x32_bf16 v[84:87], v[24:27], v[236:239], v[84:87]
    ds_read_b64_tr_b16 v[38:39], v11 offset:12800
    s_cmp_lg_u32 s3, 0
    s_cbranch_scc1 L_w0_cAR
    s_mov_b32 s50, 131072
    s_waitcnt vmcnt(0)
    s_branch L_pollQAR_w
L_pollQAR:
    s_mov_b64 exec, s[64:65]
    buffer_load_dwordx2 v[140:141], v142, s[16:19], 0 offen sc1
    s_mov_b64 exec, -1
    s_waitcnt vmcnt(0)
L_pollQAR_w:
    v_cmp_eq_u64 vcc, s[48:49], v[140:141]
    s_sub_u32 s50, s50, 1
    s_cbranch_scc1 L_pollQAR_x
    s_and_b64 vcc, vcc, s[64:65]
    s_cmp_eq_u64 vcc, s[64:65]
    s_cbranch_scc0 L_pollQAR
L_pollQAR_x:
L_w0_cAR:
    s_waitcnt vmcnt(0)
    s_barrier
    v_and_b32 v44, 0x300, v1
    v_mad_u32_u24 v44, v44, 3, v1
    buffer_load_dwordx4 v[192:195], v44, s[16:19], s0 offen offset:0 sc1
    buffer_load_dwordx4 v[196:199], v44, s[16:19], s0 offen offset:512 sc1
    buffer_load_dwordx4 v[160:163], v1, s[16:19], s79 offen sc1
    buffer_load_dwordx4 v[128:131], v1, s[16:19], s86 offen offset:0 sc1
    buffer_load_dwordx4 v[132:135], v1, s[16:19], s86 offen offset:1024 sc1
    s_waitcnt lgkmcnt(4)
    v_mfma_f32_16x16x32_bf16 v[56:59], v[28:31], v[232:235], v[56:59]
    ds_read_b64_tr_b16 v[16:17], v9 offset:32768
    v_mfma_f32_16x16x32_bf16 v[60:63], v[28:31], v[236:239], v[60:63]
    ds_read_b64_tr_b16 v[18:19], v9 offset:33280
    s_mov_b64 exec, s[82:83]
    buffer_load_dwordx4 v[164:167], v8, s[16:19], s79 offen sc1
    buffer_load_dwordx4 v[168:171], v8, s[16:19], s79 offen offset:512 sc1
    s_mov_b64 exec, -1
    s_waitcnt lgkmcnt(4)
    v_mfma_f32_16x16x32_bf16 v[72:75], v[32:35], v[232:235], v[72:75]
    ds_read_b64_tr_b16 v[20:21], v10 offset:32768
    v_mfma_f32_16x16x32_bf16 v[76:79], v[32:35], v[236:239], v[76:79]
    ds_read_b64_tr_b16 v[22:23], v10 offset:33280
    buffer_load_dwordx4 v[136:139], v1, s[16:19], s87 offen offset:0 sc1
    s_waitcnt lgkmcnt(4)
    v_mfma_f32_16x16x32_bf16 v[88:91], v[36:39], v[232:235], v[88:91]
    ds_read_b64_tr_b16 v[24:25], v11 offset:32768
    v_mfma_f32_16x16x32_bf16 v[92:95], v[36:39], v[236:239], v[92:95]
    ds_read_b64_tr_b16 v[26:27], v11 offset:33280
    buffer_load_dwordx4 v[140:143], v1, s[16:19], s87 offen offset:1024 sc1
    s_waitcnt lgkmcnt(4)
    v_mfma_f32_16x16x32_bf16 v[48:51], v[16:19], v[240:243], v[48:51]
    ds_read_b64_tr_b16 v[28:29], v9 offset:40960
    v_mfma_f32_16x16x32_bf16 v[52:55], v[16:19], v[244:247], v[52:55]
    ds_read_b64_tr_b16 v[30:31], v9 offset:41472
    buffer_load_dwordx4 v[144:147], v1, s[16:19], s88 offen offset:0 sc1
    s_waitcnt lgkmcnt(4)
    v_mfma_f32_16x16x32_bf16 v[64:67], v[20:23], v[240:243], v[64:67]
    ds_read_b64_tr_b16 v[32:33], v10 offset:40960
    v_mfma_f32_16x16x32_bf16 v[68:71], v[20:23], v[244:247], v[68:71]
    ds_read_b64_tr_b16 v[34:35], v10 offset:41472
    buffer_load_dwordx4 v[148:151], v1, s[16:19], s88 offen offset:1024 sc1
    s_waitcnt lgkmcnt(4)
    v_mfma_f32_16x16x32_bf16 v[80:83], v[24:27], v[240:243], v[80:83]
    ds_read_b64_tr_b16 v[36:37], v11 offset:40960
    v_mfma_f32_16x16x32_bf16 v[84:87], v[24:27], v[244:247], v[84:87]
    ds_read_b64_tr_b16 v[38:39], v11 offset:41472
    buffer_load_dwordx4 v[152:155], v1, s[16:19], s89 offen offset:0 sc1
    s_waitcnt lgkmcnt(4)
    v_mfma_f32_16x16x32_bf16 v[56:59], v[28:31], v[240:243], v[56:59]
    ds_read_b64_tr_b16 v[16:17], v9 offset:36864
    v_mfma_f32_16x16x32_bf16 v[60:63], v[28:31], v[244:247], v[60:63]
    ds_read_b64_tr_b16 v[18:19], v9 offset:37376
    buffer_load_dwordx4 v[156:159], v1, s[16:19], s89 offen offset:1024 sc1
    s_waitcnt lgkmcnt(4)
    v_mfma_f32_16x16x32_bf16 v[72:75], v[32:35], v[240:243], v[72:75]
    ds_read_b64_tr_b16 v[20:21], v10 offset:36864
    v_mfma_f32_16x16x32_bf16 v[76:79], v[32:35], v[244:247], v[76:79]
    ds_read_b64_tr_b16 v[22:23], v10 offset:37376
    buffer_load_dwordx4 v[172:175], v1, s[16:19], s79 offen offset:1024 sc1
    s_waitcnt lgkmcnt(4)
    v_mfma_f32_16x16x32_bf16 v[88:91], v[36:39], v[240:243], v[88:91]
    ds_read_b64_tr_b16 v[24:25], v11 offset:36864
    v_mfma_f32_16x16x32_bf16 v[92:95], v[36:39], v[244:247], v[92:95]
    ds_read_b64_tr_b16 v[26:27], v11 offset:37376
    s_mov_b64 exec, s[82:83]
    buffer_load_dwordx4 v[176:179], v8, s[16:19], s79 offen offset:1024 sc1
    buffer_load_dwordx4 v[180:183], v8, s[16:19], s79 offen offset:1536 sc1
    s_mov_b64 exec, -1
    s_waitcnt lgkmcnt(4)
    v_mfma_f32_16x16x32_bf16 v[48:51], v[16:19], v[248:251], v[48:51]
    ds_read_b64_tr_b16 v[28:29], v9 offset:45056
    v_mfma_f32_16x16x32_bf16 v[52:55], v[16:19], v[252:255], v[52:55]
    ds_read_b64_tr_b16 v[30:31], v9 offset:45568
    s_waitcnt lgkmcnt(4)
    v_mfma_f32_16x16x32_bf16 v[64:67], v[20:23], v[248:251], v[64:67]
    ds_read_b64_tr_b16 v[32:33], v10 offset:45056
    v_mfma_f32_16x16x32_bf16 v[68:71], v[20:23], v[252:255], v[68:71]
    ds_read_b64_tr_b16 v[34:35], v10 offset:45568
    s_waitcnt lgkmcnt(4)
    v_mfma_f32_16x16x32_bf16 v[80:83], v[24:27], v[248:251], v[80:83]
    ds_read_b64_tr_b16 v[36:37], v11 offset:45056
    v_mfma_f32_16x16x32_bf16 v[84:87], v[24:27], v[252:255], v[84:87]
    ds_read_b64_tr_b16 v[38:39], v11 offset:45568
    v_mov_b32 v220, v5
    v_mov_b32 v221, v5
    v_mov_b32 v222, v5
    v_mov_b32 v223, v5
    v_mov_b32 v224, v5
    v_mov_b32 v225, v5
    v_mov_b32 v226, v5
    v_mov_b32 v227, v5
    v_mov_b32 v232, v5
    v_mov_b32 v233, v5
    v_mov_b32 v234, v5
    v_mov_b32 v235, v5
    v_mov_b32 v236, v5
    v_mov_b32 v237, v5
    v_mov_b32 v238, v5
    v_mov_b32 v239, v5
    s_waitcnt vmcnt(14)
    v_add_f32 v40, v192, v196
    v_add_f32 v41, v193, v197
    v_add_f32 v42, v194, v198
    s_lshl_b32 s52, s32, 2
    s_add_u32 s52, s52, 151552
    v_add_u32 v4, s52, v1
    v_cvt_pk_bf16_f32 v3, v40, v40
    v_lshlrev_b32 v3, 16, v3
    v_sub_f32 v5, v40, v3
    v_cvt_pk_bf16_f32 v3, v3, v5
    ds_write_b32 v4, v3 offset:0
    v_cvt_pk_bf16_f32 v3, v41, v41
    v_lshlrev_b32 v3, 16, v3
    v_sub_f32 v5, v41, v3
    v_cvt_pk_bf16_f32 v3, v3, v5
    ds_write_b32 v4, v3 offset:1024
    v_cvt_pk_bf16_f32 v3, v42, v42
    v_lshlrev_b32 v3, 16, v3
    v_sub_f32 v5, v42, v3
    v_cvt_pk_bf16_f32 v3, v3, v5
    ds_write_b32 v4, v3 offset:2048
    v_mov_b32 v184, 0
    v_mov_b32 v185, 0
    v_mov_b32 v186, v12
    v_mov_b32 v187, v12
    v_mov_b32 v188, 0
    v_mov_b32 v189, 0
    v_mov_b32 v190, v14
    v_mov_b32 v191, v14
    v_mov_b32 v192, 0
    v_mov_b32 v193, 0
    v_mul_f32 v44, v13, v13
    v_mul_f32 v45, v15, v15
    s_waitcnt lgkmcnt(0)
    s_barrier
    v_add_u32 v4, 151552, v1
    ds_read_b128 v[96:99], v4 offset:0
    ds_read_b128 v[100:103], v4 offset:1024
    ds_read_b128 v[104:107], v4 offset:2048
    v_mfma_f32_16x16x32_bf16 v[56:59], v[28:31], v[248:251], v[56:59]
    v_mfma_f32_16x16x32_bf16 v[60:63], v[28:31], v[252:255], v[60:63]
    v_mfma_f32_16x16x32_bf16 v[72:75], v[32:35], v[248:251], v[72:75]
    v_mfma_f32_16x16x32_bf16 v[76:79], v[32:35], v[252:255], v[76:79]
    v_mfma_f32_16x16x32_bf16 v[88:91], v[36:39], v[248:251], v[88:91]
    v_mfma_f32_16x16x32_bf16 v[92:95], v[36:39], v[252:255], v[92:95]
    s_waitcnt lgkmcnt(2)
    v_mfma_f32_16x16x32_bf16 v[48:51], v[96:99], v[186:189], v[48:51]
    v_mfma_f32_16x16x32_bf16 v[52:55], v[96:99], v[190:193], v[52:55]
    v_mfma_f32_16x16x32_bf16 v[56:59], v[96:99], v[184:187], v[56:59]
    v_mfma_f32_16x16x32_bf16 v[60:63], v[96:99], v[188:191], v[60:63]
    s_waitcnt lgkmcnt(1)
    v_mfma_f32_16x16x32_bf16 v[64:67], v[100:103], v[186:189], v[64:67]
    v_mfma_f32_16x16x32_bf16 v[68:71], v[100:103], v[190:193], v[68:71]
    v_mfma_f32_16x16x32_bf16 v[72:75], v[100:103], v[184:187], v[72:75]
    v_mfma_f32_16x16x32_bf16 v[76:79], v[100:103], v[188:191], v[76:79]
    s_nop 1
    v_max_f32 v48, 0, v48
    v_max_f32 v49, 0, v49
    v_max_f32 v50, 0, v50
    v_max_f32 v51, 0, v51
    s_waitcnt lgkmcnt(0)
    v_mfma_f32_16x16x32_bf16 v[80:83], v[104:107], v[186:189], v[80:83]
    v_max_f32 v52, 0, v52
    v_max_f32 v53, 0, v53
    v_max_f32 v54, 0, v54
    v_max_f32 v55, 0, v55
    v_mfma_f32_16x16x32_bf16 v[84:87], v[104:107], v[190:193], v[84:87]
    v_mul_f32 v56, v44, v56
    v_mul_f32 v57, v44, v57
    v_mul_f32 v58, v44, v58
    v_mul_f32 v59, v44, v59
    v_mfma_f32_16x16x32_bf16 v[88:91], v[104:107], v[184:187], v[88:91]
    v_mul_f32 v60, v45, v60
    v_mul_f32 v61, v45, v61
    v_mul_f32 v62, v45, v62
    v_mul_f32 v63, v45, v63
    v_mfma_f32_16x16x32_bf16 v[92:95], v[104:107], v[188:191], v[92:95]
    v_mul_f32 v48, v48, v56
    v_mul_f32 v49, v49, v57
    v_mul_f32 v50, v50, v58
    v_mul_f32 v51, v51, v59
    v_mul_f32 v52, v52, v60
    v_mul_f32 v53, v53, v61
    v_mul_f32 v54, v54, v62
    v_mul_f32 v55, v55, v63
    v_cvt_pk_bf16_f32 v200, v48, v49
    v_cvt_pk_bf16_f32 v201, v50, v51
    v_cvt_pk_bf16_f32 v202, v52, v53
    v_cvt_pk_bf16_f32 v203, v54, v55
    v_max_f32 v64, 0, v64
    v_max_f32 v65, 0, v65
    v_permlane32_swap_b32 v200, v202
    v_permlane32_swap_b32 v201, v203
    buffer_store_dwordx4 v[200:203], v46, s[16:19], s77 offen offset:0 sc1
    v_max_f32 v66, 0, v66
    v_max_f32 v67, 0, v67
    v_max_f32 v68, 0, v68
    v_max_f32 v69, 0, v69
    v_max_f32 v70, 0, v70
    v_max_f32 v71, 0, v71
    v_mul_f32 v72, v44, v72
    v_mul_f32 v73, v44, v73
    v_mul_f32 v74, v44, v74
    v_mul_f32 v75, v44, v75
    v_mul_f32 v76, v45, v76
    v_mul_f32 v77, v45, v77
    v_mul_f32 v78, v45, v78
    v_mul_f32 v79, v45, v79
    v_mul_f32 v64, v64, v72
    v_mul_f32 v65, v65, v73
    v_mul_f32 v66, v66, v74
    v_mul_f32 v67, v67, v75
    v_mul_f32 v68, v68, v76
    v_mul_f32 v69, v69, v77
    v_mul_f32 v70, v70, v78
    v_mul_f32 v71, v71, v79
    v_cvt_pk_bf16_f32 v204, v64, v65
    v_cvt_pk_bf16_f32 v205, v66, v67
    v_cvt_pk_bf16_f32 v206, v68, v69
    v_cvt_pk_bf16_f32 v207, v70, v71
    v_max_f32 v80, 0, v80
    v_max_f32 v81, 0, v81
    v_permlane32_swap_b32 v204, v206
    v_permlane32_swap_b32 v205, v207
    buffer_store_dwordx4 v[204:207], v46, s[16:19], s77 offen offset:1024 sc1
    v_max_f32 v82, 0, v82
    v_max_f32 v83, 0, v83
    v_max_f32 v84, 0, v84
    v_max_f32 v85, 0, v85
    v_max_f32 v86, 0, v86
    v_max_f32 v87, 0, v87
    v_mul_f32 v88, v44, v88
    v_mul_f32 v89, v44, v89
    v_mul_f32 v90, v44, v90
    v_mul_f32 v91, v44, v91
    v_mul_f32 v92, v45, v92
    v_mul_f32 v93, v45, v93
    v_mul_f32 v94, v45, v94
    v_mul_f32 v95, v45, v95
    v_mul_f32 v80, v80, v88
    v_mul_f32 v81, v81, v89
    v_mul_f32 v82, v82, v90
    v_mul_f32 v83, v83, v91
    v_mul_f32 v84, v84, v92
    v_mul_f32 v85, v85, v93
    v_mul_f32 v86, v86, v94
    v_mul_f32 v87, v87, v95
    v_cvt_pk_bf16_f32 v208, v80, v81
    v_cvt_pk_bf16_f32 v209, v82, v83
    v_cvt_pk_bf16_f32 v210, v84, v85
    v_cvt_pk_bf16_f32 v211, v86, v87
    s_nop 1
    v_permlane32_swap_b32 v208, v210
    v_permlane32_swap_b32 v209, v211
    buffer_store_dwordx4 v[208:211], v46, s[16:19], s77 offen offset:2048 sc1
    s_setprio 1
    s_waitcnt vmcnt(6)
L_Ax:
    v_mfma_f32_32x32x16_bf16 v[184:199], v[160:163], v[128:131], 0
    v_mov_b32 v14, 0
    v_mov_b32 v15, 0
    v_add_u32 v9, s90, v1
    v_add_u32 v10, s91, v1
    v_add_u32 v11, s92, v1
    v_add_u32 v12, s93, v1
    v_mov_b32 v13, 0xdddd
    v_mfma_f32_32x32x8_bf16 v[16:31], v[14:15], v[14:15], 0
    s_add_u32 s51, s79, 12288
    s_nop 2
    v_exp_f32 v184, v184
    v_exp_f32 v185, v185
    v_exp_f32 v186, v186
    buffer_load_dwordx4 v[216:219], v1, s[16:19], s79 offen offset:2048 sc1
    v_exp_f32 v187, v187
    v_exp_f32 v188, v188
    v_mfma_f32_32x32x16_bf16 v[200:215], v[160:163], v[132:135], 0
    v_exp_f32 v189, v189
    v_exp_f32 v190, v190
    v_exp_f32 v191, v191
    v_exp_f32 v192, v192
    v_exp_f32 v193, v193
    v_exp_f32 v194, v194
    v_smfmac_f32_32x32x32_bf16 v[16:31], v[164:167], v[184:191], v13
    v_exp_f32 v195, v195
    v_exp_f32 v196, v196
    v_exp_f32 v197, v197
    v_exp_f32 v198, v198
    v_mfma_f32_32x32x8_bf16 v[32:47], v[14:15], v[14:15], 0
    v_exp_f32 v199, v199
    v_exp_f32 v200, v200
    v_exp_f32 v201, v201
    v_smfmac_f32_32x32x32_bf16 v[16:31], v[168:171], v[192:199], v13
    v_exp_f32 v202, v202
    s_mov_b64 exec, s[82:83]
    buffer_load_dwordx4 v[220:223], v8, s[16:19], s79 offen offset:2048 sc1
    buffer_load_dwordx4 v[224:227], v8, s[16:19], s79 offen offset:2560 sc1
    s_mov_b64 exec, -1
    v_exp_f32 v203, v203
    v_exp_f32 v204, v204
    v_mfma_f32_32x32x16_bf16 v[184:199], v[160:163], v[136:139], 0
    v_exp_f32 v205, v205
    v_exp_f32 v206, v206
    v_exp_f32 v207, v207
    v_exp_f32 v208, v208
    v_exp_f32 v209, v209
    v_exp_f32 v210, v210
    v_smfmac_f32_32x32x32_bf16 v[32:47], v[164:167], v[200:207], v13
    v_exp_f32 v211, v211
    v_exp_f32 v212, v212
    v_exp_f32 v213, v213
    v_exp_f32 v214, v214
    v_mfma_f32_32x32x8_bf16 v[48:63], v[14:15], v[14:15], 0
    v_exp_f32 v215, v215
    v_exp_f32 v184, v184
    v_exp_f32 v185, v185
    v_smfmac_f32_32x32x32_bf16 v[32:47], v[168:171], v[208:215], v13
    v_exp_f32 v186, v186
    buffer_load_dwordx4 v[228:231], v1, s[16:19], s79 offen offset:3072 sc1
    v_exp_f32 v187, v187
    v_exp_f32 v188, v188
    v_mfma_f32_32x32x16_bf16 v[200:215], v[160:163], v[140:143], 0
    v_exp_f32 v189, v189
    v_exp_f32 v190, v190
    v_exp_f32 v191, v191
    v_exp_f32 v192, v192
    v_exp_f32 v193, v193
    v_exp_f32 v194, v194
    v_smfmac_f32_32x32x32_bf16 v[48:63], v[164:167], v[184:191], v13
    v_exp_f32 v195, v195
    v_exp_f32 v196, v196
    v_exp_f32 v197, v197
    v_exp_f32 v198, v198
    v_mfma_f32_32x32x8_bf16 v[64:79], v[14:15], v[14:15], 0
    v_exp_f32 v199, v199
    v_exp_f32 v200, v200
    v_exp_f32 v201, v201
    v_smfmac_f32_32x32x32_bf16 v[48:63], v[168:171], v[192:199], v13
    v_exp_f32 v202, v202
    s_mov_b64 exec, s[82:83]
    buffer_load_dwordx4 v[232:235], v8, s[16:19], s79 offen offset:3072 sc1
    buffer_load_dwordx4 v[236:239], v8, s[16:19], s79 offen offset:3584 sc1
    s_mov_b64 exec, -1
    v_exp_f32 v203, v203
    v_exp_f32 v204, v204
    v_mfma_f32_32x32x16_bf16 v[184:199], v[160:163], v[144:147], 0
    v_exp_f32 v205, v205
    v_exp_f32 v206, v206
    v_exp_f32 v207, v207
    v_exp_f32 v208, v208
    v_exp_f32 v209, v209
    v_exp_f32 v210, v210
    v_smfmac_f32_32x32x32_bf16 v[64:79], v[164:167], v[200:207], v13
    v_exp_f32 v211, v211
    v_exp_f32 v212, v212
    v_exp_f32 v213, v213
    v_exp_f32 v214, v214
    v_mfma_f32_32x32x8_bf16 v[80:95], v[14:15], v[14:15], 0
    v_exp_f32 v215, v215
    v_exp_f32 v184, v184
    v_exp_f32 v185, v185
    v_smfmac_f32_32x32x32_bf16 v[64:79], v[168:171], v[208:215], v13
    v_exp_f32 v186, v186
    v_exp_f32 v187, v187
    v_exp_f32 v188, v188
    v_mfma_f32_32x32x16_bf16 v[200:215], v[160:163], v[148:151], 0
    v_exp_f32 v189, v189
    v_exp_f32 v190, v190
    v_exp_f32 v191, v191
    v_exp_f32 v192, v192
    v_exp_f32 v193, v193
    v_exp_f32 v194, v194
    v_smfmac_f32_32x32x32_bf16 v[80:95], v[164:167], v[184:191], v13
    v_exp_f32 v195, v195
    v_exp_f32 v196, v196
    v_exp_f32 v197, v197
    v_exp_f32 v198, v198
    v_mfma_f32_32x32x8_bf16 v[96:111], v[14:15], v[14:15], 0
    v_exp_f32 v199, v199
    v_exp_f32 v200, v200
    v_exp_f32 v201, v201
    v_smfmac_f32_32x32x32_bf16 v[80:95], v[168:171], v[192:199], v13
    v_exp_f32 v202, v202
    v_exp_f32 v203, v203
    v_exp_f32 v204, v204
    v_mfma_f32_32x32x16_bf16 v[184:199], v[160:163], v[152:155], 0
    v_exp_f32 v205, v205
    v_exp_f32 v206, v206
    v_exp_f32 v207, v207
    v_exp_f32 v208, v208
    v_exp_f32 v209, v209
    v_exp_f32 v210, v210
    v_smfmac_f32_32x32x32_bf16 v[96:111], v[164:167], v[200:207], v13
    v_exp_f32 v211, v211
    v_exp_f32 v212, v212
    v_exp_f32 v213, v213
    v_exp_f32 v214, v214
    v_mfma_f32_32x32x8_bf16 v[112:127], v[14:15], v[14:15], 0
    v_exp_f32 v215, v215
    v_exp_f32 v184, v184
    v_exp_f32 v185, v185
    v_smfmac_f32_32x32x32_bf16 v[96:111], v[168:171], v[208:215], v13
    v_exp_f32 v186, v186
    v_exp_f32 v187, v187
    v_exp_f32 v188, v188
    v_mfma_f32_32x32x16_bf16 v[200:215], v[160:163], v[156:159], 0
    v_exp_f32 v189, v189
    v_exp_f32 v190, v190
    v_exp_f32 v191, v191
    v_exp_f32 v192, v192
    v_exp_f32 v193, v193
    v_exp_f32 v194, v194
    v_smfmac_f32_32x32x32_bf16 v[112:127], v[164:167], v[184:191], v13
    v_exp_f32 v195, v195
    v_exp_f32 v196, v196
    v_exp_f32 v197, v197
    v_exp_f32 v198, v198
    v_mfma_f32_32x32x8_bf16 v[240:255], v[14:15], v[14:15], 0
    v_exp_f32 v199, v199
    v_exp_f32 v200, v200
    v_exp_f32 v201, v201
    v_smfmac_f32_32x32x32_bf16 v[112:127], v[168:171], v[192:199], v13
    v_exp_f32 v202, v202
    v_exp_f32 v203, v203
    v_exp_f32 v204, v204
    s_waitcnt vmcnt(9)
    v_mfma_f32_32x32x16_bf16 v[184:199], v[172:175], v[128:131], 0
    v_exp_f32 v205, v205
    v_exp_f32 v206, v206
    v_exp_f32 v207, v207
    v_exp_f32 v208, v208
    v_exp_f32 v209, v209
    v_exp_f32 v210, v210
    v_smfmac_f32_32x32x32_bf16 v[240:255], v[164:167], v[200:207], v13
    v_exp_f32 v211, v211
    v_exp_f32 v212, v212
    v_exp_f32 v213, v213
    v_exp_f32 v214, v214
    v_exp_f32 v215, v215
    v_exp_f32 v184, v184
    v_exp_f32 v185, v185
    v_smfmac_f32_32x32x32_bf16 v[240:255], v[168:171], v[208:215], v13
    v_exp_f32 v186, v186
    v_exp_f32 v187, v187
    v_exp_f32 v188, v188
    v_mfma_f32_32x32x16_bf16 v[200:215], v[172:175], v[132:135], 0
    v_exp_f32 v189, v189
    v_exp_f32 v190, v190
    v_exp_f32 v191, v191
    v_exp_f32 v192, v192
    v_exp_f32 v193, v193
    v_exp_f32 v194, v194
    v_smfmac_f32_32x32x32_bf16 v[16:31], v[176:179], v[184:191], v13
    v_exp_f32 v195, v195
    v_exp_f32 v196, v196
    v_exp_f32 v197, v197
    v_exp_f32 v198, v198
    v_exp_f32 v199, v199
    v_exp_f32 v200, v200
    v_exp_f32 v201, v201
    v_smfmac_f32_32x32x32_bf16 v[16:31], v[180:183], v[192:199], v13
    v_exp_f32 v202, v202
    v_exp_f32 v203, v203
    v_exp_f32 v204, v204
    v_mfma_f32_32x32x16_bf16 v[184:199], v[172:175], v[136:139], 0
    v_exp_f32 v205, v205
    v_exp_f32 v206, v206
    v_exp_f32 v207, v207
    v_exp_f32 v208, v208
    v_exp_f32 v209, v209
    v_exp_f32 v210, v210
    v_smfmac_f32_32x32x32_bf16 v[32:47], v[176:179], v[200:207], v13
    v_exp_f32 v211, v211
    v_exp_f32 v212, v212
    v_exp_f32 v213, v213
    v_exp_f32 v214, v214
    v_exp_f32 v215, v215
    v_exp_f32 v184, v184
    v_exp_f32 v185, v185
    v_smfmac_f32_32x32x32_bf16 v[32:47], v[180:183], v[208:215], v13
    v_exp_f32 v186, v186
    v_exp_f32 v187, v187
    v_exp_f32 v188, v188
    v_mfma_f32_32x32x16_bf16 v[200:215], v[172:175], v[140:143], 0
    v_exp_f32 v189, v189
    v_exp_f32 v190, v190
    v_exp_f32 v191, v191
    v_exp_f32 v192, v192
    v_exp_f32 v193, v193
    v_exp_f32 v194, v194
    v_smfmac_f32_32x32x32_bf16 v[48:63], v[176:179], v[184:191], v13
    v_exp_f32 v195, v195
    v_exp_f32 v196, v196
    v_exp_f32 v197, v197
    v_exp_f32 v198, v198
    v_exp_f32 v199, v199
    v_exp_f32 v200, v200
    v_exp_f32 v201, v201
    v_smfmac_f32_32x32x32_bf16 v[48:63], v[180:183], v[192:199], v13
    v_exp_f32 v202, v202
    v_exp_f32 v203, v203
    v_exp_f32 v204, v204
    v_mfma_f32_32x32x16_bf16 v[184:199], v[172:175], v[144:147], 0
    v_exp_f32 v205, v205
    v_exp_f32 v206, v206
    v_exp_f32 v207, v207
    v_exp_f32 v208, v208
    v_exp_f32 v209, v209
    v_exp_f32 v210, v210
    v_smfmac_f32_32x32x32_bf16 v[64:79], v[176:179], v[200:207], v13
    v_exp_f32 v211, v211
    v_exp_f32 v212, v212
    v_exp_f32 v213, v213
    v_exp_f32 v214, v214
    v_exp_f32 v215, v215
    v_exp_f32 v184, v184
    v_exp_f32 v185, v185
    v_smfmac_f32_32x32x32_bf16 v[64:79], v[180:183], v[208:215], v13
    v_exp_f32 v186, v186
    v_exp_f32 v187, v187
    v_exp_f32 v188, v188
    v_mfma_f32_32x32x16_bf16 v[200:215], v[172:175], v[148:151], 0
    v_exp_f32 v189, v189
    v_exp_f32 v190, v190
    v_exp_f32 v191, v191
    v_exp_f32 v192, v192
    v_exp_f32 v193, v193
    v_exp_f32 v194, v194
    v_smfmac_f32_32x32x32_bf16 v[80:95], v[176:179], v[184:191], v13
    v_exp_f32 v195, v195
    v_exp_f32 v196, v196
    v_exp_f32 v197, v197
    v_exp_f32 v198, v198
    v_exp_f32 v199, v199
    v_exp_f32 v200, v200
    v_exp_f32 v201, v201
    v_smfmac_f32_32x32x32_bf16 v[80:95], v[180:183], v[192:199], v13
    v_exp_f32 v202, v202
    v_exp_f32 v203, v203
    v_exp_f32 v204, v204
    v_mfma_f32_32x32x16_bf16 v[184:199], v[172:175], v[152:155], 0
    v_exp_f32 v205, v205
    v_exp_f32 v206, v206
    v_exp_f32 v207, v207
    v_exp_f32 v208, v208
    v_exp_f32 v209, v209
    v_exp_f32 v210, v210
    v_smfmac_f32_32x32x32_bf16 v[96:111], v[176:179], v[200:207], v13
    v_exp_f32 v211, v211
    v_exp_f32 v212, v212
    v_exp_f32 v213, v213
    v_exp_f32 v214, v214
    v_exp_f32 v215, v215
    v_exp_f32 v184, v184
    v_exp_f32 v185, v185
    v_smfmac_f32_32x32x32_bf16 v[96:111], v[180:183], v[208:215], v13
    v_exp_f32 v186, v186
    v_exp_f32 v187, v187
    v_exp_f32 v188, v188
    v_mfma_f32_32x32x16_bf16 v[200:215], v[172:175], v[156:159], 0
    v_exp_f32 v189, v189
    v_exp_f32 v190, v190
    v_exp_f32 v191, v191
    v_exp_f32 v192, v192
    v_exp_f32 v193, v193
    v_exp_f32 v194, v194
    v_smfmac_f32_32x32x32_bf16 v[112:127], v[176:179], v[184:191], v13
    v_exp_f32 v195, v195
    v_exp_f32 v196, v196
    v_exp_f32 v197, v197
    v_exp_f32 v198, v198
    v_exp_f32 v199, v199
    v_exp_f32 v200, v200
    v_exp_f32 v201, v201
    v_smfmac_f32_32x32x32_bf16 v[112:127], v[180:183], v[192:199], v13
    v_exp_f32 v202, v202
    v_exp_f32 v203, v203
    v_exp_f32 v204, v204
    s_waitcnt vmcnt(0)
    v_mfma_f32_32x32x16_bf16 v[184:199], v[216:219], v[128:131], 0
    v_exp_f32 v205, v205
    v_exp_f32 v206, v206
    s_mov_b64 exec, 1
    buffer_store_dwordx2 v[6:7], off, s[16:19], s78 sc1
    s_mov_b64 exec, -1
    v_exp_f32 v207, v207
    v_exp_f32 v208, v208
    v_exp_f32 v209, v209
    v_exp_f32 v210, v210
    v_smfmac_f32_32x32x32_bf16 v[240:255], v[176:179], v[200:207], v13
    v_exp_f32 v211, v211
    v_exp_f32 v212, v212
    v_exp_f32 v213, v213
    v_exp_f32 v214, v214
    v_exp_f32 v215, v215
    v_exp_f32 v184, v184
    v_exp_f32 v185, v185
    v_smfmac_f32_32x32x32_bf16 v[240:255], v[180:183], v[208:215], v13
    v_exp_f32 v186, v186
    s_add_u32 s79, s79, 4096
    buffer_load_dwordx4 v[160:163], v1, s[16:19], s79 offen offset:0 sc1
    v_exp_f32 v187, v187
    v_exp_f32 v188, v188
    v_mfma_f32_32x32x16_bf16 v[200:215], v[216:219], v[132:135], 0
    v_exp_f32 v189, v189
    v_exp_f32 v190, v190
    v_exp_f32 v191, v191
    v_exp_f32 v192, v192
    v_exp_f32 v193, v193
    v_exp_f32 v194, v194
    v_smfmac_f32_32x32x32_bf16 v[16:31], v[220:223], v[184:191], v13
    v_exp_f32 v195, v195
    v_exp_f32 v196, v196
    v_exp_f32 v197, v197
    v_exp_f32 v198, v198
    v_exp_f32 v199, v199
    v_exp_f32 v200, v200
    v_exp_f32 v201, v201
    v_smfmac_f32_32x32x32_bf16 v[16:31], v[224:227], v[192:199], v13
    v_exp_f32 v202, v202
    s_mov_b64 exec, s[82:83]
    buffer_load_dwordx4 v[164:167], v8, s[16:19], s79 offen offset:0 sc1
    buffer_load_dwordx4 v[168:171], v8, s[16:19], s79 offen offset:512 sc1
    s_mov_b64 exec, -1
    v_exp_f32 v203, v203
    v_exp_f32 v204, v204
    v_mfma_f32_32x32x16_bf16 v[184:199], v[216:219], v[136:139], 0
    v_exp_f32 v205, v205
    v_exp_f32 v206, v206
    v_exp_f32 v207, v207
    v_exp_f32 v208, v208
    v_exp_f32 v209, v209
    v_exp_f32 v210, v210
    v_smfmac_f32_32x32x32_bf16 v[32:47], v[220:223], v[200:207], v13
    v_exp_f32 v211, v211
    v_exp_f32 v212, v212
    v_exp_f32 v213, v213
    v_exp_f32 v214, v214
    v_exp_f32 v215, v215
    v_exp_f32 v184, v184
    v_exp_f32 v185, v185
    v_smfmac_f32_32x32x32_bf16 v[32:47], v[224:227], v[208:215], v13
    v_exp_f32 v186, v186
    buffer_load_dwordx4 v[172:175], v1, s[16:19], s79 offen offset:1024 sc1
    v_exp_f32 v187, v187
    v_exp_f32 v188, v188
    v_mfma_f32_32x32x16_bf16 v[200:215], v[216:219], v[140:143], 0
    v_exp_f32 v189, v189
    v_exp_f32 v190, v190
    v_exp_f32 v191, v191
    v_exp_f32 v192, v192
    v_exp_f32 v193, v193
    v_exp_f32 v194, v194
    v_smfmac_f32_32x32x32_bf16 v[48:63], v[220:223], v[184:191], v13
    v_exp_f32 v195, v195
    v_exp_f32 v196, v196
    v_exp_f32 v197, v197
    v_exp_f32 v198, v198
    v_exp_f32 v199, v199
    v_exp_f32 v200, v200
    v_exp_f32 v201, v201
    v_smfmac_f32_32x32x32_bf16 v[48:63], v[224:227], v[192:199], v13
    v_exp_f32 v202, v202
    s_mov_b64 exec, s[82:83]
    buffer_load_dwordx4 v[176:179], v8, s[16:19], s79 offen offset:1024 sc1
    buffer_load_dwordx4 v[180:183], v8, s[16:19], s79 offen offset:1536 sc1
    s_mov_b64 exec, -1
    v_exp_f32 v203, v203
    v_exp_f32 v204, v204
    v_mfma_f32_32x32x16_bf16 v[184:199], v[216:219], v[144:147], 0
    v_exp_f32 v205, v205
    v_exp_f32 v206, v206
    v_exp_f32 v207, v207
    v_exp_f32 v208, v208
    v_exp_f32 v209, v209
    v_exp_f32 v210, v210
    v_smfmac_f32_32x32x32_bf16 v[64:79], v[220:223], v[200:207], v13
    v_exp_f32 v211, v211
    v_exp_f32 v212, v212
    v_exp_f32 v213, v213
    v_exp_f32 v214, v214
    v_exp_f32 v215, v215
    v_exp_f32 v184, v184
    v_exp_f32 v185, v185
    v_smfmac_f32_32x32x32_bf16 v[64:79], v[224:227], v[208:215], v13
    v_exp_f32 v186, v186
    v_exp_f32 v187, v187
    v_exp_f32 v188, v188
    v_mfma_f32_32x32x16_bf16 v[200:215], v[216:219], v[148:151], 0
    v_exp_f32 v189, v189
    v_exp_f32 v190, v190
    v_exp_f32 v191, v191
    v_exp_f32 v192, v192
    v_exp_f32 v193, v193
    v_exp_f32 v194, v194
    v_smfmac_f32_32x32x32_bf16 v[80:95], v[220:223], v[184:191], v13
    v_exp_f32 v195, v195
    v_exp_f32 v196, v196
    v_exp_f32 v197, v197
    v_exp_f32 v198, v198
    v_exp_f32 v199, v199
    v_exp_f32 v200, v200
    v_exp_f32 v201, v201
    v_smfmac_f32_32x32x32_bf16 v[80:95], v[224:227], v[192:199], v13
    v_exp_f32 v202, v202
    v_exp_f32 v203, v203
    v_exp_f32 v204, v204
    v_mfma_f32_32x32x16_bf16 v[184:199], v[216:219], v[152:155], 0
    v_exp_f32 v205, v205
    v_exp_f32 v206, v206
    v_exp_f32 v207, v207
    v_exp_f32 v208, v208
    v_exp_f32 v209, v209
    v_exp_f32 v210, v210
    v_smfmac_f32_32x32x32_bf16 v[96:111], v[220:223], v[200:207], v13
    v_exp_f32 v211, v211
    v_exp_f32 v212, v212
    v_exp_f32 v213, v213
    v_exp_f32 v214, v214
    v_exp_f32 v215, v215
    v_exp_f32 v184, v184
    v_exp_f32 v185, v185
    v_smfmac_f32_32x32x32_bf16 v[96:111], v[224:227], v[208:215], v13
    v_exp_f32 v186, v186
    v_exp_f32 v187, v187
    v_exp_f32 v188, v188
    v_mfma_f32_32x32x16_bf16 v[200:215], v[216:219], v[156:159], 0
    v_exp_f32 v189, v189
    v_exp_f32 v190, v190
    v_exp_f32 v191, v191
    v_exp_f32 v192, v192
    v_exp_f32 v193, v193
    v_exp_f32 v194, v194
    v_smfmac_f32_32x32x32_bf16 v[112:127], v[220:223], v[184:191], v13
    v_exp_f32 v195, v195
    v_exp_f32 v196, v196
    v_exp_f32 v197, v197
    v_exp_f32 v198, v198
    v_exp_f32 v199, v199
    v_exp_f32 v200, v200
    v_exp_f32 v201, v201
    v_smfmac_f32_32x32x32_bf16 v[112:127], v[224:227], v[192:199], v13
    v_exp_f32 v202, v202
    v_exp_f32 v203, v203
    v_exp_f32 v204, v204
    v_mfma_f32_32x32x16_bf16 v[184:199], v[228:231], v[128:131], 0
    v_exp_f32 v205, v205
    v_exp_f32 v206, v206
    v_exp_f32 v207, v207
    v_exp_f32 v208, v208
    v_exp_f32 v209, v209
    v_exp_f32 v210, v210
    v_smfmac_f32_32x32x32_bf16 v[240:255], v[220:223], v[200:207], v13
    v_exp_f32 v211, v211
    v_exp_f32 v212, v212
    v_exp_f32 v213, v213
    v_exp_f32 v214, v214
    v_exp_f32 v215, v215
    v_exp_f32 v184, v184
    v_exp_f32 v185, v185
    v_smfmac_f32_32x32x32_bf16 v[240:255], v[224:227], v[208:215], v13
    v_exp_f32 v186, v186
    v_exp_f32 v187, v187
    v_exp_f32 v188, v188
    v_mfma_f32_32x32x16_bf16 v[200:215], v[228:231], v[132:135], 0
    v_exp_f32 v189, v189
    v_exp_f32 v190, v190
    v_exp_f32 v191, v191
    v_exp_f32 v192, v192
    v_exp_f32 v193, v193
    v_exp_f32 v194, v194
    v_smfmac_f32_32x32x32_bf16 v[16:31], v[232:235], v[184:191], v13
    v_exp_f32 v195, v195
    v_exp_f32 v196, v196
    v_exp_f32 v197, v197
    v_exp_f32 v198, v198
    v_exp_f32 v199, v199
    v_exp_f32 v200, v200
    v_exp_f32 v201, v201
    v_smfmac_f32_32x32x32_bf16 v[16:31], v[236:239], v[192:199], v13
    v_exp_f32 v202, v202
    v_exp_f32 v203, v203
    v_exp_f32 v204, v204
    v_mfma_f32_32x32x16_bf16 v[184:199], v[228:231], v[136:139], 0
    v_exp_f32 v205, v205
    v_exp_f32 v206, v206
    v_exp_f32 v207, v207
    v_exp_f32 v208, v208
    v_exp_f32 v209, v209
    v_exp_f32 v210, v210
    v_smfmac_f32_32x32x32_bf16 v[32:47], v[232:235], v[200:207], v13
    v_exp_f32 v211, v211
    v_exp_f32 v212, v212
    v_exp_f32 v213, v213
    v_exp_f32 v214, v214
    v_exp_f32 v215, v215
    v_exp_f32 v184, v184
    v_exp_f32 v185, v185
    v_smfmac_f32_32x32x32_bf16 v[32:47], v[236:239], v[208:215], v13
    v_exp_f32 v186, v186
    v_exp_f32 v187, v187
    v_exp_f32 v188, v188
    v_mfma_f32_32x32x16_bf16 v[200:215], v[228:231], v[140:143], 0
    v_exp_f32 v189, v189
    v_exp_f32 v190, v190
    v_exp_f32 v191, v191
    v_exp_f32 v192, v192
    v_exp_f32 v193, v193
    v_exp_f32 v194, v194
    v_smfmac_f32_32x32x32_bf16 v[48:63], v[232:235], v[184:191], v13
    v_exp_f32 v195, v195
    v_exp_f32 v196, v196
    v_exp_f32 v197, v197
    v_exp_f32 v198, v198
    v_exp_f32 v199, v199
    v_exp_f32 v200, v200
    v_exp_f32 v201, v201
    v_smfmac_f32_32x32x32_bf16 v[48:63], v[236:239], v[192:199], v13
    v_exp_f32 v202, v202
    v_exp_f32 v203, v203
    v_exp_f32 v204, v204
    v_mfma_f32_32x32x16_bf16 v[184:199], v[228:231], v[144:147], 0
    v_exp_f32 v205, v205
    v_exp_f32 v206, v206
    v_exp_f32 v207, v207
    v_exp_f32 v208, v208
    v_exp_f32 v209, v209
    v_exp_f32 v210, v210
    v_smfmac_f32_32x32x32_bf16 v[64:79], v[232:235], v[200:207], v13
    v_exp_f32 v211, v211
    v_exp_f32 v212, v212
    v_exp_f32 v213, v213
    v_exp_f32 v214, v214
    v_exp_f32 v215, v215
    v_exp_f32 v184, v184
    v_exp_f32 v185, v185
    v_smfmac_f32_32x32x32_bf16 v[64:79], v[236:239], v[208:215], v13
    v_exp_f32 v186, v186
    v_exp_f32 v187, v187
    v_exp_f32 v188, v188
    v_mfma_f32_32x32x16_bf16 v[200:215], v[228:231], v[148:151], 0
    v_exp_f32 v189, v189
    v_exp_f32 v190, v190
    v_exp_f32 v191, v191
    v_exp_f32 v192, v192
    v_exp_f32 v193, v193
    v_exp_f32 v194, v194
    v_smfmac_f32_32x32x32_bf16 v[80:95], v[232:235], v[184:191], v13
    v_exp_f32 v195, v195
    v_exp_f32 v196, v196
    v_exp_f32 v197, v197
    v_exp_f32 v198, v198
    v_exp_f32 v199, v199
    v_exp_f32 v200, v200
    v_exp_f32 v201, v201
    v_smfmac_f32_32x32x32_bf16 v[80:95], v[236:239], v[192:199], v13
    v_exp_f32 v202, v202
    v_exp_f32 v203, v203
    v_exp_f32 v204, v204
    v_mfma_f32_32x32x16_bf16 v[184:199], v[228:231], v[152:155], 0
    v_exp_f32 v205, v205
    v_exp_f32 v206, v206
    v_exp_f32 v207, v207
    v_exp_f32 v208, v208
    v_exp_f32 v209, v209
    v_exp_f32 v210, v210
    v_smfmac_f32_32x32x32_bf16 v[96:111], v[232:235], v[200:207], v13
    v_exp_f32 v211, v211
    v_exp_f32 v212, v212
    v_exp_f32 v213, v213
    v_exp_f32 v214, v214
    v_exp_f32 v215, v215
    v_exp_f32 v184, v184
    v_exp_f32 v185, v185
    v_smfmac_f32_32x32x32_bf16 v[96:111], v[236:239], v[208:215], v13
    v_exp_f32 v186, v186
    v_exp_f32 v187, v187
    v_exp_f32 v188, v188
    v_mfma_f32_32x32x16_bf16 v[200:215], v[228:231], v[156:159], 0
    v_exp_f32 v189, v189
    v_exp_f32 v190, v190
    v_exp_f32 v191, v191
    v_exp_f32 v192, v192
    v_exp_f32 v193, v193
    v_exp_f32 v194, v194
    v_smfmac_f32_32x32x32_bf16 v[112:127], v[232:235], v[184:191], v13
    v_exp_f32 v195, v195
    v_exp_f32 v196, v196
    v_exp_f32 v197, v197
    v_exp_f32 v198, v198
    v_exp_f32 v199, v199
    v_exp_f32 v200, v200
    v_exp_f32 v201, v201
    v_smfmac_f32_32x32x32_bf16 v[112:127], v[236:239], v[192:199], v13
    v_exp_f32 v202, v202
    v_exp_f32 v203, v203
    v_exp_f32 v204, v204
    s_waitcnt vmcnt(0)
    v_mfma_f32_32x32x16_bf16 v[184:199], v[160:163], v[128:131], 0
    v_exp_f32 v205, v205
    v_exp_f32 v206, v206
    v_exp_f32 v207, v207
    v_exp_f32 v208, v208
    v_exp_f32 v209, v209
    v_exp_f32 v210, v210
    v_smfmac_f32_32x32x32_bf16 v[240:255], v[232:235], v[200:207], v13
    v_exp_f32 v211, v211
    v_exp_f32 v212, v212
    v_exp_f32 v213, v213
    v_exp_f32 v214, v214
    v_exp_f32 v215, v215
L_att:
    v_exp_f32 v184, v184
    v_exp_f32 v185, v185
    v_smfmac_f32_32x32x32_bf16 v[240:255], v[236:239], v[208:215], v13
    v_exp_f32 v186, v186
    buffer_load_dwordx4 v[216:219], v1, s[16:19], s79 offen offset:2048 sc1
    v_exp_f32 v187, v187
    v_exp_f32 v188, v188
    v_mfma_f32_32x32x16_bf16 v[200:215], v[160:163], v[132:135], 0
    v_exp_f32 v189, v189
    v_exp_f32 v190, v190
    v_exp_f32 v191, v191
    v_exp_f32 v192, v192
    v_exp_f32 v193, v193
    v_exp_f32 v194, v194
    v_smfmac_f32_32x32x32_bf16 v[16:31], v[164:167], v[184:191], v13
    v_exp_f32 v195, v195
    v_exp_f32 v196, v196
    v_exp_f32 v197, v197
    v_exp_f32 v198, v198
    v_exp_f32 v199, v199
    v_exp_f32 v200, v200
    v_exp_f32 v201, v201
    v_smfmac_f32_32x32x32_bf16 v[16:31], v[168:171], v[192:199], v13
    v_exp_f32 v202, v202
    s_mov_b64 exec, s[82:83]
    buffer_load_dwordx4 v[220:223], v8, s[16:19], s79 offen offset:2048 sc1
    buffer_load_dwordx4 v[224:227], v8, s[16:19], s79 offen offset:2560 sc1
    s_mov_b64 exec, -1
    v_exp_f32 v203, v203
    v_exp_f32 v204, v204
    v_mfma_f32_32x32x16_bf16 v[184:199], v[160:163], v[136:139], 0
    v_exp_f32 v205, v205
    v_exp_f32 v206, v206
    v_exp_f32 v207, v207
    v_exp_f32 v208, v208
    v_exp_f32 v209, v209
    v_exp_f32 v210, v210
    v_smfmac_f32_32x32x32_bf16 v[32:47], v[164:167], v[200:207], v13
    v_exp_f32 v211, v211
    v_exp_f32 v212, v212
    v_exp_f32 v213, v213
    v_exp_f32 v214, v214
    v_exp_f32 v215, v215
    v_exp_f32 v184, v184
    v_exp_f32 v185, v185
    v_smfmac_f32_32x32x32_bf16 v[32:47], v[168:171], v[208:215], v13
    v_exp_f32 v186, v186
    buffer_load_dwordx4 v[228:231], v1, s[16:19], s79 offen offset:3072 sc1
    v_exp_f32 v187, v187
    v_exp_f32 v188, v188
    v_mfma_f32_32x32x16_bf16 v[200:215], v[160:163], v[140:143], 0
    v_exp_f32 v189, v189
    v_exp_f32 v190, v190
    v_exp_f32 v191, v191
    v_exp_f32 v192, v192
    v_exp_f32 v193, v193
    v_exp_f32 v194, v194
    v_smfmac_f32_32x32x32_bf16 v[48:63], v[164:167], v[184:191], v13
    v_exp_f32 v195, v195
    v_exp_f32 v196, v196
    v_exp_f32 v197, v197
    v_exp_f32 v198, v198
    v_exp_f32 v199, v199
    v_exp_f32 v200, v200
    v_exp_f32 v201, v201
    v_smfmac_f32_32x32x32_bf16 v[48:63], v[168:171], v[192:199], v13
    v_exp_f32 v202, v202
    s_mov_b64 exec, s[82:83]
    buffer_load_dwordx4 v[232:235], v8, s[16:19], s79 offen offset:3072 sc1
    buffer_load_dwordx4 v[236:239], v8, s[16:19], s79 offen offset:3584 sc1
    s_mov_b64 exec, -1
    v_exp_f32 v203, v203
    v_exp_f32 v204, v204
    v_mfma_f32_32x32x16_bf16 v[184:199], v[160:163], v[144:147], 0
    v_exp_f32 v205, v205
    v_exp_f32 v206, v206
    v_exp_f32 v207, v207
    v_exp_f32 v208, v208
    v_exp_f32 v209, v209
    v_exp_f32 v210, v210
    v_smfmac_f32_32x32x32_bf16 v[64:79], v[164:167], v[200:207], v13
    v_exp_f32 v211, v211
    v_exp_f32 v212, v212
    v_exp_f32 v213, v213
    v_exp_f32 v214, v214
    v_exp_f32 v215, v215
    v_exp_f32 v184, v184
    v_exp_f32 v185, v185
    v_smfmac_f32_32x32x32_bf16 v[64:79], v[168:171], v[208:215], v13
    v_exp_f32 v186, v186
    v_exp_f32 v187, v187
    v_exp_f32 v188, v188
    v_mfma_f32_32x32x16_bf16 v[200:215], v[160:163], v[148:151], 0
    v_exp_f32 v189, v189
    v_exp_f32 v190, v190
    v_exp_f32 v191, v191
    v_exp_f32 v192, v192
    v_exp_f32 v193, v193
    v_exp_f32 v194, v194
    v_smfmac_f32_32x32x32_bf16 v[80:95], v[164:167], v[184:191], v13
    v_exp_f32 v195, v195
    v_exp_f32 v196, v196
    v_exp_f32 v197, v197
    v_exp_f32 v198, v198
    v_exp_f32 v199, v199
    v_exp_f32 v200, v200
    v_exp_f32 v201, v201
    v_smfmac_f32_32x32x32_bf16 v[80:95], v[168:171], v[192:199], v13
    v_exp_f32 v202, v202
    v_exp_f32 v203, v203
    v_exp_f32 v204, v204
    v_mfma_f32_32x32x16_bf16 v[184:199], v[160:163], v[152:155], 0
    v_exp_f32 v205, v205
    v_exp_f32 v206, v206
    v_exp_f32 v207, v207
    v_exp_f32 v208, v208
    v_exp_f32 v209, v209
    v_exp_f32 v210, v210
    v_smfmac_f32_32x32x32_bf16 v[96:111], v[164:167], v[200:207], v13
    v_exp_f32 v211, v211
    v_exp_f32 v212, v212
    v_exp_f32 v213, v213
    v_exp_f32 v214, v214
    v_exp_f32 v215, v215
    v_exp_f32 v184, v184
    v_exp_f32 v185, v185
    v_smfmac_f32_32x32x32_bf16 v[96:111], v[168:171], v[208:215], v13
    v_exp_f32 v186, v186
    v_exp_f32 v187, v187
    v_exp_f32 v188, v188
    v_mfma_f32_32x32x16_bf16 v[200:215], v[160:163], v[156:159], 0
    v_exp_f32 v189, v189
    v_exp_f32 v190, v190
    v_exp_f32 v191, v191
    v_exp_f32 v192, v192
    v_exp_f32 v193, v193
    v_exp_f32 v194, v194
    v_smfmac_f32_32x32x32_bf16 v[112:127], v[164:167], v[184:191], v13
    v_exp_f32 v195, v195
    v_exp_f32 v196, v196
    v_exp_f32 v197, v197
    v_exp_f32 v198, v198
    v_exp_f32 v199, v199
    v_exp_f32 v200, v200
    v_exp_f32 v201, v201
    v_smfmac_f32_32x32x32_bf16 v[112:127], v[168:171], v[192:199], v13
    v_exp_f32 v202, v202
    v_exp_f32 v203, v203
    v_exp_f32 v204, v204
    v_mfma_f32_32x32x16_bf16 v[184:199], v[172:175], v[128:131], 0
    v_exp_f32 v205, v205
    v_exp_f32 v206, v206
    v_exp_f32 v207, v207
    v_exp_f32 v208, v208
    v_exp_f32 v209, v209
    v_exp_f32 v210, v210
    v_smfmac_f32_32x32x32_bf16 v[240:255], v[164:167], v[200:207], v13
    v_exp_f32 v211, v211
    v_exp_f32 v212, v212
    v_exp_f32 v213, v213
    v_exp_f32 v214, v214
    v_exp_f32 v215, v215
    v_exp_f32 v184, v184
    v_exp_f32 v185, v185
    v_smfmac_f32_32x32x32_bf16 v[240:255], v[168:171], v[208:215], v13
    v_exp_f32 v186, v186
    v_exp_f32 v187, v187
    v_exp_f32 v188, v188
    v_mfma_f32_32x32x16_bf16 v[200:215], v[172:175], v[132:135], 0
    v_exp_f32 v189, v189
    v_exp_f32 v190, v190
    v_exp_f32 v191, v191
    v_exp_f32 v192, v192
    v_exp_f32 v193, v193
    v_exp_f32 v194, v194
    v_smfmac_f32_32x32x32_bf16 v[16:31], v[176:179], v[184:191], v13
    v_exp_f32 v195, v195
    v_exp_f32 v196, v196
    v_exp_f32 v197, v197
    v_exp_f32 v198, v198
    v_exp_f32 v199, v199
    v_exp_f32 v200, v200
    v_exp_f32 v201, v201
    v_smfmac_f32_32x32x32_bf16 v[16:31], v[180:183], v[192:199], v13
    v_exp_f32 v202, v202
    v_exp_f32 v203, v203
    v_exp_f32 v204, v204
    v_mfma_f32_32x32x16_bf16 v[184:199], v[172:175], v[136:139], 0
    v_exp_f32 v205, v205
    v_exp_f32 v206, v206
    v_exp_f32 v207, v207
    v_exp_f32 v208, v208
    v_exp_f32 v209, v209
    v_exp_f32 v210, v210
    v_smfmac_f32_32x32x32_bf16 v[32:47], v[176:179], v[200:207], v13
    v_exp_f32 v211, v211
    v_exp_f32 v212, v212
    v_exp_f32 v213, v213
    v_exp_f32 v214, v214
    v_exp_f32 v215, v215
    v_exp_f32 v184, v184
    v_exp_f32 v185, v185
    v_smfmac_f32_32x32x32_bf16 v[32:47], v[180:183], v[208:215], v13
    v_exp_f32 v186, v186
    v_exp_f32 v187, v187
    v_exp_f32 v188, v188
    v_mfma_f32_32x32x16_bf16 v[200:215], v[172:175], v[140:143], 0
    v_exp_f32 v189, v189
    v_exp_f32 v190, v190
    v_exp_f32 v191, v191
    v_exp_f32 v192, v192
    v_exp_f32 v193, v193
    v_exp_f32 v194, v194
    v_smfmac_f32_32x32x32_bf16 v[48:63], v[176:179], v[184:191], v13
    v_exp_f32 v195, v195
    v_exp_f32 v196, v196
    v_exp_f32 v197, v197
    v_exp_f32 v198, v198
    v_exp_f32 v199, v199
    v_exp_f32 v200, v200
    v_exp_f32 v201, v201
    v_smfmac_f32_32x32x32_bf16 v[48:63], v[180:183], v[192:199], v13
    v_exp_f32 v202, v202
    v_exp_f32 v203, v203
    v_exp_f32 v204, v204
    v_mfma_f32_32x32x16_bf16 v[184:199], v[172:175], v[144:147], 0
    v_exp_f32 v205, v205
    v_exp_f32 v206, v206
    v_exp_f32 v207, v207
    v_exp_f32 v208, v208
    v_exp_f32 v209, v209
    v_exp_f32 v210, v210
    v_smfmac_f32_32x32x32_bf16 v[64:79], v[176:179], v[200:207], v13
    v_exp_f32 v211, v211
    v_exp_f32 v212, v212
    v_exp_f32 v213, v213
    v_exp_f32 v214, v214
    v_exp_f32 v215, v215
    v_exp_f32 v184, v184
    v_exp_f32 v185, v185
    v_smfmac_f32_32x32x32_bf16 v[64:79], v[180:183], v[208:215], v13
    v_exp_f32 v186, v186
    v_exp_f32 v187, v187
    v_exp_f32 v188, v188
    v_mfma_f32_32x32x16_bf16 v[200:215], v[172:175], v[148:151], 0
    v_exp_f32 v189, v189
    v_exp_f32 v190, v190
    v_exp_f32 v191, v191
    v_exp_f32 v192, v192
    v_exp_f32 v193, v193
    v_exp_f32 v194, v194
    v_smfmac_f32_32x32x32_bf16 v[80:95], v[176:179], v[184:191], v13
    v_exp_f32 v195, v195
    v_exp_f32 v196, v196
    v_exp_f32 v197, v197
    v_exp_f32 v198, v198
    v_exp_f32 v199, v199
    v_exp_f32 v200, v200
    v_exp_f32 v201, v201
    v_smfmac_f32_32x32x32_bf16 v[80:95], v[180:183], v[192:199], v13
    v_exp_f32 v202, v202
    v_exp_f32 v203, v203
    v_exp_f32 v204, v204
    v_mfma_f32_32x32x16_bf16 v[184:199], v[172:175], v[152:155], 0
    v_exp_f32 v205, v205
    v_exp_f32 v206, v206
    v_exp_f32 v207, v207
    v_exp_f32 v208, v208
    v_exp_f32 v209, v209
    v_exp_f32 v210, v210
    v_smfmac_f32_32x32x32_bf16 v[96:111], v[176:179], v[200:207], v13
    v_exp_f32 v211, v211
    v_exp_f32 v212, v212
    v_exp_f32 v213, v213
    v_exp_f32 v214, v214
    v_exp_f32 v215, v215
    v_exp_f32 v184, v184
    v_exp_f32 v185, v185
    v_smfmac_f32_32x32x32_bf16 v[96:111], v[180:183], v[208:215], v13
    v_exp_f32 v186, v186
    v_exp_f32 v187, v187
    v_exp_f32 v188, v188
    v_mfma_f32_32x32x16_bf16 v[200:215], v[172:175], v[156:159], 0
    v_exp_f32 v189, v189
    v_exp_f32 v190, v190
    v_exp_f32 v191, v191
    v_exp_f32 v192, v192
    v_exp_f32 v193, v193
    v_exp_f32 v194, v194
    v_smfmac_f32_32x32x32_bf16 v[112:127], v[176:179], v[184:191], v13
    v_exp_f32 v195, v195
    v_exp_f32 v196, v196
    v_exp_f32 v197, v197
    v_exp_f32 v198, v198
    v_exp_f32 v199, v199
    v_exp_f32 v200, v200
    v_exp_f32 v201, v201
    v_smfmac_f32_32x32x32_bf16 v[112:127], v[180:183], v[192:199], v13
    v_exp_f32 v202, v202
    v_exp_f32 v203, v203
    v_exp_f32 v204, v204
    s_waitcnt vmcnt(0)
    v_mfma_f32_32x32x16_bf16 v[184:199], v[216:219], v[128:131], 0
    v_exp_f32 v205, v205
    v_exp_f32 v206, v206
    v_exp_f32 v207, v207
    v_exp_f32 v208, v208
    v_exp_f32 v209, v209
    v_exp_f32 v210, v210
    v_smfmac_f32_32x32x32_bf16 v[240:255], v[176:179], v[200:207], v13
    v_exp_f32 v211, v211
    v_exp_f32 v212, v212
    v_exp_f32 v213, v213
    v_exp_f32 v214, v214
    v_exp_f32 v215, v215
    v_exp_f32 v184, v184
    v_exp_f32 v185, v185
    v_smfmac_f32_32x32x32_bf16 v[240:255], v[180:183], v[208:215], v13
    v_exp_f32 v186, v186
    s_add_u32 s79, s79, 4096
    buffer_load_dwordx4 v[160:163], v1, s[16:19], s79 offen offset:0 sc1
    v_exp_f32 v187, v187
    v_exp_f32 v188, v188
    v_mfma_f32_32x32x16_bf16 v[200:215], v[216:219], v[132:135], 0
    v_exp_f32 v189, v189
    v_exp_f32 v190, v190
    v_exp_f32 v191, v191
    v_exp_f32 v192, v192
    v_exp_f32 v193, v193
    v_exp_f32 v194, v194
    v_smfmac_f32_32x32x32_bf16 v[16:31], v[220:223], v[184:191], v13
    v_exp_f32 v195, v195
    v_exp_f32 v196, v196
    v_exp_f32 v197, v197
    v_exp_f32 v198, v198
    v_exp_f32 v199, v199
    v_exp_f32 v200, v200
    v_exp_f32 v201, v201
    v_smfmac_f32_32x32x32_bf16 v[16:31], v[224:227], v[192:199], v13
    v_exp_f32 v202, v202
    s_mov_b64 exec, s[82:83]
    buffer_load_dwordx4 v[164:167], v8, s[16:19], s79 offen offset:0 sc1
    buffer_load_dwordx4 v[168:171], v8, s[16:19], s79 offen offset:512 sc1
    s_mov_b64 exec, -1
    v_exp_f32 v203, v203
    v_exp_f32 v204, v204
    v_mfma_f32_32x32x16_bf16 v[184:199], v[216:219], v[136:139], 0
    v_exp_f32 v205, v205
    v_exp_f32 v206, v206
    v_exp_f32 v207, v207
    v_exp_f32 v208, v208
    v_exp_f32 v209, v209
    v_exp_f32 v210, v210
    v_smfmac_f32_32x32x32_bf16 v[32:47], v[220:223], v[200:207], v13
    v_exp_f32 v211, v211
    v_exp_f32 v212, v212
    v_exp_f32 v213, v213
    v_exp_f32 v214, v214
    v_exp_f32 v215, v215
    v_exp_f32 v184, v184
    v_exp_f32 v185, v185
    v_smfmac_f32_32x32x32_bf16 v[32:47], v[224:227], v[208:215], v13
    v_exp_f32 v186, v186
    buffer_load_dwordx4 v[172:175], v1, s[16:19], s79 offen offset:1024 sc1
    v_exp_f32 v187, v187
    v_exp_f32 v188, v188
    v_mfma_f32_32x32x16_bf16 v[200:215], v[216:219], v[140:143], 0
    v_exp_f32 v189, v189
    v_exp_f32 v190, v190
    v_exp_f32 v191, v191
    v_exp_f32 v192, v192
    v_exp_f32 v193, v193
    v_exp_f32 v194, v194
    v_smfmac_f32_32x32x32_bf16 v[48:63], v[220:223], v[184:191], v13
    v_exp_f32 v195, v195
    v_exp_f32 v196, v196
    v_exp_f32 v197, v197
    v_exp_f32 v198, v198
    v_exp_f32 v199, v199
    v_exp_f32 v200, v200
    v_exp_f32 v201, v201
    v_smfmac_f32_32x32x32_bf16 v[48:63], v[224:227], v[192:199], v13
    v_exp_f32 v202, v202
    s_mov_b64 exec, s[82:83]
    buffer_load_dwordx4 v[176:179], v8, s[16:19], s79 offen offset:1024 sc1
    buffer_load_dwordx4 v[180:183], v8, s[16:19], s79 offen offset:1536 sc1
    s_mov_b64 exec, -1
    v_exp_f32 v203, v203
    v_exp_f32 v204, v204
    v_mfma_f32_32x32x16_bf16 v[184:199], v[216:219], v[144:147], 0
    v_exp_f32 v205, v205
    v_exp_f32 v206, v206
    v_exp_f32 v207, v207
    v_exp_f32 v208, v208
    v_exp_f32 v209, v209
    v_exp_f32 v210, v210
    v_smfmac_f32_32x32x32_bf16 v[64:79], v[220:223], v[200:207], v13
    v_exp_f32 v211, v211
    v_exp_f32 v212, v212
    v_exp_f32 v213, v213
    v_exp_f32 v214, v214
    v_exp_f32 v215, v215
    v_exp_f32 v184, v184
    v_exp_f32 v185, v185
    v_smfmac_f32_32x32x32_bf16 v[64:79], v[224:227], v[208:215], v13
    v_exp_f32 v186, v186
    v_exp_f32 v187, v187
    v_exp_f32 v188, v188
    v_mfma_f32_32x32x16_bf16 v[200:215], v[216:219], v[148:151], 0
    v_exp_f32 v189, v189
    v_exp_f32 v190, v190
    v_exp_f32 v191, v191
    v_exp_f32 v192, v192
    v_exp_f32 v193, v193
    v_exp_f32 v194, v194
    v_smfmac_f32_32x32x32_bf16 v[80:95], v[220:223], v[184:191], v13
    v_exp_f32 v195, v195
    v_exp_f32 v196, v196
    v_exp_f32 v197, v197
    v_exp_f32 v198, v198
    v_exp_f32 v199, v199
    v_exp_f32 v200, v200
    v_exp_f32 v201, v201
    v_smfmac_f32_32x32x32_bf16 v[80:95], v[224:227], v[192:199], v13
    v_exp_f32 v202, v202
    v_exp_f32 v203, v203
    v_exp_f32 v204, v204
    v_mfma_f32_32x32x16_bf16 v[184:199], v[216:219], v[152:155], 0
    v_exp_f32 v205, v205
    v_exp_f32 v206, v206
    v_exp_f32 v207, v207
    v_exp_f32 v208, v208
    v_exp_f32 v209, v209
    v_exp_f32 v210, v210
    v_smfmac_f32_32x32x32_bf16 v[96:111], v[220:223], v[200:207], v13
    v_exp_f32 v211, v211
    v_exp_f32 v212, v212
    v_exp_f32 v213, v213
    v_exp_f32 v214, v214
    v_exp_f32 v215, v215
    v_exp_f32 v184, v184
    v_exp_f32 v185, v185
    v_smfmac_f32_32x32x32_bf16 v[96:111], v[224:227], v[208:215], v13
    v_exp_f32 v186, v186
    v_exp_f32 v187, v187
    v_exp_f32 v188, v188
    v_mfma_f32_32x32x16_bf16 v[200:215], v[216:219], v[156:159], 0
    v_exp_f32 v189, v189
    v_exp_f32 v190, v190
    v_exp_f32 v191, v191
    v_exp_f32 v192, v192
    v_exp_f32 v193, v193
    v_exp_f32 v194, v194
    v_smfmac_f32_32x32x32_bf16 v[112:127], v[220:223], v[184:191], v13
    v_exp_f32 v195, v195
    v_exp_f32 v196, v196
    v_exp_f32 v197, v197
    v_exp_f32 v198, v198
    v_exp_f32 v199, v199
    v_exp_f32 v200, v200
    v_exp_f32 v201, v201
    v_smfmac_f32_32x32x32_bf16 v[112:127], v[224:227], v[192:199], v13
    v_exp_f32 v202, v202
    v_exp_f32 v203, v203
    v_exp_f32 v204, v204
    v_mfma_f32_32x32x16_bf16 v[184:199], v[228:231], v[128:131], 0
    v_exp_f32 v205, v205
    v_exp_f32 v206, v206
    v_exp_f32 v207, v207
    v_exp_f32 v208, v208
    v_exp_f32 v209, v209
    v_exp_f32 v210, v210
    v_smfmac_f32_32x32x32_bf16 v[240:255], v[220:223], v[200:207], v13
    v_exp_f32 v211, v211
    v_exp_f32 v212, v212
    v_exp_f32 v213, v213
    v_exp_f32 v214, v214
    v_exp_f32 v215, v215
    v_exp_f32 v184, v184
    v_exp_f32 v185, v185
    v_smfmac_f32_32x32x32_bf16 v[240:255], v[224:227], v[208:215], v13
    v_exp_f32 v186, v186
    v_exp_f32 v187, v187
    v_exp_f32 v188, v188
    v_mfma_f32_32x32x16_bf16 v[200:215], v[228:231], v[132:135], 0
    v_exp_f32 v189, v189
    v_exp_f32 v190, v190
    v_exp_f32 v191, v191
    v_exp_f32 v192, v192
    v_exp_f32 v193, v193
    v_exp_f32 v194, v194
    v_smfmac_f32_32x32x32_bf16 v[16:31], v[232:235], v[184:191], v13
    v_exp_f32 v195, v195
    v_exp_f32 v196, v196
    v_exp_f32 v197, v197
    v_exp_f32 v198, v198
    v_exp_f32 v199, v199
    v_exp_f32 v200, v200
    v_exp_f32 v201, v201
    v_smfmac_f32_32x32x32_bf16 v[16:31], v[236:239], v[192:199], v13
    v_exp_f32 v202, v202
    v_exp_f32 v203, v203
    v_exp_f32 v204, v204
    v_mfma_f32_32x32x16_bf16 v[184:199], v[228:231], v[136:139], 0
    v_exp_f32 v205, v205
    v_exp_f32 v206, v206
    v_exp_f32 v207, v207
    v_exp_f32 v208, v208
    v_exp_f32 v209, v209
    v_exp_f32 v210, v210
    v_smfmac_f32_32x32x32_bf16 v[32:47], v[232:235], v[200:207], v13
    v_exp_f32 v211, v211
    v_exp_f32 v212, v212
    v_exp_f32 v213, v213
    v_exp_f32 v214, v214
    v_exp_f32 v215, v215
    v_exp_f32 v184, v184
    v_exp_f32 v185, v185
    v_smfmac_f32_32x32x32_bf16 v[32:47], v[236:239], v[208:215], v13
    v_exp_f32 v186, v186
    v_exp_f32 v187, v187
    v_exp_f32 v188, v188
    v_mfma_f32_32x32x16_bf16 v[200:215], v[228:231], v[140:143], 0
    v_exp_f32 v189, v189
    v_exp_f32 v190, v190
    v_exp_f32 v191, v191
    v_exp_f32 v192, v192
    v_exp_f32 v193, v193
    v_exp_f32 v194, v194
    v_smfmac_f32_32x32x32_bf16 v[48:63], v[232:235], v[184:191], v13
    v_exp_f32 v195, v195
    v_exp_f32 v196, v196
    v_exp_f32 v197, v197
    v_exp_f32 v198, v198
    v_exp_f32 v199, v199
    v_exp_f32 v200, v200
    v_exp_f32 v201, v201
    v_smfmac_f32_32x32x32_bf16 v[48:63], v[236:239], v[192:199], v13
    v_exp_f32 v202, v202
    v_exp_f32 v203, v203
    v_exp_f32 v204, v204
    v_mfma_f32_32x32x16_bf16 v[184:199], v[228:231], v[144:147], 0
    v_exp_f32 v205, v205
    v_exp_f32 v206, v206
    v_exp_f32 v207, v207
    v_exp_f32 v208, v208
    v_exp_f32 v209, v209
    v_exp_f32 v210, v210
    v_smfmac_f32_32x32x32_bf16 v[64:79], v[232:235], v[200:207], v13
    v_exp_f32 v211, v211
    v_exp_f32 v212, v212
    v_exp_f32 v213, v213
    v_exp_f32 v214, v214
    v_exp_f32 v215, v215
    v_exp_f32 v184, v184
    v_exp_f32 v185, v185
    v_smfmac_f32_32x32x32_bf16 v[64:79], v[236:239], v[208:215], v13
    v_exp_f32 v186, v186
    v_exp_f32 v187, v187
    v_exp_f32 v188, v188
    v_mfma_f32_32x32x16_bf16 v[200:215], v[228:231], v[148:151], 0
    v_exp_f32 v189, v189
    v_exp_f32 v190, v190
    v_exp_f32 v191, v191
    v_exp_f32 v192, v192
    v_exp_f32 v193, v193
    v_exp_f32 v194, v194
    v_smfmac_f32_32x32x32_bf16 v[80:95], v[232:235], v[184:191], v13
    v_exp_f32 v195, v195
    v_exp_f32 v196, v196
    v_exp_f32 v197, v197
    v_exp_f32 v198, v198
    v_exp_f32 v199, v199
    v_exp_f32 v200, v200
    v_exp_f32 v201, v201
    v_smfmac_f32_32x32x32_bf16 v[80:95], v[236:239], v[192:199], v13
    v_exp_f32 v202, v202
    v_exp_f32 v203, v203
    v_exp_f32 v204, v204
    v_mfma_f32_32x32x16_bf16 v[184:199], v[228:231], v[152:155], 0
    v_exp_f32 v205, v205
    v_exp_f32 v206, v206
    v_exp_f32 v207, v207
    v_exp_f32 v208, v208
    v_exp_f32 v209, v209
    v_exp_f32 v210, v210
    v_smfmac_f32_32x32x32_bf16 v[96:111], v[232:235], v[200:207], v13
    v_exp_f32 v211, v211
    v_exp_f32 v212, v212
    v_exp_f32 v213, v213
    v_exp_f32 v214, v214
    v_exp_f32 v215, v215
    v_exp_f32 v184, v184
    v_exp_f32 v185, v185
    v_smfmac_f32_32x32x32_bf16 v[96:111], v[236:239], v[208:215], v13
    v_exp_f32 v186, v186
    v_exp_f32 v187, v187
    v_exp_f32 v188, v188
    v_mfma_f32_32x32x16_bf16 v[200:215], v[228:231], v[156:159], 0
    v_exp_f32 v189, v189
    v_exp_f32 v190, v190
    v_exp_f32 v191, v191
    v_exp_f32 v192, v192
    v_exp_f32 v193, v193
    v_exp_f32 v194, v194
    v_smfmac_f32_32x32x32_bf16 v[112:127], v[232:235], v[184:191], v13
    v_exp_f32 v195, v195
    v_exp_f32 v196, v196
    v_exp_f32 v197, v197
    v_exp_f32 v198, v198
    v_exp_f32 v199, v199
    v_exp_f32 v200, v200
    v_exp_f32 v201, v201
    v_smfmac_f32_32x32x32_bf16 v[112:127], v[236:239], v[192:199], v13
    v_exp_f32 v202, v202
    v_exp_f32 v203, v203
    v_exp_f32 v204, v204
    s_waitcnt vmcnt(0)
    v_mfma_f32_32x32x16_bf16 v[184:199], v[160:163], v[128:131], 0
    v_exp_f32 v205, v205
    v_exp_f32 v206, v206
    v_exp_f32 v207, v207
    v_exp_f32 v208, v208
    v_exp_f32 v209, v209
    v_exp_f32 v210, v210
    v_smfmac_f32_32x32x32_bf16 v[240:255], v[232:235], v[200:207], v13
    v_exp_f32 v211, v211
    v_exp_f32 v212, v212
    v_exp_f32 v213, v213
    v_exp_f32 v214, v214
    v_exp_f32 v215, v215
    s_cmp_lg_u32 s51, s79
    s_cbranch_scc1 L_att
L_lastbody:
    v_exp_f32 v184, v184
    v_exp_f32 v185, v185
    v_smfmac_f32_32x32x32_bf16 v[240:255], v[236:239], v[208:215], v13
    v_exp_f32 v186, v186
    buffer_load_dwordx4 v[216:219], v1, s[16:19], s79 offen offset:2048 sc1
    v_exp_f32 v187, v187
    v_exp_f32 v188, v188
    v_mfma_f32_32x32x16_bf16 v[200:215], v[160:163], v[132:135], 0
    v_exp_f32 v189, v189
    v_exp_f32 v190, v190
    v_exp_f32 v191, v191
    v_exp_f32 v192, v192
    v_exp_f32 v193, v193
    v_exp_f32 v194, v194
    v_smfmac_f32_32x32x32_bf16 v[16:31], v[164:167], v[184:191], v13
    v_exp_f32 v195, v195
    v_exp_f32 v196, v196
    v_exp_f32 v197, v197
    v_exp_f32 v198, v198
    v_exp_f32 v199, v199
    v_exp_f32 v200, v200
    v_exp_f32 v201, v201
    v_smfmac_f32_32x32x32_bf16 v[16:31], v[168:171], v[192:199], v13
    v_exp_f32 v202, v202
    s_mov_b64 exec, s[82:83]
    buffer_load_dwordx4 v[220:223], v8, s[16:19], s79 offen offset:2048 sc1
    buffer_load_dwordx4 v[224:227], v8, s[16:19], s79 offen offset:2560 sc1
    s_mov_b64 exec, -1
    v_exp_f32 v203, v203
    v_exp_f32 v204, v204
    v_mfma_f32_32x32x16_bf16 v[184:199], v[160:163], v[136:139], 0
    v_exp_f32 v205, v205
    v_exp_f32 v206, v206
    v_exp_f32 v207, v207
    v_exp_f32 v208, v208
    v_exp_f32 v209, v209
    v_exp_f32 v210, v210
    v_smfmac_f32_32x32x32_bf16 v[32:47], v[164:167], v[200:207], v13
    v_exp_f32 v211, v211
    v_exp_f32 v212, v212
    v_exp_f32 v213, v213
    v_exp_f32 v214, v214
    v_exp_f32 v215, v215
    v_exp_f32 v184, v184
    v_exp_f32 v185, v185
    v_smfmac_f32_32x32x32_bf16 v[32:47], v[168:171], v[208:215], v13
    v_exp_f32 v186, v186
    buffer_load_dwordx4 v[228:231], v1, s[16:19], s79 offen offset:3072 sc1
    v_exp_f32 v187, v187
    v_exp_f32 v188, v188
    v_mfma_f32_32x32x16_bf16 v[200:215], v[160:163], v[140:143], 0
    v_exp_f32 v189, v189
    v_exp_f32 v190, v190
    v_exp_f32 v191, v191
    v_exp_f32 v192, v192
    v_exp_f32 v193, v193
    v_exp_f32 v194, v194
    v_smfmac_f32_32x32x32_bf16 v[48:63], v[164:167], v[184:191], v13
    v_exp_f32 v195, v195
    v_exp_f32 v196, v196
    v_exp_f32 v197, v197
    v_exp_f32 v198, v198
    v_exp_f32 v199, v199
    v_exp_f32 v200, v200
    v_exp_f32 v201, v201
    v_smfmac_f32_32x32x32_bf16 v[48:63], v[168:171], v[192:199], v13
    v_exp_f32 v202, v202
    s_mov_b64 exec, s[82:83]
    buffer_load_dwordx4 v[232:235], v8, s[16:19], s79 offen offset:3072 sc1
    buffer_load_dwordx4 v[236:239], v8, s[16:19], s79 offen offset:3584 sc1
    s_mov_b64 exec, -1
    v_exp_f32 v203, v203
    v_exp_f32 v204, v204
    v_mfma_f32_32x32x16_bf16 v[184:199], v[160:163], v[144:147], 0
    v_exp_f32 v205, v205
    v_exp_f32 v206, v206
    v_exp_f32 v207, v207
    v_exp_f32 v208, v208
    v_exp_f32 v209, v209
    v_exp_f32 v210, v210
    v_smfmac_f32_32x32x32_bf16 v[64:79], v[164:167], v[200:207], v13
    v_exp_f32 v211, v211
    v_exp_f32 v212, v212
    v_exp_f32 v213, v213
    v_exp_f32 v214, v214
    v_exp_f32 v215, v215
    v_exp_f32 v184, v184
    v_exp_f32 v185, v185
    v_smfmac_f32_32x32x32_bf16 v[64:79], v[168:171], v[208:215], v13
    v_exp_f32 v186, v186
    v_exp_f32 v187, v187
    v_exp_f32 v188, v188
    v_mfma_f32_32x32x16_bf16 v[200:215], v[160:163], v[148:151], 0
    v_exp_f32 v189, v189
    v_exp_f32 v190, v190
    v_exp_f32 v191, v191
    v_exp_f32 v192, v192
    v_exp_f32 v193, v193
    v_exp_f32 v194, v194
    v_smfmac_f32_32x32x32_bf16 v[80:95], v[164:167], v[184:191], v13
    v_exp_f32 v195, v195
    v_exp_f32 v196, v196
    v_exp_f32 v197, v197
    v_exp_f32 v198, v198
    v_exp_f32 v199, v199
    v_exp_f32 v200, v200
    v_exp_f32 v201, v201
    v_smfmac_f32_32x32x32_bf16 v[80:95], v[168:171], v[192:199], v13
    v_exp_f32 v202, v202
    v_exp_f32 v203, v203
    v_exp_f32 v204, v204
    v_mfma_f32_32x32x16_bf16 v[184:199], v[160:163], v[152:155], 0
    v_exp_f32 v205, v205
    v_exp_f32 v206, v206
    v_exp_f32 v207, v207
    v_exp_f32 v208, v208
    v_exp_f32 v209, v209
    v_exp_f32 v210, v210
    v_smfmac_f32_32x32x32_bf16 v[96:111], v[164:167], v[200:207], v13
    v_exp_f32 v211, v211
    v_exp_f32 v212, v212
    v_exp_f32 v213, v213
    v_exp_f32 v214, v214
    v_exp_f32 v215, v215
    v_exp_f32 v184, v184
    v_exp_f32 v185, v185
    v_smfmac_f32_32x32x32_bf16 v[96:111], v[168:171], v[208:215], v13
    v_exp_f32 v186, v186
    v_exp_f32 v187, v187
    v_exp_f32 v188, v188
    v_mfma_f32_32x32x16_bf16 v[200:215], v[160:163], v[156:159], 0
    v_exp_f32 v189, v189
    v_exp_f32 v190, v190
    v_exp_f32 v191, v191
    v_exp_f32 v192, v192
    v_exp_f32 v193, v193
    v_exp_f32 v194, v194
    v_smfmac_f32_32x32x32_bf16 v[112:127], v[164:167], v[184:191], v13
    v_exp_f32 v195, v195
    v_exp_f32 v196, v196
    v_exp_f32 v197, v197
    v_exp_f32 v198, v198
    v_exp_f32 v199, v199
    v_exp_f32 v200, v200
    v_exp_f32 v201, v201
    v_smfmac_f32_32x32x32_bf16 v[112:127], v[168:171], v[192:199], v13
    v_exp_f32 v202, v202
    v_exp_f32 v203, v203
    v_exp_f32 v204, v204
    v_mfma_f32_32x32x16_bf16 v[184:199], v[172:175], v[128:131], 0
    v_exp_f32 v205, v205
    v_exp_f32 v206, v206
    v_exp_f32 v207, v207
    v_exp_f32 v208, v208
    v_exp_f32 v209, v209
    v_exp_f32 v210, v210
    v_smfmac_f32_32x32x32_bf16 v[240:255], v[164:167], v[200:207], v13
    v_exp_f32 v211, v211
    v_exp_f32 v212, v212
    v_exp_f32 v213, v213
    v_exp_f32 v214, v214
    v_exp_f32 v215, v215
    v_exp_f32 v184, v184
    v_exp_f32 v185, v185
    v_smfmac_f32_32x32x32_bf16 v[240:255], v[168:171], v[208:215], v13
    v_exp_f32 v186, v186
    v_exp_f32 v187, v187
    v_exp_f32 v188, v188
    v_mfma_f32_32x32x16_bf16 v[200:215], v[172:175], v[132:135], 0
    v_exp_f32 v189, v189
    v_exp_f32 v190, v190
    v_exp_f32 v191, v191
    v_exp_f32 v192, v192
    v_exp_f32 v193, v193
    v_exp_f32 v194, v194
    v_smfmac_f32_32x32x32_bf16 v[16:31], v[176:179], v[184:191], v13
    v_exp_f32 v195, v195
    v_exp_f32 v196, v196
    v_exp_f32 v197, v197
    v_exp_f32 v198, v198
    v_exp_f32 v199, v199
    v_exp_f32 v200, v200
    v_exp_f32 v201, v201
    v_smfmac_f32_32x32x32_bf16 v[16:31], v[180:183], v[192:199], v13
    v_exp_f32 v202, v202
    v_exp_f32 v203, v203
    v_exp_f32 v204, v204
    v_mfma_f32_32x32x16_bf16 v[184:199], v[172:175], v[136:139], 0
    v_exp_f32 v205, v205
    v_exp_f32 v206, v206
    v_exp_f32 v207, v207
    v_exp_f32 v208, v208
    v_exp_f32 v209, v209
    v_exp_f32 v210, v210
    v_smfmac_f32_32x32x32_bf16 v[32:47], v[176:179], v[200:207], v13
    v_exp_f32 v211, v211
    v_exp_f32 v212, v212
    v_exp_f32 v213, v213
    v_exp_f32 v214, v214
    v_exp_f32 v215, v215
    v_exp_f32 v184, v184
    v_exp_f32 v185, v185
    v_smfmac_f32_32x32x32_bf16 v[32:47], v[180:183], v[208:215], v13
    v_exp_f32 v186, v186
    v_exp_f32 v187, v187
    v_exp_f32 v188, v188
    v_mfma_f32_32x32x16_bf16 v[200:215], v[172:175], v[140:143], 0
    v_exp_f32 v189, v189
    v_exp_f32 v190, v190
    v_exp_f32 v191, v191
    v_exp_f32 v192, v192
    v_exp_f32 v193, v193
    v_exp_f32 v194, v194
    v_smfmac_f32_32x32x32_bf16 v[48:63], v[176:179], v[184:191], v13
    v_exp_f32 v195, v195
    v_exp_f32 v196, v196
    v_exp_f32 v197, v197
    v_exp_f32 v198, v198
    v_exp_f32 v199, v199
    v_exp_f32 v200, v200
    v_exp_f32 v201, v201
    v_smfmac_f32_32x32x32_bf16 v[48:63], v[180:183], v[192:199], v13
    v_exp_f32 v202, v202
    v_exp_f32 v203, v203
    v_exp_f32 v204, v204
    v_mfma_f32_32x32x16_bf16 v[184:199], v[172:175], v[144:147], 0
    v_exp_f32 v205, v205
    v_exp_f32 v206, v206
    v_exp_f32 v207, v207
    v_exp_f32 v208, v208
    v_exp_f32 v209, v209
    v_exp_f32 v210, v210
    v_smfmac_f32_32x32x32_bf16 v[64:79], v[176:179], v[200:207], v13
    v_exp_f32 v211, v211
    v_exp_f32 v212, v212
    v_exp_f32 v213, v213
    v_exp_f32 v214, v214
    v_exp_f32 v215, v215
    v_exp_f32 v184, v184
    v_exp_f32 v185, v185
    v_smfmac_f32_32x32x32_bf16 v[64:79], v[180:183], v[208:215], v13
    v_exp_f32 v186, v186
    v_exp_f32 v187, v187
    v_exp_f32 v188, v188
    v_mfma_f32_32x32x16_bf16 v[200:215], v[172:175], v[148:151], 0
    v_exp_f32 v189, v189
    v_exp_f32 v190, v190
    v_exp_f32 v191, v191
    v_exp_f32 v192, v192
    v_exp_f32 v193, v193
    v_exp_f32 v194, v194
    v_smfmac_f32_32x32x32_bf16 v[80:95], v[176:179], v[184:191], v13
    v_exp_f32 v195, v195
    v_exp_f32 v196, v196
    v_exp_f32 v197, v197
    v_exp_f32 v198, v198
    v_exp_f32 v199, v199
    v_exp_f32 v200, v200
    v_exp_f32 v201, v201
    v_smfmac_f32_32x32x32_bf16 v[80:95], v[180:183], v[192:199], v13
    v_exp_f32 v202, v202
    v_exp_f32 v203, v203
    v_exp_f32 v204, v204
    v_mfma_f32_32x32x16_bf16 v[184:199], v[172:175], v[152:155], 0
    v_exp_f32 v205, v205
    v_exp_f32 v206, v206
    v_exp_f32 v207, v207
    v_exp_f32 v208, v208
    v_exp_f32 v209, v209
    v_exp_f32 v210, v210
    v_smfmac_f32_32x32x32_bf16 v[96:111], v[176:179], v[200:207], v13
    v_exp_f32 v211, v211
    v_exp_f32 v212, v212
    v_exp_f32 v213, v213
    v_exp_f32 v214, v214
    v_exp_f32 v215, v215
    v_exp_f32 v184, v184
    v_exp_f32 v185, v185
    v_smfmac_f32_32x32x32_bf16 v[96:111], v[180:183], v[208:215], v13
    v_exp_f32 v186, v186
    v_exp_f32 v187, v187
    v_exp_f32 v188, v188
    v_mfma_f32_32x32x16_bf16 v[200:215], v[172:175], v[156:159], 0
    v_exp_f32 v189, v189
    v_exp_f32 v190, v190
    v_exp_f32 v191, v191
    v_exp_f32 v192, v192
    v_exp_f32 v193, v193
    v_exp_f32 v194, v194
    v_smfmac_f32_32x32x32_bf16 v[112:127], v[176:179], v[184:191], v13
    v_exp_f32 v195, v195
    v_exp_f32 v196, v196
    v_exp_f32 v197, v197
    v_exp_f32 v198, v198
    v_exp_f32 v199, v199
    v_exp_f32 v200, v200
    v_exp_f32 v201, v201
    v_smfmac_f32_32x32x32_bf16 v[112:127], v[180:183], v[192:199], v13
    v_exp_f32 v202, v202
    v_exp_f32 v203, v203
    v_exp_f32 v204, v204
    s_waitcnt vmcnt(0)
    v_mfma_f32_32x32x16_bf16 v[184:199], v[216:219], v[128:131], 0
    v_exp_f32 v205, v205
    v_exp_f32 v206, v206
    v_exp_f32 v207, v207
    v_exp_f32 v208, v208
    v_exp_f32 v209, v209
    v_exp_f32 v210, v210
    v_smfmac_f32_32x32x32_bf16 v[240:255], v[176:179], v[200:207], v13
    v_exp_f32 v211, v211
    v_exp_f32 v212, v212
    v_exp_f32 v213, v213
    v_exp_f32 v214, v214
    v_exp_f32 v215, v215
    v_exp_f32 v184, v184
    v_exp_f32 v185, v185
    v_smfmac_f32_32x32x32_bf16 v[240:255], v[180:183], v[208:215], v13
    v_exp_f32 v186, v186
    v_exp_f32 v187, v187
    v_exp_f32 v188, v188
    v_mfma_f32_32x32x16_bf16 v[200:215], v[216:219], v[132:135], 0
    v_exp_f32 v189, v189
    v_exp_f32 v190, v190
    v_exp_f32 v191, v191
    v_exp_f32 v192, v192
    v_exp_f32 v193, v193
    v_exp_f32 v194, v194
    v_smfmac_f32_32x32x32_bf16 v[16:31], v[220:223], v[184:191], v13
    v_exp_f32 v195, v195
    v_exp_f32 v196, v196
    v_exp_f32 v197, v197
    v_exp_f32 v198, v198
    v_exp_f32 v199, v199
    v_exp_f32 v200, v200
    v_exp_f32 v201, v201
    v_smfmac_f32_32x32x32_bf16 v[16:31], v[224:227], v[192:199], v13
    v_exp_f32 v202, v202
    v_exp_f32 v203, v203
    v_exp_f32 v204, v204
    v_mfma_f32_32x32x16_bf16 v[184:199], v[216:219], v[136:139], 0
    v_exp_f32 v205, v205
    v_exp_f32 v206, v206
    v_exp_f32 v207, v207
    v_exp_f32 v208, v208
    v_exp_f32 v209, v209
    v_exp_f32 v210, v210
    v_smfmac_f32_32x32x32_bf16 v[32:47], v[220:223], v[200:207], v13
    v_exp_f32 v211, v211
    v_exp_f32 v212, v212
    v_exp_f32 v213, v213
    v_exp_f32 v214, v214
    v_exp_f32 v215, v215
    v_exp_f32 v184, v184
    v_exp_f32 v185, v185
    v_smfmac_f32_32x32x32_bf16 v[32:47], v[224:227], v[208:215], v13
    v_exp_f32 v186, v186
    v_exp_f32 v187, v187
    v_exp_f32 v188, v188
    v_mfma_f32_32x32x16_bf16 v[200:215], v[216:219], v[140:143], 0
    v_exp_f32 v189, v189
    v_exp_f32 v190, v190
    v_exp_f32 v191, v191
    v_exp_f32 v192, v192
    v_exp_f32 v193, v193
    v_exp_f32 v194, v194
    v_smfmac_f32_32x32x32_bf16 v[48:63], v[220:223], v[184:191], v13
    v_exp_f32 v195, v195
    v_exp_f32 v196, v196
    v_exp_f32 v197, v197
    v_exp_f32 v198, v198
    v_exp_f32 v199, v199
    v_exp_f32 v200, v200
    v_exp_f32 v201, v201
    v_smfmac_f32_32x32x32_bf16 v[48:63], v[224:227], v[192:199], v13
    v_exp_f32 v202, v202
    v_exp_f32 v203, v203
    v_exp_f32 v204, v204
    v_mfma_f32_32x32x16_bf16 v[184:199], v[216:219], v[144:147], 0
    v_exp_f32 v205, v205
    v_exp_f32 v206, v206
    v_exp_f32 v207, v207
    v_exp_f32 v208, v208
    v_exp_f32 v209, v209
    v_exp_f32 v210, v210
    v_smfmac_f32_32x32x32_bf16 v[64:79], v[220:223], v[200:207], v13
    v_exp_f32 v211, v211
    v_exp_f32 v212, v212
    v_exp_f32 v213, v213
    v_exp_f32 v214, v214
    v_exp_f32 v215, v215
    v_exp_f32 v184, v184
    v_exp_f32 v185, v185
    v_smfmac_f32_32x32x32_bf16 v[64:79], v[224:227], v[208:215], v13
    v_exp_f32 v186, v186
    v_exp_f32 v187, v187
    v_exp_f32 v188, v188
    v_mfma_f32_32x32x16_bf16 v[200:215], v[216:219], v[148:151], 0
    v_exp_f32 v189, v189
    v_exp_f32 v190, v190
    v_exp_f32 v191, v191
    v_exp_f32 v192, v192
    v_exp_f32 v193, v193
    v_exp_f32 v194, v194
    v_smfmac_f32_32x32x32_bf16 v[80:95], v[220:223], v[184:191], v13
    v_exp_f32 v195, v195
    v_exp_f32 v196, v196
    v_exp_f32 v197, v197
    v_exp_f32 v198, v198
    v_exp_f32 v199, v199
    v_exp_f32 v200, v200
    v_exp_f32 v201, v201
    v_smfmac_f32_32x32x32_bf16 v[80:95], v[224:227], v[192:199], v13
    v_exp_f32 v202, v202
    v_exp_f32 v203, v203
    v_exp_f32 v204, v204
    v_mfma_f32_32x32x16_bf16 v[184:199], v[216:219], v[152:155], 0
    v_exp_f32 v205, v205
    v_exp_f32 v206, v206
    v_exp_f32 v207, v207
    v_exp_f32 v208, v208
    v_exp_f32 v209, v209
    v_exp_f32 v210, v210
    v_smfmac_f32_32x32x32_bf16 v[96:111], v[220:223], v[200:207], v13
    v_exp_f32 v211, v211
    v_exp_f32 v212, v212
    v_exp_f32 v213, v213
    v_exp_f32 v214, v214
    v_exp_f32 v215, v215
    v_exp_f32 v184, v184
    v_exp_f32 v185, v185
    v_smfmac_f32_32x32x32_bf16 v[96:111], v[224:227], v[208:215], v13
    v_exp_f32 v186, v186
    v_exp_f32 v187, v187
    v_exp_f32 v188, v188
    v_mfma_f32_32x32x16_bf16 v[200:215], v[216:219], v[156:159], 0
    v_exp_f32 v189, v189
    v_exp_f32 v190, v190
    v_exp_f32 v191, v191
    v_exp_f32 v192, v192
    v_exp_f32 v193, v193
    v_exp_f32 v194, v194
    v_smfmac_f32_32x32x32_bf16 v[112:127], v[220:223], v[184:191], v13
    v_exp_f32 v195, v195
    v_exp_f32 v196, v196
    v_exp_f32 v197, v197
    v_exp_f32 v198, v198
    v_exp_f32 v199, v199
    v_exp_f32 v200, v200
    v_exp_f32 v201, v201
    v_smfmac_f32_32x32x32_bf16 v[112:127], v[224:227], v[192:199], v13
    v_exp_f32 v202, v202
    v_exp_f32 v203, v203
    v_exp_f32 v204, v204
    v_mfma_f32_32x32x16_bf16 v[184:199], v[228:231], v[128:131], 0
    v_exp_f32 v205, v205
    v_exp_f32 v206, v206
    v_exp_f32 v207, v207
    v_exp_f32 v208, v208
    v_exp_f32 v209, v209
    v_exp_f32 v210, v210
    v_smfmac_f32_32x32x32_bf16 v[240:255], v[220:223], v[200:207], v13
    v_exp_f32 v211, v211
    v_exp_f32 v212, v212
    v_exp_f32 v213, v213
    v_exp_f32 v214, v214
    v_exp_f32 v215, v215
    v_exp_f32 v184, v184
    v_exp_f32 v185, v185
    v_smfmac_f32_32x32x32_bf16 v[240:255], v[224:227], v[208:215], v13
    v_exp_f32 v186, v186
    v_exp_f32 v187, v187
    v_exp_f32 v188, v188
    v_mfma_f32_32x32x16_bf16 v[200:215], v[228:231], v[132:135], 0
    v_exp_f32 v189, v189
    v_exp_f32 v190, v190
    v_exp_f32 v191, v191
    v_exp_f32 v192, v192
    v_exp_f32 v193, v193
    v_exp_f32 v194, v194
    v_smfmac_f32_32x32x32_bf16 v[16:31], v[232:235], v[184:191], v13
    v_exp_f32 v195, v195
    v_exp_f32 v196, v196
    v_exp_f32 v197, v197
    v_exp_f32 v198, v198
    v_exp_f32 v199, v199
    v_exp_f32 v200, v200
    v_exp_f32 v201, v201
    v_smfmac_f32_32x32x32_bf16 v[16:31], v[236:239], v[192:199], v13
    v_exp_f32 v202, v202
    v_exp_f32 v203, v203
    v_exp_f32 v204, v204
    v_mfma_f32_32x32x16_bf16 v[184:199], v[228:231], v[136:139], 0
    v_exp_f32 v205, v205
    v_exp_f32 v206, v206
    v_exp_f32 v207, v207
    v_exp_f32 v208, v208
    v_exp_f32 v209, v209
    v_exp_f32 v210, v210
    v_smfmac_f32_32x32x32_bf16 v[32:47], v[232:235], v[200:207], v13
    v_exp_f32 v211, v211
    v_exp_f32 v212, v212
    v_exp_f32 v213, v213
    ds_write_b128 v10, v[16:19] offset:0
    ds_write_b128 v10, v[20:23] offset:1024
    ds_write_b32 v10, v24 offset:2048
    v_exp_f32 v214, v214
    v_exp_f32 v215, v215
    v_exp_f32 v184, v184
    v_exp_f32 v185, v185
    v_smfmac_f32_32x32x32_bf16 v[32:47], v[236:239], v[208:215], v13
    v_exp_f32 v186, v186
    v_exp_f32 v187, v187
    v_exp_f32 v188, v188
    v_mfma_f32_32x32x16_bf16 v[200:215], v[228:231], v[140:143], 0
    v_exp_f32 v189, v189
    v_exp_f32 v190, v190
    v_exp_f32 v191, v191
    v_exp_f32 v192, v192
    v_exp_f32 v193, v193
    v_exp_f32 v194, v194
    v_smfmac_f32_32x32x32_bf16 v[48:63], v[232:235], v[184:191], v13
    v_exp_f32 v195, v195
    v_exp_f32 v196, v196
    v_exp_f32 v197, v197
    ds_write_b128 v10, v[32:35] offset:3072
    ds_write_b128 v10, v[36:39] offset:4096
    ds_write_b32 v10, v40 offset:5120
    v_exp_f32 v198, v198
    v_exp_f32 v199, v199
    v_exp_f32 v200, v200
    v_exp_f32 v201, v201
    v_smfmac_f32_32x32x32_bf16 v[48:63], v[236:239], v[192:199], v13
    v_exp_f32 v202, v202
    v_exp_f32 v203, v203
    v_exp_f32 v204, v204
    v_mfma_f32_32x32x16_bf16 v[184:199], v[228:231], v[144:147], 0
    v_exp_f32 v205, v205
    v_exp_f32 v206, v206
    v_exp_f32 v207, v207
    v_exp_f32 v208, v208
    v_exp_f32 v209, v209
    v_exp_f32 v210, v210
    v_smfmac_f32_32x32x32_bf16 v[64:79], v[232:235], v[200:207], v13
    v_exp_f32 v211, v211
    v_exp_f32 v212, v212
    v_exp_f32 v213, v213
    ds_write_b128 v11, v[48:51] offset:0
    ds_write_b128 v11, v[52:55] offset:1024
    ds_write_b32 v11, v56 offset:2048
    v_exp_f32 v214, v214
    v_exp_f32 v215, v215
    v_exp_f32 v184, v184
    v_exp_f32 v185, v185
    v_smfmac_f32_32x32x32_bf16 v[64:79], v[236:239], v[208:215], v13
    v_exp_f32 v186, v186
    v_exp_f32 v187, v187
    v_exp_f32 v188, v188
    v_mfma_f32_32x32x16_bf16 v[200:215], v[228:231], v[148:151], 0
    v_exp_f32 v189, v189
    v_exp_f32 v190, v190
    v_exp_f32 v191, v191
    v_exp_f32 v192, v192
    v_exp_f32 v193, v193
    v_exp_f32 v194, v194
    v_smfmac_f32_32x32x32_bf16 v[80:95], v[232:235], v[184:191], v13
    v_exp_f32 v195, v195
    v_exp_f32 v196, v196
    v_exp_f32 v197, v197
    ds_write_b128 v11, v[64:67] offset:3072
    ds_write_b128 v11, v[68:71] offset:4096
    ds_write_b32 v11, v72 offset:5120
    v_exp_f32 v198, v198
    v_exp_f32 v199, v199
    v_exp_f32 v200, v200
    v_exp_f32 v201, v201
    v_smfmac_f32_32x32x32_bf16 v[80:95], v[236:239], v[192:199], v13
    v_exp_f32 v202, v202
    v_exp_f32 v203, v203
    v_exp_f32 v204, v204
    v_mfma_f32_32x32x16_bf16 v[184:199], v[228:231], v[152:155], 0
    v_exp_f32 v205, v205
    v_exp_f32 v206, v206
    v_exp_f32 v207, v207
    v_exp_f32 v208, v208
    v_exp_f32 v209, v209
    v_exp_f32 v210, v210
    v_smfmac_f32_32x32x32_bf16 v[96:111], v[232:235], v[200:207], v13
    v_exp_f32 v211, v211
    v_exp_f32 v212, v212
    v_exp_f32 v213, v213
    ds_write_b128 v12, v[80:83] offset:0
    ds_write_b128 v12, v[84:87] offset:1024
    ds_write_b32 v12, v88 offset:2048
    v_exp_f32 v214, v214
    v_exp_f32 v215, v215
    v_exp_f32 v184, v184
    v_exp_f32 v185, v185
    v_smfmac_f32_32x32x32_bf16 v[96:111], v[236:239], v[208:215], v13
    v_exp_f32 v186, v186
    v_exp_f32 v187, v187
    v_exp_f32 v188, v188
    v_mfma_f32_32x32x16_bf16 v[200:215], v[228:231], v[156:159], 0
    v_exp_f32 v189, v189
    v_exp_f32 v190, v190
    v_exp_f32 v191, v191
    v_exp_f32 v192, v192
    v_exp_f32 v193, v193
    v_exp_f32 v194, v194
    v_smfmac_f32_32x32x32_bf16 v[112:127], v[232:235], v[184:191], v13
    v_exp_f32 v195, v195
    v_exp_f32 v196, v196
    v_exp_f32 v197, v197
    ds_write_b128 v12, v[96:99] offset:3072
    ds_write_b128 v12, v[100:103] offset:4096
    ds_write_b32 v12, v104 offset:5120
    v_exp_f32 v198, v198
    v_exp_f32 v199, v199
    v_exp_f32 v200, v200
    v_exp_f32 v201, v201
    v_smfmac_f32_32x32x32_bf16 v[112:127], v[236:239], v[192:199], v13
    v_exp_f32 v202, v202
    v_exp_f32 v203, v203
    v_exp_f32 v204, v204
    v_exp_f32 v205, v205
    s_waitcnt lgkmcnt(0)
    s_barrier
    ds_read_b32 v136, v9 offset:2048
    ds_read_b128 v[128:131], v9 offset:0
    ds_read_b128 v[132:135], v9 offset:1024
    v_exp_f32 v206, v206
    v_exp_f32 v207, v207
    v_exp_f32 v208, v208
    ds_read_b32 v148, v9 offset:8192
    ds_read_b128 v[140:143], v9 offset:6144
    ds_read_b128 v[144:147], v9 offset:7168
    v_exp_f32 v209, v209
    v_exp_f32 v210, v210
    v_smfmac_f32_32x32x32_bf16 v[240:255], v[232:235], v[200:207], v13
    v_exp_f32 v211, v211
    v_exp_f32 v212, v212
    ds_read_b32 v160, v9 offset:14336
    ds_read_b128 v[152:155], v9 offset:12288
    ds_read_b128 v[156:159], v9 offset:13312
    v_exp_f32 v213, v213
    v_exp_f32 v214, v214
    v_exp_f32 v215, v215
    s_setprio 3
    s_add_u32 s53, s84, 147456
    s_nop 0
    v_smfmac_f32_32x32x32_bf16 v[240:255], v[236:239], v[208:215], v13
    ds_read_b32 v24, v9 offset:5120
    ds_read_b128 v[16:19], v9 offset:3072
    ds_read_b128 v[20:23], v9 offset:4096
    s_waitcnt lgkmcnt(9)
    v_add_f32 v120, v120, v136
    v_pk_add_f32 v[112:113], v[112:113], v[128:129]
    v_pk_add_f32 v[114:115], v[114:115], v[130:131]
    v_pk_add_f32 v[116:117], v[116:117], v[132:133]
    v_pk_add_f32 v[118:119], v[118:119], v[134:135]
    ds_read_b32 v36, v9 offset:11264
    ds_read_b128 v[28:31], v9 offset:9216
    ds_read_b128 v[32:35], v9 offset:10240
    s_waitcnt lgkmcnt(9)
    v_add_f32 v120, v120, v148
    v_pk_add_f32 v[112:113], v[112:113], v[140:141]
    v_pk_add_f32 v[114:115], v[114:115], v[142:143]
    v_pk_add_f32 v[116:117], v[116:117], v[144:145]
    v_pk_add_f32 v[118:119], v[118:119], v[146:147]
    ds_read_b32 v48, v9 offset:17408
    ds_read_b128 v[40:43], v9 offset:15360
    ds_read_b128 v[44:47], v9 offset:16384
    s_waitcnt lgkmcnt(9)
    v_add_f32 v120, v120, v160
    v_pk_add_f32 v[112:113], v[112:113], v[152:153]
    v_pk_add_f32 v[114:115], v[114:115], v[154:155]
    v_pk_add_f32 v[116:117], v[116:117], v[156:157]
    v_pk_add_f32 v[118:119], v[118:119], v[158:159]
    v_rcp_f32 v136, v120
    s_nop 0
    v_pk_mul_f32 v[128:129], v[112:113], v[136:137] op_sel_hi:[1,0]
    v_pk_mul_f32 v[130:131], v[114:115], v[136:137] op_sel_hi:[1,0]
    v_pk_mul_f32 v[132:133], v[116:117], v[136:137] op_sel_hi:[1,0]
    v_pk_mul_f32 v[134:135], v[118:119], v[136:137] op_sel_hi:[1,0]
    v_cvt_pk_bf16_f32 v124, v128, v129
    v_cvt_pk_bf16_f32 v125, v130, v131
    v_cvt_pk_bf16_f32 v126, v132, v133
    v_cvt_pk_bf16_f32 v127, v134, v135
    buffer_store_dwordx4 v[124:127], v1, s[16:19], s84 offen sc1
    s_waitcnt lgkmcnt(6)
    v_add_f32 v248, v248, v24
    v_pk_add_f32 v[240:241], v[240:241], v[16:17]
    v_pk_add_f32 v[242:243], v[242:243], v[18:19]
    v_pk_add_f32 v[244:245], v[244:245], v[20:21]
    v_pk_add_f32 v[246:247], v[246:247], v[22:23]
    s_waitcnt lgkmcnt(3)
    v_add_f32 v248, v248, v36
    v_pk_add_f32 v[240:241], v[240:241], v[28:29]
    v_pk_add_f32 v[242:243], v[242:243], v[30:31]
    v_pk_add_f32 v[244:245], v[244:245], v[32:33]
    v_pk_add_f32 v[246:247], v[246:247], v[34:35]
    s_waitcnt lgkmcnt(0)
    v_add_f32 v248, v248, v48
    v_pk_add_f32 v[240:241], v[240:241], v[40:41]
    v_pk_add_f32 v[242:243], v[242:243], v[42:43]
    v_pk_add_f32 v[244:245], v[244:245], v[44:45]
    v_pk_add_f32 v[246:247], v[246:247], v[46:47]
    v_rcp_f32 v24, v248
    s_nop 0
    v_pk_mul_f32 v[16:17], v[240:241], v[24:25] op_sel_hi:[1,0]
    v_pk_mul_f32 v[18:19], v[242:243], v[24:25] op_sel_hi:[1,0]
    v_pk_mul_f32 v[20:21], v[244:245], v[24:25] op_sel_hi:[1,0]
    v_pk_mul_f32 v[22:23], v[246:247], v[24:25] op_sel_hi:[1,0]
    v_cvt_pk_bf16_f32 v252, v16, v17
    v_cvt_pk_bf16_f32 v253, v18, v19
    v_cvt_pk_bf16_f32 v254, v20, v21
    v_cvt_pk_bf16_f32 v255, v22, v23
    buffer_store_dwordx4 v[252:255], v1, s[16:19], s53 offen sc1
    s_barrier
    v_add_f32 v140, |v112|, |v113|
    v_add_f32 v141, |v114|, |v115|
    v_add_f32 v142, |v116|, |v117|
    v_add_f32 v143, |v118|, |v119|
    v_cmp_le_f32 vcc, 0x33800000, v120
    v_add_f32 v140, v140, v141
    v_add_f32 v142, v142, v143
    s_mov_b64 s[54:55], vcc
    v_cmp_ge_f32 vcc, 0x5f800000, v120
    v_add_f32 v140, v140, v142
    s_and_b64 s[54:55], s[54:55], vcc
    v_cmp_ge_f32 vcc, 0x7e800000, v140
    s_nop 0
    s_and_b64 s[54:55], s[54:55], vcc
    s_cmp_eq_u64 s[54:55], -1
    s_cbranch_scc0 L_slow0
L_slowr0:
    v_add_f32 v28, |v240|, |v241|
    v_add_f32 v29, |v242|, |v243|
    v_add_f32 v30, |v244|, |v245|
    v_add_f32 v31, |v246|, |v247|
    v_cmp_le_f32 vcc, 0x33800000, v248
    v_add_f32 v28, v28, v29
    v_add_f32 v30, v30, v31
    s_mov_b64 s[54:55], vcc
    v_cmp_ge_f32 vcc, 0x5f800000, v248
    v_add_f32 v28, v28, v30
    s_and_b64 s[54:55], s[54:55], vcc
    v_cmp_ge_f32 vcc, 0x7e800000, v28
    s_nop 0
    s_and_b64 s[54:55], s[54:55], vcc
    s_cmp_eq_u64 s[54:55], -1
    s_cbranch_scc0 L_slow1
L_slowr1:
    v_lshrrev_b32 v3, 3, v0
    v_and_b32 v4, 7, v0
    v_lshlrev_b32 v137, 10, v3
    v_lshl_add_u32 v137, v4, 4, v137
    v_lshrrev_b32 v136, 4, v3
    v_lshl_add_u32 v136, v136, 3, v4
    v_mul_u32_u24 v136, 576, v136
    v_and_b32 v3, 15, v3
    v_lshl_add_u32 v136, v3, 4, v136
    s_waitcnt vmcnt(0)
    s_mov_b64 exec, 1
    buffer_store_dwordx2 v[6:7], off, s[16:19], s85 sc1
    s_mov_b64 exec, -1
    buffer_load_dwordx4 v[140:143], v137, s[8:11], s94 offen
    s_branch L_fin
L_slow0:
    s_waitcnt vmcnt(0)
    buffer_load_dwordx4 v[168:171], v1, s[16:19], s89 offen offset:0 sc1
    v_mov_b32 v5, 0x3f803f80
    v_bfe_u32 v3, v1, 4, 6
    v_and_b32 v3, 27, v3
    v_cmp_eq_u32 vcc, 16, v3
    s_nop 1
    v_cndmask_b32 v5, 0, v5, vcc
    v_mov_b32 v176, v5
    v_mov_b32 v177, v5
    v_mov_b32 v178, v5
    v_mov_b32 v179, v5
    v_mov_b32 v180, v5
    v_mov_b32 v181, v5
    v_mov_b32 v182, v5
    v_mov_b32 v183, v5
    v_mov_b32 v112, 0
    v_mov_b32 v113, 0
    v_mov_b32 v114, 0
    v_mov_b32 v115, 0
    v_mov_b32 v116, 0
    v_mov_b32 v117, 0
    v_mov_b32 v118, 0
    v_mov_b32 v119, 0
    v_mov_b32 v120, 0
    v_mov_b32 v121, 0
    v_mov_b32 v122, 0
    v_mov_b32 v123, 0
    v_mov_b32 v124, 0
    v_mov_b32 v125, 0
    v_mov_b32 v126, 0
    v_mov_b32 v127, 0
    v_mov_b32 v224, 0xff800000
    s_mov_b32 s51, s81
    s_mov_b32 s52, 64
L_s1_0:
    buffer_load_dwordx4 v[172:175], v1, s[16:19], s51 offen sc1
    s_waitcnt vmcnt(0)
    v_mfma_f32_32x32x16_bf16 v[184:199], v[172:175], v[168:171], 0
    s_add_u32 s51, s51, 1024
    s_nop 15
    v_max3_f32 v224, v184, v185, v224
    v_max3_f32 v224, v186, v187, v224
    v_max3_f32 v224, v188, v189, v224
    v_max3_f32 v224, v190, v191, v224
    v_max3_f32 v224, v192, v193, v224
    v_max3_f32 v224, v194, v195, v224
    v_max3_f32 v224, v196, v197, v224
    v_max3_f32 v224, v198, v199, v224
    s_sub_u32 s52, s52, 1
    s_cmp_lg_u32 s52, 0
    s_cbranch_scc1 L_s1_0
    v_mov_b32 v225, v224
    s_nop 1
    v_permlane32_swap_b32 v224, v225
    s_nop 1
    v_max_f32 v224, v224, v225
    v_sub_f32 v208, 0, v224
    v_sub_f32 v209, 0, v224
    v_sub_f32 v210, 0, v224
    v_sub_f32 v211, 0, v224
    v_sub_f32 v212, 0, v224
    v_sub_f32 v213, 0, v224
    v_sub_f32 v214, 0, v224
    v_sub_f32 v215, 0, v224
    v_sub_f32 v216, 0, v224
    v_sub_f32 v217, 0, v224
    v_sub_f32 v218, 0, v224
    v_sub_f32 v219, 0, v224
    v_sub_f32 v220, 0, v224
    v_sub_f32 v221, 0, v224
    v_sub_f32 v222, 0, v224
    v_sub_f32 v223, 0, v224
    s_mov_b32 s51, s81
    s_mov_b32 s52, 64
L_s2_0:
    s_mov_b32 s54, s51
    buffer_load_dwordx4 v[172:175], v1, s[16:19], s51 offen sc1
    s_mov_b64 exec, s[82:83]
    buffer_load_dwordx4 v[176:179], v8, s[16:19], s54 offen sc1
    buffer_load_dwordx4 v[180:183], v8, s[16:19], s54 offen offset:512 sc1
    s_mov_b64 exec, -1
    s_waitcnt vmcnt(0)
    v_mfma_f32_32x32x16_bf16 v[184:199], v[172:175], v[168:171], v[208:223]
    s_add_u32 s51, s51, 1024
    s_nop 15
    v_exp_f32 v184, v184
    v_exp_f32 v185, v185
    v_exp_f32 v186, v186
    v_exp_f32 v187, v187
    v_exp_f32 v188, v188
    v_exp_f32 v189, v189
    v_exp_f32 v190, v190
    v_exp_f32 v191, v191
    v_exp_f32 v192, v192
    v_exp_f32 v193, v193
    v_exp_f32 v194, v194
    v_exp_f32 v195, v195
    v_exp_f32 v196, v196
    v_exp_f32 v197, v197
    v_exp_f32 v198, v198
    v_exp_f32 v199, v199
    s_nop 3
    v_smfmac_f32_32x32x32_bf16 v[112:127], v[176:179], v[184:191], v13
    v_smfmac_f32_32x32x32_bf16 v[112:127], v[180:183], v[192:199], v13
    s_sub_u32 s52, s52, 1
    s_cmp_lg_u32 s52, 0
    s_cbranch_scc1 L_s2_0
    s_nop 15
    v_rcp_f32 v136, v120
    s_nop 0
    v_pk_mul_f32 v[128:129], v[112:113], v[136:137] op_sel_hi:[1,0]
    v_pk_mul_f32 v[130:131], v[114:115], v[136:137] op_sel_hi:[1,0]
    v_pk_mul_f32 v[132:133], v[116:117], v[136:137] op_sel_hi:[1,0]
    v_pk_mul_f32 v[134:135], v[118:119], v[136:137] op_sel_hi:[1,0]
    v_cvt_pk_bf16_f32 v124, v128, v129
    v_cvt_pk_bf16_f32 v125, v130, v131
    v_cvt_pk_bf16_f32 v126, v132, v133
    v_cvt_pk_bf16_f32 v127, v134, v135
    buffer_store_dwordx4 v[124:127], v1, s[16:19], s84 offen sc1
    s_branch L_slowr0
L_slow1:
    s_waitcnt vmcnt(0)
    buffer_load_dwordx4 v[168:171], v1, s[16:19], s89 offen offset:1024 sc1
    v_mov_b32 v5, 0x3f803f80
    v_bfe_u32 v3, v1, 4, 6
    v_and_b32 v3, 27, v3
    v_cmp_eq_u32 vcc, 16, v3
    s_nop 1
    v_cndmask_b32 v5, 0, v5, vcc
    v_mov_b32 v176, v5
    v_mov_b32 v177, v5
    v_mov_b32 v178, v5
    v_mov_b32 v179, v5
    v_mov_b32 v180, v5
    v_mov_b32 v181, v5
    v_mov_b32 v182, v5
    v_mov_b32 v183, v5
    v_mov_b32 v240, 0
    v_mov_b32 v241, 0
    v_mov_b32 v242, 0
    v_mov_b32 v243, 0
    v_mov_b32 v244, 0
    v_mov_b32 v245, 0
    v_mov_b32 v246, 0
    v_mov_b32 v247, 0
    v_mov_b32 v248, 0
    v_mov_b32 v249, 0
    v_mov_b32 v250, 0
    v_mov_b32 v251, 0
    v_mov_b32 v252, 0
    v_mov_b32 v253, 0
    v_mov_b32 v254, 0
    v_mov_b32 v255, 0
    v_mov_b32 v224, 0xff800000
    s_mov_b32 s51, s81
    s_mov_b32 s52, 64
L_s1_1:
    buffer_load_dwordx4 v[172:175], v1, s[16:19], s51 offen sc1
    s_waitcnt vmcnt(0)
    v_mfma_f32_32x32x16_bf16 v[184:199], v[172:175], v[168:171], 0
    s_add_u32 s51, s51, 1024
    s_nop 15
    v_max3_f32 v224, v184, v185, v224
    v_max3_f32 v224, v186, v187, v224
    v_max3_f32 v224, v188, v189, v224
    v_max3_f32 v224, v190, v191, v224
    v_max3_f32 v224, v192, v193, v224
    v_max3_f32 v224, v194, v195, v224
    v_max3_f32 v224, v196, v197, v224
    v_max3_f32 v224, v198, v199, v224
    s_sub_u32 s52, s52, 1
    s_cmp_lg_u32 s52, 0
    s_cbranch_scc1 L_s1_1
    v_mov_b32 v225, v224
    s_nop 1
    v_permlane32_swap_b32 v224, v225
    s_nop 1
    v_max_f32 v224, v224, v225
    v_sub_f32 v208, 0, v224
    v_sub_f32 v209, 0, v224
    v_sub_f32 v210, 0, v224
    v_sub_f32 v211, 0, v224
    v_sub_f32 v212, 0, v224
    v_sub_f32 v213, 0, v224
    v_sub_f32 v214, 0, v224
    v_sub_f32 v215, 0, v224
    v_sub_f32 v216, 0, v224
    v_sub_f32 v217, 0, v224
    v_sub_f32 v218, 0, v224
    v_sub_f32 v219, 0, v224
    v_sub_f32 v220, 0, v224
    v_sub_f32 v221, 0, v224
    v_sub_f32 v222, 0, v224
    v_sub_f32 v223, 0, v224
    s_mov_b32 s51, s81
    s_mov_b32 s52, 64
L_s2_1:
    s_mov_b32 s54, s51
    buffer_load_dwordx4 v[172:175], v1, s[16:19], s51 offen sc1
    s_mov_b64 exec, s[82:83]
    buffer_load_dwordx4 v[176:179], v8, s[16:19], s54 offen sc1
    buffer_load_dwordx4 v[180:183], v8, s[16:19], s54 offen offset:512 sc1
    s_mov_b64 exec, -1
    s_waitcnt vmcnt(0)
    v_mfma_f32_32x32x16_bf16 v[184:199], v[172:175], v[168:171], v[208:223]
    s_add_u32 s51, s51, 1024
    s_nop 15
    v_exp_f32 v184, v184
    v_exp_f32 v185, v185
    v_exp_f32 v186, v186
    v_exp_f32 v187, v187
    v_exp_f32 v188, v188
    v_exp_f32 v189, v189
    v_exp_f32 v190, v190
    v_exp_f32 v191, v191
    v_exp_f32 v192, v192
    v_exp_f32 v193, v193
    v_exp_f32 v194, v194
    v_exp_f32 v195, v195
    v_exp_f32 v196, v196
    v_exp_f32 v197, v197
    v_exp_f32 v198, v198
    v_exp_f32 v199, v199
    s_nop 3
    v_smfmac_f32_32x32x32_bf16 v[240:255], v[176:179], v[184:191], v13
    v_smfmac_f32_32x32x32_bf16 v[240:255], v[180:183], v[192:199], v13
    s_sub_u32 s52, s52, 1
    s_cmp_lg_u32 s52, 0
    s_cbranch_scc1 L_s2_1
    s_nop 15
    v_rcp_f32 v24, v248
    s_nop 0
    v_pk_mul_f32 v[16:17], v[240:241], v[24:25] op_sel_hi:[1,0]
    v_pk_mul_f32 v[18:19], v[242:243], v[24:25] op_sel_hi:[1,0]
    v_pk_mul_f32 v[20:21], v[244:245], v[24:25] op_sel_hi:[1,0]
    v_pk_mul_f32 v[22:23], v[246:247], v[24:25] op_sel_hi:[1,0]
    v_cvt_pk_bf16_f32 v252, v16, v17
    v_cvt_pk_bf16_f32 v253, v18, v19
    v_cvt_pk_bf16_f32 v254, v20, v21
    v_cvt_pk_bf16_f32 v255, v22, v23
    buffer_store_dwordx4 v[252:255], v1, s[16:19], s53 offen sc1
    s_branch L_slowr1
L_gem:
    s_bitcmp1_b32 s2, 6
    s_cbranch_scc1 L_GR
    s_setprio 1
    s_waitcnt vmcnt(2)
    s_barrier
    s_add_u32 m0, s56, 65536
    s_add_u32 s54, s54, 196608
    s_cmp_eq_u32 s33, 6
    s_cselect_b32 s52, 1572864, 0
    s_sub_u32 s54, s54, s52
    buffer_load_dwordx4 v44, s[12:15], s54 offen lds
    buffer_load_dwordx4 v45, s[12:15], s54 offen offset:1024 lds
    s_add_u32 m0, s56, 98304
    s_add_u32 s54, s54, 196608
    buffer_load_dwordx4 v44, s[12:15], s54 offen lds
    buffer_load_dwordx4 v45, s[12:15], s54 offen offset:1024 lds
    ds_read_b128 v[128:131], v12 offset:0
    ds_read_b128 v[132:135], v12 offset:2048
    ds_read_b128 v[136:139], v13 offset:0
    ds_read_b128 v[140:143], v13 offset:2048
    ds_read_b64_tr_b16 v[16:17], v46 offset:16384
    ds_read_b64_tr_b16 v[18:19], v46 offset:16896
    ds_read_b64_tr_b16 v[20:21], v6 offset:16384
    ds_read_b64_tr_b16 v[22:23], v6 offset:16896
    ds_read_b64_tr_b16 v[24:25], v46 offset:20480
    ds_read_b64_tr_b16 v[26:27], v46 offset:20992
    ds_read_b64_tr_b16 v[28:29], v6 offset:20480
    ds_read_b64_tr_b16 v[30:31], v6 offset:20992
    ds_read_b64_tr_b16 v[88:89], v7 offset:16384
    ds_read_b64_tr_b16 v[90:91], v7 offset:16896
    s_and_b32 s4, s2, 7
    s_and_b32 s51, s5, 3
    s_and_b32 s52, s2, 6
    s_lshl1_add_u32 s6, s52, s51
    s_lshr_b32 s35, s5, 2
    s_and_b32 s52, s2, 1
    s_lshl3_add_u32 s7, s52, s35
    s_lshl2_add_u32 s34, s4, s51
    s_mov_b32 s72, 0xffff0000
    s_lshr_b32 s61, s3, 2
    s_lshl2_add_u32 s62, s6, s32
    s_mov_b32 s18, 0x1800000
    s_mov_b32 s19, 0x00020000
    s_mov_b32 s46, 0x100
    s_mov_b32 s47, 0x00020000
    s_mov_b32 s22, 0x1c0000
    s_mov_b32 s23, 0x00020000
    s_mov_b32 s26, 0x1c0000
    s_mov_b32 s27, 0x00020000
    s_mov_b32 s30, 0x1c0000
    s_mov_b32 s31, 0x00020000
    s_mov_b32 s38, 0x80000
    s_mov_b32 s39, 0x00020000
    s_mov_b32 s42, 0x200000
    s_mov_b32 s43, 0x00020000
    s_waitcnt lgkmcnt(0)
    s_waitcnt vmcnt(4)
    s_barrier
    v_dot2c_f32_bf16 v40, s71, v88
    v_dot2c_f32_bf16 v40, s71, v89
    v_dot2c_f32_bf16 v40, s71, v90
    v_dot2c_f32_bf16 v40, s71, v91
    v_dot2c_f32_bf16 v42, s71, v128
    v_dot2c_f32_bf16 v43, v128, v128
    v_dot2c_f32_bf16 v42, s71, v129
    v_dot2c_f32_bf16 v43, v129, v129
    v_dot2c_f32_bf16 v42, s71, v130
    v_dot2c_f32_bf16 v43, v130, v130
    v_dot2c_f32_bf16 v42, s71, v131
    v_dot2c_f32_bf16 v43, v131, v131
    v_dot2c_f32_bf16 v14, s71, v132
    v_dot2c_f32_bf16 v15, v132, v132
    v_dot2c_f32_bf16 v14, s71, v133
    v_dot2c_f32_bf16 v15, v133, v133
    v_dot2c_f32_bf16 v14, s71, v134
    v_dot2c_f32_bf16 v15, v134, v134
    v_dot2c_f32_bf16 v14, s71, v135
    v_dot2c_f32_bf16 v15, v135, v135
    v_dot2c_f32_bf16 v42, s71, v136
    v_dot2c_f32_bf16 v43, v136, v136
    v_dot2c_f32_bf16 v42, s71, v137
    v_dot2c_f32_bf16 v43, v137, v137
    v_dot2c_f32_bf16 v42, s71, v138
    v_dot2c_f32_bf16 v43, v138, v138
    v_dot2c_f32_bf16 v42, s71, v139
    v_dot2c_f32_bf16 v43, v139, v139
    v_dot2c_f32_bf16 v14, s71, v140
    v_dot2c_f32_bf16 v15, v140, v140
    v_dot2c_f32_bf16 v14, s71, v141
    v_dot2c_f32_bf16 v15, v141, v141
    v_dot2c_f32_bf16 v14, s71, v142
    v_dot2c_f32_bf16 v15, v142, v142
    v_dot2c_f32_bf16 v14, s71, v143
    v_dot2c_f32_bf16 v15, v143, v143
    v_mfma_f32_16x16x32_bf16 v[112:115], v[128:131], v[16:19], 0
    v_mfma_f32_16x16x32_bf16 v[116:119], v[132:135], v[16:19], 0
    ds_read_b128 v[144:147], v12 offset:32768
    ds_read_b64_tr_b16 v[48:49], v46 offset:49152
    ds_read_b64_tr_b16 v[50:51], v46 offset:49664
    v_mfma_f32_16x16x32_bf16 v[120:123], v[128:131], v[20:23], 0
    v_mfma_f32_16x16x32_bf16 v[124:127], v[132:135], v[20:23], 0
    ds_read_b128 v[148:151], v12 offset:34816
    ds_read_b64_tr_b16 v[52:53], v6 offset:49152
    ds_read_b64_tr_b16 v[54:55], v6 offset:49664
    v_mfma_f32_16x16x32_bf16 v[112:115], v[136:139], v[24:27], v[112:115]
    v_mfma_f32_16x16x32_bf16 v[116:119], v[140:143], v[24:27], v[116:119]
    ds_read_b128 v[152:155], v13 offset:32768
    ds_read_b64_tr_b16 v[56:57], v46 offset:53248
    ds_read_b64_tr_b16 v[58:59], v46 offset:53760
    v_mfma_f32_16x16x32_bf16 v[120:123], v[136:139], v[28:31], v[120:123]
    v_mfma_f32_16x16x32_bf16 v[124:127], v[140:143], v[28:31], v[124:127]
    ds_read_b128 v[156:159], v13 offset:34816
    ds_read_b64_tr_b16 v[60:61], v6 offset:53248
    ds_read_b64_tr_b16 v[62:63], v6 offset:53760
    ds_read_b64_tr_b16 v[88:89], v7 offset:49152
    ds_read_b64_tr_b16 v[90:91], v7 offset:49664
    s_add_u32 m0, s56, 0
    s_add_u32 s54, s54, 196608
    s_cmp_eq_u32 s33, 4
    s_cselect_b32 s52, 1572864, 0
    s_sub_u32 s54, s54, s52
    buffer_load_dwordx4 v44, s[12:15], s54 offen lds
    buffer_load_dwordx4 v45, s[12:15], s54 offen offset:1024 lds
    s_lshr_b32 s51, s7, 2
    s_mul_i32 s51, s51, 7
    s_and_b32 s52, s7, 3
    s_lshl1_add_u32 s51, s52, s51
    s_cmp_eq_u32 s52, 3
    s_cselect_b32 s63, 2, 0
    s_subb_u32 s51, s51, 0
    s_bitcmp1_b32 s2, 6
    s_cselect_b32 s52, 3, 4
    s_mul_i32 s52, s52, s61
    s_add_u32 s63, s63, s52
    s_lshl3_add_u32 s52, s33, s3
    s_mul_i32 s52, s52, 224
    s_add_u32 s52, s52, s51
    s_lshl_b32 s58, s52, 7
    s_lshl_b32 s59, s3, 10
    s_lshl2_add_u32 s51, s51, s63
    s_mul_i32 s52, s62, 144
    s_add_u32 s51, s51, s52
    s_lshl_b32 s51, s51, 10
    s_add_u32 s77, s51, 8388608
    s_lshr_b32 s51, s7, 2
    s_and_b32 s52, s7, 1
    s_lshl1_add_u32 s51, s51, s52
    s_lshl1_add_u32 s51, s51, s61
    s_lshl_b32 s51, s51, 7
    s_add_u32 s51, s51, s62
    s_lshl_b32 s51, s51, 10
    s_add_u32 s74, s51, 2097152
    v_add_u32 v12, 0x10000, v12
    v_add_u32 v13, 0x10000, v13
    v_add_u32 v46, 0x10000, v46
    v_add_u32 v6, 0x10000, v6
    v_add_u32 v7, 0x10000, v7
    s_waitcnt lgkmcnt(0)
    s_waitcnt vmcnt(4)
    s_barrier
    v_dot2c_f32_bf16 v40, s71, v88
    v_dot2c_f32_bf16 v40, s71, v89
    v_dot2c_f32_bf16 v40, s71, v90
    v_dot2c_f32_bf16 v40, s71, v91
    v_dot2c_f32_bf16 v42, s71, v144
    v_dot2c_f32_bf16 v43, v144, v144
    v_dot2c_f32_bf16 v42, s71, v145
    v_dot2c_f32_bf16 v43, v145, v145
    v_dot2c_f32_bf16 v42, s71, v146
    v_dot2c_f32_bf16 v43, v146, v146
    v_dot2c_f32_bf16 v42, s71, v147
    v_dot2c_f32_bf16 v43, v147, v147
    v_dot2c_f32_bf16 v14, s71, v148
    v_dot2c_f32_bf16 v15, v148, v148
    v_dot2c_f32_bf16 v14, s71, v149
    v_dot2c_f32_bf16 v15, v149, v149
    v_dot2c_f32_bf16 v14, s71, v150
    v_dot2c_f32_bf16 v15, v150, v150
    v_dot2c_f32_bf16 v14, s71, v151
    v_dot2c_f32_bf16 v15, v151, v151
    v_dot2c_f32_bf16 v42, s71, v152
    v_dot2c_f32_bf16 v43, v152, v152
    v_dot2c_f32_bf16 v42, s71, v153
    v_dot2c_f32_bf16 v43, v153, v153
    v_dot2c_f32_bf16 v42, s71, v154
    v_dot2c_f32_bf16 v43, v154, v154
    v_dot2c_f32_bf16 v42, s71, v155
    v_dot2c_f32_bf16 v43, v155, v155
    v_dot2c_f32_bf16 v14, s71, v156
    v_dot2c_f32_bf16 v15, v156, v156
    v_dot2c_f32_bf16 v14, s71, v157
    v_dot2c_f32_bf16 v15, v157, v157
    v_dot2c_f32_bf16 v14, s71, v158
    v_dot2c_f32_bf16 v15, v158, v158
    v_dot2c_f32_bf16 v14, s71, v159
    v_dot2c_f32_bf16 v15, v159, v159
    v_mfma_f32_16x16x32_bf16 v[112:115], v[144:147], v[48:51], v[112:115]
    v_mfma_f32_16x16x32_bf16 v[116:119], v[148:151], v[48:51], v[116:119]
    ds_read_b128 v[160:163], v12 offset:0
    ds_read_b64_tr_b16 v[16:17], v46 offset:16384
    ds_read_b64_tr_b16 v[18:19], v46 offset:16896
    v_mfma_f32_16x16x32_bf16 v[120:123], v[144:147], v[52:55], v[120:123]
    v_mfma_f32_16x16x32_bf16 v[124:127], v[148:151], v[52:55], v[124:127]
    ds_read_b128 v[164:167], v12 offset:2048
    ds_read_b64_tr_b16 v[20:21], v6 offset:16384
    ds_read_b64_tr_b16 v[22:23], v6 offset:16896
    v_mfma_f32_16x16x32_bf16 v[112:115], v[152:155], v[56:59], v[112:115]
    v_mfma_f32_16x16x32_bf16 v[116:119], v[156:159], v[56:59], v[116:119]
    ds_read_b128 v[168:171], v13 offset:0
    ds_read_b64_tr_b16 v[24:25], v46 offset:20480
    ds_read_b64_tr_b16 v[26:27], v46 offset:20992
    v_mfma_f32_16x16x32_bf16 v[120:123], v[152:155], v[60:63], v[120:123]
    v_mfma_f32_16x16x32_bf16 v[124:127], v[156:159], v[60:63], v[124:127]
    ds_read_b128 v[172:175], v13 offset:2048
    ds_read_b64_tr_b16 v[28:29], v6 offset:20480
    ds_read_b64_tr_b16 v[30:31], v6 offset:20992
    ds_read_b64_tr_b16 v[88:89], v7 offset:16384
    ds_read_b64_tr_b16 v[90:91], v7 offset:16896
    s_add_u32 m0, s56, 32768
    s_add_u32 s54, s54, 196608
    buffer_load_dwordx4 v44, s[12:15], s54 offen lds
    buffer_load_dwordx4 v45, s[12:15], s54 offen offset:1024 lds
    v_lshrrev_b32 v3, 2, v1
    v_and_b32 v3, 64, v3
    v_xor_b32 v3, v3, v1
    v_and_b32 v3, 0x70, v3
    s_and_b32 s51, s3, 1
    s_lshl_b32 s51, s51, 5
    v_xor_b32 v3, s51, v3
    v_lshrrev_b32 v4, 7, v1
    v_mul_u32_u24 v8, 3584, v4
    v_add_u32 v8, v8, v3
    v_mov_b32 v3, v9
    s_add_u32 s51, s63, 0
    s_and_b32 s52, s51, 3
    s_lshl_b32 s52, s52, 5
    s_lshr_b32 s51, s51, 2
    s_lshl_b32 s51, s51, 14
    s_or_b32 s51, s51, s52
    v_xor_b32 v9, s51, v3
    s_add_u32 s51, s63, 1
    s_and_b32 s52, s51, 3
    s_lshl_b32 s52, s52, 5
    s_lshr_b32 s51, s51, 2
    s_lshl_b32 s51, s51, 14
    s_or_b32 s51, s51, s52
    v_xor_b32 v10, s51, v3
    s_add_u32 s51, s63, 2
    s_and_b32 s52, s51, 3
    s_lshl_b32 s52, s52, 5
    s_lshr_b32 s51, s51, 2
    s_lshl_b32 s51, s51, 14
    s_or_b32 s51, s51, s52
    v_xor_b32 v11, s51, v3
    s_add_u32 s51, s63, 3
    s_and_b32 s52, s51, 3
    s_lshl_b32 s52, s52, 5
    s_lshr_b32 s51, s51, 2
    s_lshl_b32 s51, s51, 14
    s_or_b32 s51, s51, s52
    v_xor_b32 v47, s51, v3
    s_waitcnt lgkmcnt(0)
    s_waitcnt vmcnt(4)
    s_barrier
    v_dot2c_f32_bf16 v40, s71, v88
    v_dot2c_f32_bf16 v40, s71, v89
    v_dot2c_f32_bf16 v40, s71, v90
    v_dot2c_f32_bf16 v40, s71, v91
    v_dot2c_f32_bf16 v42, s71, v160
    v_dot2c_f32_bf16 v43, v160, v160
    v_dot2c_f32_bf16 v42, s71, v161
    v_dot2c_f32_bf16 v43, v161, v161
    v_dot2c_f32_bf16 v42, s71, v162
    v_dot2c_f32_bf16 v43, v162, v162
    v_dot2c_f32_bf16 v42, s71, v163
    v_dot2c_f32_bf16 v43, v163, v163
    v_dot2c_f32_bf16 v14, s71, v164
    v_dot2c_f32_bf16 v15, v164, v164
    v_dot2c_f32_bf16 v14, s71, v165
    v_dot2c_f32_bf16 v15, v165, v165
    v_dot2c_f32_bf16 v14, s71, v166
    v_dot2c_f32_bf16 v15, v166, v166
    v_dot2c_f32_bf16 v14, s71, v167
    v_dot2c_f32_bf16 v15, v167, v167
    v_dot2c_f32_bf16 v42, s71, v168
    v_dot2c_f32_bf16 v43, v168, v168
    v_dot2c_f32_bf16 v42, s71, v169
    v_dot2c_f32_bf16 v43, v169, v169
    v_dot2c_f32_bf16 v42, s71, v170
    v_dot2c_f32_bf16 v43, v170, v170
    v_dot2c_f32_bf16 v42, s71, v171
    v_dot2c_f32_bf16 v43, v171, v171
    v_dot2c_f32_bf16 v14, s71, v172
    v_dot2c_f32_bf16 v15, v172, v172
    v_dot2c_f32_bf16 v14, s71, v173
    v_dot2c_f32_bf16 v15, v173, v173
    v_dot2c_f32_bf16 v14, s71, v174
    v_dot2c_f32_bf16 v15, v174, v174
    v_dot2c_f32_bf16 v14, s71, v175
    v_dot2c_f32_bf16 v15, v175, v175
    v_mfma_f32_16x16x32_bf16 v[112:115], v[160:163], v[16:19], v[112:115]
    v_mfma_f32_16x16x32_bf16 v[116:119], v[164:167], v[16:19], v[116:119]
    ds_read_b128 v[176:179], v12 offset:32768
    ds_read_b64_tr_b16 v[48:49], v46 offset:49152
    ds_read_b64_tr_b16 v[50:51], v46 offset:49664
    v_mfma_f32_16x16x32_bf16 v[120:123], v[160:163], v[20:23], v[120:123]
    v_mfma_f32_16x16x32_bf16 v[124:127], v[164:167], v[20:23], v[124:127]
    ds_read_b128 v[180:183], v12 offset:34816
    ds_read_b64_tr_b16 v[52:53], v6 offset:49152
    ds_read_b64_tr_b16 v[54:55], v6 offset:49664
    v_mfma_f32_16x16x32_bf16 v[112:115], v[168:171], v[24:27], v[112:115]
    v_mfma_f32_16x16x32_bf16 v[116:119], v[172:175], v[24:27], v[116:119]
    ds_read_b128 v[184:187], v13 offset:32768
    ds_read_b64_tr_b16 v[56:57], v46 offset:53248
    ds_read_b64_tr_b16 v[58:59], v46 offset:53760
    v_mfma_f32_16x16x32_bf16 v[120:123], v[168:171], v[28:31], v[120:123]
    v_mfma_f32_16x16x32_bf16 v[124:127], v[172:175], v[28:31], v[124:127]
    ds_read_b128 v[188:191], v13 offset:34816
    ds_read_b64_tr_b16 v[60:61], v6 offset:53248
    ds_read_b64_tr_b16 v[62:63], v6 offset:53760
    ds_read_b64_tr_b16 v[88:89], v7 offset:49152
    ds_read_b64_tr_b16 v[90:91], v7 offset:49664
    s_add_u32 m0, s56, 65536
    s_add_u32 s54, s54, 196608
    s_cmp_eq_u32 s33, 2
    s_cselect_b32 s52, 1572864, 0
    s_sub_u32 s54, s54, s52
    buffer_load_dwordx4 v44, s[12:15], s54 offen lds
    buffer_load_dwordx4 v45, s[12:15], s54 offen offset:1024 lds
    s_lshr_b32 s51, s62, 1
    s_lshl4_add_u32 s51, s51, s7
    s_lshl1_add_u32 s51, s51, s61
    s_and_b32 s52, s62, 1
    s_lshl1_add_u32 s51, s51, s52
    s_lshl_b32 s51, s51, 3
    s_add_u32 s78, s51, 17891328
    s_lshl_b32 s94, s34, 16
    s_lshl_b32 s52, s35, 7
    s_add_u32 s94, s94, s52
    s_lshl1_add_u32 s0, s7, s61
    s_lshl_b32 s0, s0, 13
    s_add_u32 s0, s0, 18350080
    s_lshl_b32 s52, s6, 9
    s_add_u32 s1, s0, s52
    s_lshl_b32 s51, s61, 1
    s_cmp_eq_u32 s32, s51
    s_cselect_b32 s1, s1, 0x7ff00000
    s_and_b32 s52, s6, 1
    s_lshl_b32 s60, s52, 12
    s_bitcmp1_b32 s6, 1
    s_cselect_b32 s52, 32768, 0
    s_add_u32 s60, s60, s52
    s_and_b32 s52, s32, 1
    s_lshl_b32 s52, s52, 12
    s_add_u32 s0, s0, s52
    s_lshr_b32 s52, s32, 1
    s_lshl_b32 s52, s52, 8
    s_add_u32 s0, s0, s52
    v_add_u32 v12, 0xffff0000, v12
    v_add_u32 v13, 0xffff0000, v13
    v_add_u32 v46, 0xffff0000, v46
    v_add_u32 v6, 0xffff0000, v6
    v_add_u32 v7, 0xffff0000, v7
    s_waitcnt lgkmcnt(0)
    s_waitcnt vmcnt(4)
    s_barrier
    v_dot2c_f32_bf16 v40, s71, v88
    v_dot2c_f32_bf16 v40, s71, v89
    v_dot2c_f32_bf16 v40, s71, v90
    v_dot2c_f32_bf16 v40, s71, v91
    v_dot2c_f32_bf16 v42, s71, v176
    v_dot2c_f32_bf16 v43, v176, v176
    v_dot2c_f32_bf16 v42, s71, v177
    v_dot2c_f32_bf16 v43, v177, v177
    v_dot2c_f32_bf16 v42, s71, v178
    v_dot2c_f32_bf16 v43, v178, v178
    v_dot2c_f32_bf16 v42, s71, v179
    v_dot2c_f32_bf16 v43, v179, v179
    v_dot2c_f32_bf16 v14, s71, v180
    v_dot2c_f32_bf16 v15, v180, v180
    v_dot2c_f32_bf16 v14, s71, v181
    v_dot2c_f32_bf16 v15, v181, v181
    v_dot2c_f32_bf16 v14, s71, v182
    v_dot2c_f32_bf16 v15, v182, v182
    v_dot2c_f32_bf16 v14, s71, v183
    v_dot2c_f32_bf16 v15, v183, v183
    v_dot2c_f32_bf16 v42, s71, v184
    v_dot2c_f32_bf16 v43, v184, v184
    v_dot2c_f32_bf16 v42, s71, v185
    v_dot2c_f32_bf16 v43, v185, v185
    v_dot2c_f32_bf16 v42, s71, v186
    v_dot2c_f32_bf16 v43, v186, v186
    v_dot2c_f32_bf16 v42, s71, v187
    v_dot2c_f32_bf16 v43, v187, v187
    v_dot2c_f32_bf16 v14, s71, v188
    v_dot2c_f32_bf16 v15, v188, v188
    v_dot2c_f32_bf16 v14, s71, v189
    v_dot2c_f32_bf16 v15, v189, v189
    v_dot2c_f32_bf16 v14, s71, v190
    v_dot2c_f32_bf16 v15, v190, v190
    v_dot2c_f32_bf16 v14, s71, v191
    v_dot2c_f32_bf16 v15, v191, v191
    v_mfma_f32_16x16x32_bf16 v[112:115], v[176:179], v[48:51], v[112:115]
    v_mfma_f32_16x16x32_bf16 v[116:119], v[180:183], v[48:51], v[116:119]
    ds_read_b128 v[192:195], v12 offset:0
    ds_read_b64_tr_b16 v[16:17], v46 offset:16384
    ds_read_b64_tr_b16 v[18:19], v46 offset:16896
    v_mfma_f32_16x16x32_bf16 v[120:123], v[176:179], v[52:55], v[120:123]
    v_mfma_f32_16x16x32_bf16 v[124:127], v[180:183], v[52:55], v[124:127]
    ds_read_b128 v[196:199], v12 offset:2048
    ds_read_b64_tr_b16 v[20:21], v6 offset:16384
    ds_read_b64_tr_b16 v[22:23], v6 offset:16896
    v_mfma_f32_16x16x32_bf16 v[112:115], v[184:187], v[56:59], v[112:115]
    v_mfma_f32_16x16x32_bf16 v[116:119], v[188:191], v[56:59], v[116:119]
    ds_read_b128 v[200:203], v13 offset:0
    ds_read_b64_tr_b16 v[24:25], v46 offset:20480
    ds_read_b64_tr_b16 v[26:27], v46 offset:20992
    v_mfma_f32_16x16x32_bf16 v[120:123], v[184:187], v[60:63], v[120:123]
    v_mfma_f32_16x16x32_bf16 v[124:127], v[188:191], v[60:63], v[124:127]
    ds_read_b128 v[204:207], v13 offset:2048
    ds_read_b64_tr_b16 v[28:29], v6 offset:20480
    ds_read_b64_tr_b16 v[30:31], v6 offset:20992
    ds_read_b64_tr_b16 v[88:89], v7 offset:16384
    ds_read_b64_tr_b16 v[90:91], v7 offset:16896
    s_add_u32 m0, s56, 98304
    s_add_u32 s54, s54, 196608
    buffer_load_dwordx4 v44, s[12:15], s54 offen lds
    buffer_load_dwordx4 v45, s[12:15], s54 offen offset:1024 lds
    s_waitcnt lgkmcnt(0)
    s_waitcnt vmcnt(4)
    s_barrier
    s_load_dwordx2 s[48:49], s[44:45], 0
    v_dot2c_f32_bf16 v40, s71, v88
    v_dot2c_f32_bf16 v40, s71, v89
    v_dot2c_f32_bf16 v40, s71, v90
    v_dot2c_f32_bf16 v40, s71, v91
    v_dot2c_f32_bf16 v42, s71, v192
    v_dot2c_f32_bf16 v43, v192, v192
    v_dot2c_f32_bf16 v42, s71, v193
    v_dot2c_f32_bf16 v43, v193, v193
    v_dot2c_f32_bf16 v42, s71, v194
    v_dot2c_f32_bf16 v43, v194, v194
    v_dot2c_f32_bf16 v42, s71, v195
    v_dot2c_f32_bf16 v43, v195, v195
    v_dot2c_f32_bf16 v14, s71, v196
    v_dot2c_f32_bf16 v15, v196, v196
    v_dot2c_f32_bf16 v14, s71, v197
    v_dot2c_f32_bf16 v15, v197, v197
    v_dot2c_f32_bf16 v14, s71, v198
    v_dot2c_f32_bf16 v15, v198, v198
    v_dot2c_f32_bf16 v14, s71, v199
    v_dot2c_f32_bf16 v15, v199, v199
    v_dot2c_f32_bf16 v42, s71, v200
    v_dot2c_f32_bf16 v43, v200, v200
    v_dot2c_f32_bf16 v42, s71, v201
    v_dot2c_f32_bf16 v43, v201, v201
    v_dot2c_f32_bf16 v42, s71, v202
    v_dot2c_f32_bf16 v43, v202, v202
    v_dot2c_f32_bf16 v42, s71, v203
    v_dot2c_f32_bf16 v43, v203, v203
    v_dot2c_f32_bf16 v14, s71, v204
    v_dot2c_f32_bf16 v15, v204, v204
    v_dot2c_f32_bf16 v14, s71, v205
    v_dot2c_f32_bf16 v15, v205, v205
    v_dot2c_f32_bf16 v14, s71, v206
    v_dot2c_f32_bf16 v15, v206, v206
    v_dot2c_f32_bf16 v14, s71, v207
    v_dot2c_f32_bf16 v15, v207, v207
    v_mfma_f32_16x16x32_bf16 v[112:115], v[192:195], v[16:19], v[112:115]
    v_mfma_f32_16x16x32_bf16 v[116:119], v[196:199], v[16:19], v[116:119]
    ds_read_b128 v[208:211], v12 offset:32768
    ds_read_b64_tr_b16 v[48:49], v46 offset:49152
    ds_read_b64_tr_b16 v[50:51], v46 offset:49664
    v_mfma_f32_16x16x32_bf16 v[120:123], v[192:195], v[20:23], v[120:123]
    v_mfma_f32_16x16x32_bf16 v[124:127], v[196:199], v[20:23], v[124:127]
    ds_read_b128 v[212:215], v12 offset:34816
    ds_read_b64_tr_b16 v[52:53], v6 offset:49152
    ds_read_b64_tr_b16 v[54:55], v6 offset:49664
    v_mfma_f32_16x16x32_bf16 v[112:115], v[200:203], v[24:27], v[112:115]
    v_mfma_f32_16x16x32_bf16 v[116:119], v[204:207], v[24:27], v[116:119]
    ds_read_b128 v[216:219], v13 offset:32768
    ds_read_b64_tr_b16 v[56:57], v46 offset:53248
    ds_read_b64_tr_b16 v[58:59], v46 offset:53760
    v_mfma_f32_16x16x32_bf16 v[120:123], v[200:203], v[28:31], v[120:123]
    v_mfma_f32_16x16x32_bf16 v[124:127], v[204:207], v[28:31], v[124:127]
    ds_read_b128 v[220:223], v13 offset:34816
    ds_read_b64_tr_b16 v[60:61], v6 offset:53248
    ds_read_b64_tr_b16 v[62:63], v6 offset:53760
    ds_read_b64_tr_b16 v[88:89], v7 offset:49152
    ds_read_b64_tr_b16 v[90:91], v7 offset:49664
    s_add_u32 m0, s59, 0
    s_nop 0
    buffer_load_dwordx4 v8, s[20:23], s58 offen offset:0 lds
    s_add_u32 m0, s59, 8192
    s_nop 0
    buffer_load_dwordx4 v8, s[24:27], s58 offen offset:0 lds
    s_add_u32 m0, s59, 16256
    s_nop 0
    buffer_load_dwordx4 v8, s[20:23], s58 offen offset:128 lds
    s_add_u32 m0, s59, 24448
    s_nop 0
    buffer_load_dwordx4 v8, s[24:27], s58 offen offset:128 lds
    v_add_u32 v12, 0x10000, v12
    v_add_u32 v13, 0x10000, v13
    v_add_u32 v46, 0x10000, v46
    v_add_u32 v6, 0x10000, v6
    v_add_u32 v7, 0x10000, v7
    s_waitcnt lgkmcnt(0)
    s_waitcnt vmcnt(6)
    s_barrier
    v_dot2c_f32_bf16 v40, s71, v88
    v_dot2c_f32_bf16 v40, s71, v89
    v_dot2c_f32_bf16 v40, s71, v90
    v_dot2c_f32_bf16 v40, s71, v91
    v_dot2c_f32_bf16 v42, s71, v208
    v_dot2c_f32_bf16 v43, v208, v208
    v_dot2c_f32_bf16 v42, s71, v209
    v_dot2c_f32_bf16 v43, v209, v209
    v_dot2c_f32_bf16 v42, s71, v210
    v_dot2c_f32_bf16 v43, v210, v210
    v_dot2c_f32_bf16 v42, s71, v211
    v_dot2c_f32_bf16 v43, v211, v211
    v_dot2c_f32_bf16 v14, s71, v212
    v_dot2c_f32_bf16 v15, v212, v212
    v_dot2c_f32_bf16 v14, s71, v213
    v_dot2c_f32_bf16 v15, v213, v213
    v_dot2c_f32_bf16 v14, s71, v214
    v_dot2c_f32_bf16 v15, v214, v214
    v_dot2c_f32_bf16 v14, s71, v215
    v_dot2c_f32_bf16 v15, v215, v215
    v_dot2c_f32_bf16 v42, s71, v216
    v_dot2c_f32_bf16 v43, v216, v216
    v_dot2c_f32_bf16 v42, s71, v217
    v_dot2c_f32_bf16 v43, v217, v217
    v_dot2c_f32_bf16 v42, s71, v218
    v_dot2c_f32_bf16 v43, v218, v218
    v_dot2c_f32_bf16 v42, s71, v219
    v_dot2c_f32_bf16 v43, v219, v219
    v_dot2c_f32_bf16 v14, s71, v220
    v_dot2c_f32_bf16 v15, v220, v220
    v_dot2c_f32_bf16 v14, s71, v221
    v_dot2c_f32_bf16 v15, v221, v221
    v_dot2c_f32_bf16 v14, s71, v222
    v_dot2c_f32_bf16 v15, v222, v222
    v_dot2c_f32_bf16 v14, s71, v223
    v_dot2c_f32_bf16 v15, v223, v223
    v_mfma_f32_16x16x32_bf16 v[112:115], v[208:211], v[48:51], v[112:115]
    v_mfma_f32_16x16x32_bf16 v[116:119], v[212:215], v[48:51], v[116:119]
    ds_read_b128 v[224:227], v12 offset:0
    ds_read_b64_tr_b16 v[16:17], v46 offset:16384
    ds_read_b64_tr_b16 v[18:19], v46 offset:16896
    v_mfma_f32_16x16x32_bf16 v[120:123], v[208:211], v[52:55], v[120:123]
    v_mfma_f32_16x16x32_bf16 v[124:127], v[212:215], v[52:55], v[124:127]
    ds_read_b128 v[228:231], v12 offset:2048
    ds_read_b64_tr_b16 v[20:21], v6 offset:16384
    ds_read_b64_tr_b16 v[22:23], v6 offset:16896
    v_mfma_f32_16x16x32_bf16 v[112:115], v[216:219], v[56:59], v[112:115]
    v_mfma_f32_16x16x32_bf16 v[116:119], v[220:223], v[56:59], v[116:119]
    ds_read_b128 v[232:235], v13 offset:0
    ds_read_b64_tr_b16 v[24:25], v46 offset:20480
    ds_read_b64_tr_b16 v[26:27], v46 offset:20992
    v_mfma_f32_16x16x32_bf16 v[120:123], v[216:219], v[60:63], v[120:123]
    v_mfma_f32_16x16x32_bf16 v[124:127], v[220:223], v[60:63], v[124:127]
    ds_read_b128 v[236:239], v13 offset:2048
    ds_read_b64_tr_b16 v[28:29], v6 offset:20480
    ds_read_b64_tr_b16 v[30:31], v6 offset:20992
    ds_read_b64_tr_b16 v[88:89], v7 offset:16384
    ds_read_b64_tr_b16 v[90:91], v7 offset:16896
    s_add_u32 m0, s59, 32768
    s_add_u32 s58, s58, 229376
    buffer_load_dwordx4 v8, s[20:23], s58 offen offset:0 lds
    s_add_u32 m0, s59, 40960
    s_nop 0
    buffer_load_dwordx4 v8, s[24:27], s58 offen offset:0 lds
    s_add_u32 m0, s59, 49024
    s_nop 0
    buffer_load_dwordx4 v8, s[20:23], s58 offen offset:128 lds
    s_add_u32 m0, s59, 57216
    s_nop 0
    buffer_load_dwordx4 v8, s[24:27], s58 offen offset:128 lds
    s_waitcnt lgkmcnt(0)
    s_waitcnt vmcnt(8)
    s_barrier
    v_dot2c_f32_bf16 v40, s71, v88
    v_dot2c_f32_bf16 v40, s71, v89
    v_dot2c_f32_bf16 v40, s71, v90
    v_dot2c_f32_bf16 v40, s71, v91
    v_dot2c_f32_bf16 v42, s71, v224
    v_dot2c_f32_bf16 v43, v224, v224
    v_dot2c_f32_bf16 v42, s71, v225
    v_dot2c_f32_bf16 v43, v225, v225
    v_dot2c_f32_bf16 v42, s71, v226
    v_dot2c_f32_bf16 v43, v226, v226
    v_dot2c_f32_bf16 v42, s71, v227
    v_dot2c_f32_bf16 v43, v227, v227
    v_dot2c_f32_bf16 v14, s71, v228
    v_dot2c_f32_bf16 v15, v228, v228
    v_dot2c_f32_bf16 v14, s71, v229
    v_dot2c_f32_bf16 v15, v229, v229
    v_dot2c_f32_bf16 v14, s71, v230
    v_dot2c_f32_bf16 v15, v230, v230
    v_dot2c_f32_bf16 v14, s71, v231
    v_dot2c_f32_bf16 v15, v231, v231
    v_dot2c_f32_bf16 v42, s71, v232
    v_dot2c_f32_bf16 v43, v232, v232
    v_dot2c_f32_bf16 v42, s71, v233
    v_dot2c_f32_bf16 v43, v233, v233
    v_dot2c_f32_bf16 v42, s71, v234
    v_dot2c_f32_bf16 v43, v234, v234
    v_dot2c_f32_bf16 v42, s71, v235
    v_dot2c_f32_bf16 v43, v235, v235
    v_dot2c_f32_bf16 v14, s71, v236
    v_dot2c_f32_bf16 v15, v236, v236
    v_dot2c_f32_bf16 v14, s71, v237
    v_dot2c_f32_bf16 v15, v237, v237
    v_dot2c_f32_bf16 v14, s71, v238
    v_dot2c_f32_bf16 v15, v238, v238
    v_dot2c_f32_bf16 v14, s71, v239
    v_dot2c_f32_bf16 v15, v239, v239
    v_mfma_f32_16x16x32_bf16 v[112:115], v[224:227], v[16:19], v[112:115]
    v_mfma_f32_16x16x32_bf16 v[116:119], v[228:231], v[16:19], v[116:119]
    ds_read_b128 v[240:243], v12 offset:32768
    ds_read_b64_tr_b16 v[48:49], v46 offset:49152
    ds_read_b64_tr_b16 v[50:51], v46 offset:49664
    v_mfma_f32_16x16x32_bf16 v[120:123], v[224:227], v[20:23], v[120:123]
    v_mfma_f32_16x16x32_bf16 v[124:127], v[228:231], v[20:23], v[124:127]
    ds_read_b128 v[244:247], v12 offset:34816
    ds_read_b64_tr_b16 v[52:53], v6 offset:49152
    ds_read_b64_tr_b16 v[54:55], v6 offset:49664
    v_mfma_f32_16x16x32_bf16 v[112:115], v[232:235], v[24:27], v[112:115]
    v_mfma_f32_16x16x32_bf16 v[116:119], v[236:239], v[24:27], v[116:119]
    ds_read_b128 v[248:251], v13 offset:32768
    ds_read_b64_tr_b16 v[56:57], v46 offset:53248
    ds_read_b64_tr_b16 v[58:59], v46 offset:53760
    v_mfma_f32_16x16x32_bf16 v[120:123], v[232:235], v[28:31], v[120:123]
    v_mfma_f32_16x16x32_bf16 v[124:127], v[236:239], v[28:31], v[124:127]
    ds_read_b128 v[252:255], v13 offset:34816
    ds_read_b64_tr_b16 v[60:61], v6 offset:53248
    ds_read_b64_tr_b16 v[62:63], v6 offset:53760
    ds_read_b64_tr_b16 v[88:89], v7 offset:49152
    ds_read_b64_tr_b16 v[90:91], v7 offset:49664
    s_cmp_lg_u32 s48, 0
    s_cbranch_scc1 L_tokGP_x
    s_mov_b32 s50, 131072
L_tokGP:
    buffer_load_dwordx2 v[44:45], off, s[44:47], 0 sc1
    s_waitcnt vmcnt(0)
    v_readfirstlane_b32 s48, v44
    v_readfirstlane_b32 s49, v45
    s_sub_u32 s50, s50, 1
    s_cbranch_scc1 L_tokGP_x
    s_cmp_eq_u32 s48, 0
    s_cbranch_scc1 L_tokGP
L_tokGP_x:
    s_waitcnt lgkmcnt(0)
    v_dot2c_f32_bf16 v40, s71, v88
    v_dot2c_f32_bf16 v40, s71, v89
    v_dot2c_f32_bf16 v40, s71, v90
    v_dot2c_f32_bf16 v40, s71, v91
    v_dot2c_f32_bf16 v42, s71, v240
    v_dot2c_f32_bf16 v43, v240, v240
    v_dot2c_f32_bf16 v42, s71, v241
    v_dot2c_f32_bf16 v43, v241, v241
    v_dot2c_f32_bf16 v42, s71, v242
    v_dot2c_f32_bf16 v43, v242, v242
    v_dot2c_f32_bf16 v42, s71, v243
    v_dot2c_f32_bf16 v43, v243, v243
    v_dot2c_f32_bf16 v14, s71, v244
    v_dot2c_f32_bf16 v15, v244, v244
    v_dot2c_f32_bf16 v14, s71, v245
    v_dot2c_f32_bf16 v15, v245, v245
    v_dot2c_f32_bf16 v14, s71, v246
    v_dot2c_f32_bf16 v15, v246, v246
    v_dot2c_f32_bf16 v14, s71, v247
    v_dot2c_f32_bf16 v15, v247, v247
    v_dot2c_f32_bf16 v42, s71, v248
    v_dot2c_f32_bf16 v43, v248, v248
    v_dot2c_f32_bf16 v42, s71, v249
    v_dot2c_f32_bf16 v43, v249, v249
    v_dot2c_f32_bf16 v42, s71, v250
    v_dot2c_f32_bf16 v43, v250, v250
    v_dot2c_f32_bf16 v42, s71, v251
    v_dot2c_f32_bf16 v43, v251, v251
    v_dot2c_f32_bf16 v14, s71, v252
    v_dot2c_f32_bf16 v15, v252, v252
    v_dot2c_f32_bf16 v14, s71, v253
    v_dot2c_f32_bf16 v15, v253, v253
    v_dot2c_f32_bf16 v14, s71, v254
    v_dot2c_f32_bf16 v15, v254, v254
    v_dot2c_f32_bf16 v14, s71, v255
    v_dot2c_f32_bf16 v15, v255, v255
    s_lshl_b32 s52, s32, 2
    s_add_u32 s52, s52, 155648
    v_add_u32 v4, s52, v1
    v_cvt_pk_bf16_f32 v3, v40, v40
    v_lshlrev_b32 v3, 16, v3
    v_sub_f32 v5, v40, v3
    v_cvt_pk_bf16_f32 v3, v3, v5
    ds_write_b32 v4, v3 offset:0
    v_permlane32_swap_b32 v42, v14
    v_permlane32_swap_b32 v43, v15
    s_nop 1
    v_add_f32 v42, v42, v14
    v_add_f32 v43, v43, v15
    v_mov_b32 v3, v42
    v_mov_b32 v5, v43
    s_nop 1
    v_permlane16_swap_b32 v42, v3
    v_permlane16_swap_b32 v43, v5
    s_nop 1
    v_add_f32 v42, v42, v3
    v_add_f32 v43, v43, v5
    v_mul_f32 v42, 0x3b000000, v42
    v_mul_f32 v43, 0x3b000000, v43
    v_fma_f32 v43, -v42, v42, v43
    v_max_f32 v43, 0, v43
    v_cvt_pk_bf16_f32 v42, -v42, -v42
    v_cvt_pk_bf16_f32 v43, v43, v43
    v_and_b32 v43, s72, v43
    v_add_f32 v43, 0x3727c5ac, v43
    v_cvt_pk_bf16_f32 v43, v43, v43
    v_and_b32 v43, s72, v43
    v_sqrt_f32 v43, v43
    v_and_b32 v3, 0xf0, v1
    v_cvt_pk_bf16_f32 v43, v43, v43
    v_lshrrev_b32 v5, 9, v1
    v_and_b32 v43, s72, v43
    v_lshl_add_u32 v3, v5, 8, v3
    v_rcp_f32 v43, v43
    v_lshrrev_b32 v3, 1, v3
    s_lshl_b32 s52, s32, 9
    s_add_u32 s52, s52, 159744
    v_add_u32 v5, s52, v3
    ds_write_b64 v5, v[42:43]
    s_lshl_b32 s52, s32, 8
    s_add_u32 s52, s52, 161792
    v_lshrrev_b32 v3, 1, v3
    v_add_u32 v3, s52, v3
    ds_write_b32 v3, v43
    s_waitcnt lgkmcnt(0)
    s_waitcnt vmcnt(4)
    s_barrier
    s_setprio 1
    v_mfma_f32_16x16x32_bf16 v[112:115], v[240:243], v[48:51], v[112:115]
    v_mfma_f32_16x16x32_bf16 v[116:119], v[244:247], v[48:51], v[116:119]
    s_lshl_b32 s52, s32, 9
    s_add_u32 s52, s52, 159744
    v_bfe_u32 v3, v1, 4, 4
    v_lshl_add_u32 v3, v3, 3, s52
    ds_read_b64 v[12:13], v3
    ds_read_b64 v[14:15], v3 offset:128
    v_add_u32 v4, 155648, v1
    ds_read_b128 v[32:35], v4 offset:0
    s_lshl_b32 s52, s32, 8
    s_add_u32 s52, s52, 161792
    v_lshrrev_b32 v3, 8, v1
    v_lshl_add_u32 v3, v3, 4, s52
    ds_read_b128 v[96:99], v3 offset:0
    ds_read_b128 v[100:103], v3 offset:64
    v_mfma_f32_16x16x32_bf16 v[120:123], v[240:243], v[52:55], v[120:123]
    v_mfma_f32_16x16x32_bf16 v[124:127], v[244:247], v[52:55], v[124:127]
    ds_read_b64_tr_b16 v[16:17], v9 offset:0
    ds_read_b64_tr_b16 v[18:19], v9 offset:512
    ds_read_b64_tr_b16 v[20:21], v10 offset:0
    ds_read_b64_tr_b16 v[22:23], v10 offset:512
    ds_read_b64_tr_b16 v[24:25], v11 offset:0
    ds_read_b64_tr_b16 v[26:27], v11 offset:512
    ds_read_b64_tr_b16 v[28:29], v47 offset:0
    ds_read_b64_tr_b16 v[30:31], v47 offset:512
    v_mfma_f32_16x16x32_bf16 v[112:115], v[248:251], v[56:59], v[112:115]
    v_mfma_f32_16x16x32_bf16 v[116:119], v[252:255], v[56:59], v[116:119]
    s_waitcnt lgkmcnt(11)
    v_mov_b32 v88, 0
    v_mov_b32 v89, 0
    v_mov_b32 v90, v12
    v_mov_b32 v91, v12
    v_mov_b32 v92, 0
    v_mov_b32 v93, 0
    v_mov_b32 v64, 0
    v_mov_b32 v65, 0
    v_mov_b32 v66, v14
    v_mov_b32 v67, v14
    v_mov_b32 v68, 0
    v_mov_b32 v69, 0
    v_mfma_f32_16x16x32_bf16 v[120:123], v[248:251], v[60:63], v[120:123]
    v_mfma_f32_16x16x32_bf16 v[124:127], v[252:255], v[60:63], v[124:127]
    s_waitcnt lgkmcnt(10)
    v_mfma_f32_16x16x32_bf16 v[112:115], v[90:93], v[32:35], v[112:115]
    v_mfma_f32_16x16x32_bf16 v[116:119], v[66:69], v[32:35], v[116:119]
    v_mfma_f32_16x16x32_bf16 v[120:123], v[88:91], v[32:35], v[120:123]
    v_mfma_f32_16x16x32_bf16 v[124:127], v[64:67], v[32:35], v[124:127]
    s_setprio 0
    s_add_u32 m0, s59, 65536
    s_add_u32 s58, s58, 229376
    s_cmp_eq_u32 s33, 6
    s_cselect_b32 s52, 1835008, 0
    s_sub_u32 s58, s58, s52
    buffer_load_dwordx4 v8, s[20:23], s58 offen offset:0 lds
    s_add_u32 m0, s59, 73728
    s_nop 0
    buffer_load_dwordx4 v8, s[24:27], s58 offen offset:0 lds
    s_add_u32 m0, s59, 81792
    s_nop 0
    buffer_load_dwordx4 v8, s[20:23], s58 offen offset:128 lds
    s_add_u32 m0, s59, 89984
    s_nop 0
    buffer_load_dwordx4 v8, s[24:27], s58 offen offset:128 lds
    v_lshrrev_b32 v46, 1, v1
    v_xor_b32 v46, v46, v1
    v_and_b32 v46, 0x100, v46
    v_mul_u32_u24 v46, 3, v46
    v_xor_b32 v46, v46, v1
    s_waitcnt lgkmcnt(8)
    v_mul_f32 v112, v96, v112
    v_mul_f32 v113, v97, v113
    v_mul_f32 v114, v98, v114
    v_mul_f32 v115, v99, v115
    v_mul_f32 v116, v100, v116
    v_mul_f32 v117, v101, v117
    v_mul_f32 v118, v102, v118
    v_mul_f32 v119, v103, v119
    v_mul_f32 v120, v96, v120
    v_mul_f32 v121, v97, v121
    v_mul_f32 v122, v98, v122
    v_mul_f32 v123, v99, v123
    v_mul_f32 v124, v100, v124
    v_mul_f32 v125, v101, v125
    v_mul_f32 v126, v102, v126
    v_mul_f32 v127, v103, v127
    v_cvt_pk_bf16_f32 v112, v112, v113
    v_cvt_pk_bf16_f32 v113, v114, v115
    v_cvt_pk_bf16_f32 v114, v116, v117
    v_cvt_pk_bf16_f32 v115, v118, v119
    v_cvt_pk_bf16_f32 v116, v120, v121
    v_cvt_pk_bf16_f32 v117, v122, v123
    v_cvt_pk_bf16_f32 v118, v124, v125
    v_cvt_pk_bf16_f32 v119, v126, v127
    v_permlane32_swap_b32 v112, v114
    v_permlane32_swap_b32 v113, v115
    v_permlane32_swap_b32 v116, v118
    v_permlane32_swap_b32 v117, v119
    s_setprio 1
    s_waitcnt lgkmcnt(6)
    v_mfma_f32_16x16x32_bf16 v[48:51], v[16:19], v[128:131], 0
    ds_read_b64_tr_b16 v[32:33], v9 offset:8192
    v_mfma_f32_16x16x32_bf16 v[52:55], v[16:19], v[132:135], 0
    ds_read_b64_tr_b16 v[34:35], v9 offset:8704
    s_waitcnt lgkmcnt(6)
    v_mfma_f32_16x16x32_bf16 v[64:67], v[20:23], v[128:131], 0
    ds_read_b64_tr_b16 v[36:37], v10 offset:8192
    v_mfma_f32_16x16x32_bf16 v[68:71], v[20:23], v[132:135], 0
    ds_read_b64_tr_b16 v[38:39], v10 offset:8704
    s_waitcnt lgkmcnt(6)
    v_mfma_f32_16x16x32_bf16 v[80:83], v[24:27], v[128:131], 0
    ds_read_b64_tr_b16 v[16:17], v11 offset:8192
    v_mfma_f32_16x16x32_bf16 v[84:87], v[24:27], v[132:135], 0
    ds_read_b64_tr_b16 v[18:19], v11 offset:8704
    s_waitcnt lgkmcnt(6)
    v_mfma_f32_16x16x32_bf16 v[96:99], v[28:31], v[128:131], 0
    ds_read_b64_tr_b16 v[20:21], v47 offset:8192
    v_mfma_f32_16x16x32_bf16 v[100:103], v[28:31], v[132:135], 0
    ds_read_b64_tr_b16 v[22:23], v47 offset:8704
    s_waitcnt lgkmcnt(6)
    v_mfma_f32_16x16x32_bf16 v[56:59], v[32:35], v[128:131], 0
    ds_read_b64_tr_b16 v[24:25], v9 offset:4096
    v_mfma_f32_16x16x32_bf16 v[60:63], v[32:35], v[132:135], 0
    ds_read_b64_tr_b16 v[26:27], v9 offset:4608
    s_waitcnt lgkmcnt(6)
    v_mfma_f32_16x16x32_bf16 v[72:75], v[36:39], v[128:131], 0
    ds_read_b64_tr_b16 v[28:29], v10 offset:4096
    v_mfma_f32_16x16x32_bf16 v[76:79], v[36:39], v[132:135], 0
    ds_read_b64_tr_b16 v[30:31], v10 offset:4608
    s_waitcnt lgkmcnt(6)
    v_mfma_f32_16x16x32_bf16 v[88:91], v[16:19], v[128:131], 0
    ds_read_b64_tr_b16 v[32:33], v11 offset:4096
    v_mfma_f32_16x16x32_bf16 v[92:95], v[16:19], v[132:135], 0
    ds_read_b64_tr_b16 v[34:35], v11 offset:4608
    s_waitcnt lgkmcnt(6)
    v_mfma_f32_16x16x32_bf16 v[104:107], v[20:23], v[128:131], 0
    ds_read_b64_tr_b16 v[36:37], v47 offset:4096
    v_mfma_f32_16x16x32_bf16 v[108:111], v[20:23], v[132:135], 0
    ds_read_b64_tr_b16 v[38:39], v47 offset:4608
    s_waitcnt lgkmcnt(6)
    v_mfma_f32_16x16x32_bf16 v[48:51], v[24:27], v[136:139], v[48:51]
    ds_read_b64_tr_b16 v[16:17], v9 offset:12288
    v_mfma_f32_16x16x32_bf16 v[52:55], v[24:27], v[140:143], v[52:55]
    ds_read_b64_tr_b16 v[18:19], v9 offset:12800
    s_waitcnt lgkmcnt(6)
    v_mfma_f32_16x16x32_bf16 v[64:67], v[28:31], v[136:139], v[64:67]
    ds_read_b64_tr_b16 v[20:21], v10 offset:12288
    v_mfma_f32_16x16x32_bf16 v[68:71], v[28:31], v[140:143], v[68:71]
    ds_read_b64_tr_b16 v[22:23], v10 offset:12800
    s_waitcnt lgkmcnt(6)
    v_mfma_f32_16x16x32_bf16 v[80:83], v[32:35], v[136:139], v[80:83]
    ds_read_b64_tr_b16 v[24:25], v11 offset:12288
    v_mfma_f32_16x16x32_bf16 v[84:87], v[32:35], v[140:143], v[84:87]
    ds_read_b64_tr_b16 v[26:27], v11 offset:12800
    s_waitcnt lgkmcnt(6)
    v_mfma_f32_16x16x32_bf16 v[96:99], v[36:39], v[136:139], v[96:99]
    ds_read_b64_tr_b16 v[28:29], v47 offset:12288
    v_mfma_f32_16x16x32_bf16 v[100:103], v[36:39], v[140:143], v[100:103]
    ds_read_b64_tr_b16 v[30:31], v47 offset:12800
    s_setprio 0
    s_add_u32 s52, s74, 4194304
    s_add_u32 s53, s74, 4259840
    buffer_store_dwordx4 v[112:115], v1, s[16:19], s52 offen sc1
    buffer_store_dwordx4 v[116:119], v1, s[16:19], s53 offen sc1
    s_setprio 1
    s_waitcnt vmcnt(6)
    s_barrier
    s_waitcnt lgkmcnt(6)
    v_mfma_f32_16x16x32_bf16 v[56:59], v[16:19], v[136:139], v[56:59]
    ds_read_b64_tr_b16 v[32:33], v9 offset:32768
    v_mfma_f32_16x16x32_bf16 v[60:63], v[16:19], v[140:143], v[60:63]
    ds_read_b64_tr_b16 v[34:35], v9 offset:33280
    s_waitcnt lgkmcnt(6)
    v_mfma_f32_16x16x32_bf16 v[72:75], v[20:23], v[136:139], v[72:75]
    ds_read_b64_tr_b16 v[36:37], v10 offset:32768
    v_mfma_f32_16x16x32_bf16 v[76:79], v[20:23], v[140:143], v[76:79]
    ds_read_b64_tr_b16 v[38:39], v10 offset:33280
    s_waitcnt lgkmcnt(6)
    v_mfma_f32_16x16x32_bf16 v[88:91], v[24:27], v[136:139], v[88:91]
    ds_read_b64_tr_b16 v[16:17], v11 offset:32768
    v_mfma_f32_16x16x32_bf16 v[92:95], v[24:27], v[140:143], v[92:95]
    ds_read_b64_tr_b16 v[18:19], v11 offset:33280
    s_waitcnt lgkmcnt(6)
    v_mfma_f32_16x16x32_bf16 v[104:107], v[28:31], v[136:139], v[104:107]
    ds_read_b64_tr_b16 v[20:21], v47 offset:32768
    v_mfma_f32_16x16x32_bf16 v[108:111], v[28:31], v[140:143], v[108:111]
    ds_read_b64_tr_b16 v[22:23], v47 offset:33280
    s_waitcnt lgkmcnt(6)
    v_mfma_f32_16x16x32_bf16 v[48:51], v[32:35], v[144:147], v[48:51]
    ds_read_b64_tr_b16 v[24:25], v9 offset:40960
    v_mfma_f32_16x16x32_bf16 v[52:55], v[32:35], v[148:151], v[52:55]
    ds_read_b64_tr_b16 v[26:27], v9 offset:41472
    s_waitcnt lgkmcnt(6)
    v_mfma_f32_16x16x32_bf16 v[64:67], v[36:39], v[144:147], v[64:67]
    ds_read_b64_tr_b16 v[28:29], v10 offset:40960
    v_mfma_f32_16x16x32_bf16 v[68:71], v[36:39], v[148:151], v[68:71]
    ds_read_b64_tr_b16 v[30:31], v10 offset:41472
    s_waitcnt lgkmcnt(6)
    v_mfma_f32_16x16x32_bf16 v[80:83], v[16:19], v[144:147], v[80:83]
    ds_read_b64_tr_b16 v[32:33], v11 offset:40960
    v_mfma_f32_16x16x32_bf16 v[84:87], v[16:19], v[148:151], v[84:87]
    ds_read_b64_tr_b16 v[34:35], v11 offset:41472
    s_waitcnt lgkmcnt(6)
    v_mfma_f32_16x16x32_bf16 v[96:99], v[20:23], v[144:147], v[96:99]
    ds_read_b64_tr_b16 v[36:37], v47 offset:40960
    v_mfma_f32_16x16x32_bf16 v[100:103], v[20:23], v[148:151], v[100:103]
    ds_read_b64_tr_b16 v[38:39], v47 offset:41472
    s_waitcnt lgkmcnt(6)
    v_mfma_f32_16x16x32_bf16 v[56:59], v[24:27], v[144:147], v[56:59]
    ds_read_b64_tr_b16 v[16:17], v9 offset:36864
    v_mfma_f32_16x16x32_bf16 v[60:63], v[24:27], v[148:151], v[60:63]
    ds_read_b64_tr_b16 v[18:19], v9 offset:37376
    s_waitcnt lgkmcnt(6)
    v_mfma_f32_16x16x32_bf16 v[72:75], v[28:31], v[144:147], v[72:75]
    ds_read_b64_tr_b16 v[20:21], v10 offset:36864
    v_mfma_f32_16x16x32_bf16 v[76:79], v[28:31], v[148:151], v[76:79]
    ds_read_b64_tr_b16 v[22:23], v10 offset:37376
    s_waitcnt lgkmcnt(6)
    v_mfma_f32_16x16x32_bf16 v[88:91], v[32:35], v[144:147], v[88:91]
    ds_read_b64_tr_b16 v[24:25], v11 offset:36864
    v_mfma_f32_16x16x32_bf16 v[92:95], v[32:35], v[148:151], v[92:95]
    ds_read_b64_tr_b16 v[26:27], v11 offset:37376
    s_waitcnt lgkmcnt(6)
    v_mfma_f32_16x16x32_bf16 v[104:107], v[36:39], v[144:147], v[104:107]
    ds_read_b64_tr_b16 v[28:29], v47 offset:36864
    v_mfma_f32_16x16x32_bf16 v[108:111], v[36:39], v[148:151], v[108:111]
    ds_read_b64_tr_b16 v[30:31], v47 offset:37376
    s_waitcnt lgkmcnt(6)
    v_mfma_f32_16x16x32_bf16 v[48:51], v[16:19], v[152:155], v[48:51]
    ds_read_b64_tr_b16 v[32:33], v9 offset:45056
    v_mfma_f32_16x16x32_bf16 v[52:55], v[16:19], v[156:159], v[52:55]
    ds_read_b64_tr_b16 v[34:35], v9 offset:45568
    s_waitcnt lgkmcnt(6)
    v_mfma_f32_16x16x32_bf16 v[64:67], v[20:23], v[152:155], v[64:67]
    ds_read_b64_tr_b16 v[36:37], v10 offset:45056
    v_mfma_f32_16x16x32_bf16 v[68:71], v[20:23], v[156:159], v[68:71]
    ds_read_b64_tr_b16 v[38:39], v10 offset:45568
    s_waitcnt lgkmcnt(6)
    v_mfma_f32_16x16x32_bf16 v[80:83], v[24:27], v[152:155], v[80:83]
    ds_read_b64_tr_b16 v[16:17], v11 offset:45056
    v_mfma_f32_16x16x32_bf16 v[84:87], v[24:27], v[156:159], v[84:87]
    ds_read_b64_tr_b16 v[18:19], v11 offset:45568
    s_waitcnt lgkmcnt(6)
    v_mfma_f32_16x16x32_bf16 v[96:99], v[28:31], v[152:155], v[96:99]
    ds_read_b64_tr_b16 v[20:21], v47 offset:45056
    v_mfma_f32_16x16x32_bf16 v[100:103], v[28:31], v[156:159], v[100:103]
    ds_read_b64_tr_b16 v[22:23], v47 offset:45568
    s_setprio 0
    s_add_u32 m0, s59, 98304
    s_add_u32 s58, s58, 229376
    buffer_load_dwordx4 v8, s[20:23], s58 offen offset:0 lds
    s_add_u32 m0, s59, 106496
    s_nop 0
    buffer_load_dwordx4 v8, s[24:27], s58 offen offset:0 lds
    s_add_u32 m0, s59, 114560
    s_nop 0
    buffer_load_dwordx4 v8, s[20:23], s58 offen offset:128 lds
    s_add_u32 m0, s59, 122752
    s_nop 0
    buffer_load_dwordx4 v8, s[24:27], s58 offen offset:128 lds
    s_cmp_lg_u32 s32, 2
    s_cbranch_scc1 L_ncsGP
    v_mov_b32 v40, 0
    v_mov_b32 v44, 0
    v_mov_b32 v41, 0
    v_mov_b32 v45, 0
    v_mov_b32 v42, 0
    v_mov_b32 v4, 0
    v_mov_b32 v43, 0
    v_mov_b32 v5, 0
    v_add_u32 v3, s60, v9
    ds_read_b64_tr_b16 v[128:129], v3 offset:0
    ds_read_b64_tr_b16 v[130:131], v3 offset:512
    ds_read_b64_tr_b16 v[132:133], v3 offset:8192
    ds_read_b64_tr_b16 v[134:135], v3 offset:8704
    v_add_u32 v3, s60, v10
    ds_read_b64_tr_b16 v[120:121], v3 offset:0
    ds_read_b64_tr_b16 v[122:123], v3 offset:512
    ds_read_b64_tr_b16 v[124:125], v3 offset:8192
    ds_read_b64_tr_b16 v[126:127], v3 offset:8704
    s_waitcnt lgkmcnt(0)
    v_dot2c_f32_bf16 v40, s71, v128
    v_dot2c_f32_bf16 v40, s71, v129
    v_dot2c_f32_bf16 v40, s71, v130
    v_dot2c_f32_bf16 v40, s71, v131
    v_dot2c_f32_bf16 v44, s71, v132
    v_dot2c_f32_bf16 v44, s71, v133
    v_dot2c_f32_bf16 v44, s71, v134
    v_dot2c_f32_bf16 v44, s71, v135
    v_dot2c_f32_bf16 v41, s71, v120
    v_dot2c_f32_bf16 v41, s71, v121
    v_dot2c_f32_bf16 v41, s71, v122
    v_dot2c_f32_bf16 v41, s71, v123
    v_dot2c_f32_bf16 v45, s71, v124
    v_dot2c_f32_bf16 v45, s71, v125
    v_dot2c_f32_bf16 v45, s71, v126
    v_dot2c_f32_bf16 v45, s71, v127
    v_add_u32 v3, s60, v11
    ds_read_b64_tr_b16 v[128:129], v3 offset:0
    ds_read_b64_tr_b16 v[130:131], v3 offset:512
    ds_read_b64_tr_b16 v[132:133], v3 offset:8192
    ds_read_b64_tr_b16 v[134:135], v3 offset:8704
    v_add_u32 v3, s60, v47
    ds_read_b64_tr_b16 v[120:121], v3 offset:0
    ds_read_b64_tr_b16 v[122:123], v3 offset:512
    ds_read_b64_tr_b16 v[124:125], v3 offset:8192
    ds_read_b64_tr_b16 v[126:127], v3 offset:8704
    s_waitcnt lgkmcnt(0)
    v_dot2c_f32_bf16 v42, s71, v128
    v_dot2c_f32_bf16 v42, s71, v129
    v_dot2c_f32_bf16 v42, s71, v130
    v_dot2c_f32_bf16 v42, s71, v131
    v_dot2c_f32_bf16 v4, s71, v132
    v_dot2c_f32_bf16 v4, s71, v133
    v_dot2c_f32_bf16 v4, s71, v134
    v_dot2c_f32_bf16 v4, s71, v135
    v_dot2c_f32_bf16 v43, s71, v120
    v_dot2c_f32_bf16 v43, s71, v121
    v_dot2c_f32_bf16 v43, s71, v122
    v_dot2c_f32_bf16 v43, s71, v123
    v_dot2c_f32_bf16 v5, s71, v124
    v_dot2c_f32_bf16 v5, s71, v125
    v_dot2c_f32_bf16 v5, s71, v126
    v_dot2c_f32_bf16 v5, s71, v127
    s_nop 2
    v_permlane32_swap_b32 v40, v44
    v_permlane32_swap_b32 v41, v45
    v_permlane32_swap_b32 v42, v4
    v_permlane32_swap_b32 v43, v5
    s_nop 0
    v_add_f32 v40, v40, v44
    v_add_f32 v41, v41, v45
    v_add_f32 v42, v42, v4
    v_add_f32 v43, v43, v5
    v_mov_b32 v44, v40
    v_mov_b32 v45, v41
    v_mov_b32 v4, v42
    v_mov_b32 v5, v43
    s_nop 1
    v_permlane16_swap_b32 v40, v44
    v_permlane16_swap_b32 v41, v45
    v_permlane16_swap_b32 v42, v4
    v_permlane16_swap_b32 v43, v5
    s_nop 0
    v_add_f32 v40, v40, v44
    v_add_f32 v41, v41, v45
    v_add_f32 v42, v42, v4
    v_add_f32 v43, v43, v5
L_ncsGP:
    s_mov_b32 exec_lo, 0xffff
    s_mov_b32 exec_hi, 0xffff
    buffer_store_dwordx4 v[40:43], v46, s[16:19], s1 offen sc1
    s_mov_b64 exec, -1
    s_nop 0
    s_setprio 1
    v_add_u32 v9, 0x10000, v9
    v_add_u32 v10, 0x10000, v10
    v_add_u32 v11, 0x10000, v11
    v_add_u32 v47, 0x10000, v47
    s_waitcnt vmcnt(7)
    s_waitcnt vmcnt(5)
    s_barrier
    s_waitcnt lgkmcnt(6)
    v_mfma_f32_16x16x32_bf16 v[56:59], v[32:35], v[152:155], v[56:59]
    ds_read_b64_tr_b16 v[24:25], v9 offset:0
    v_mfma_f32_16x16x32_bf16 v[60:63], v[32:35], v[156:159], v[60:63]
    ds_read_b64_tr_b16 v[26:27], v9 offset:512
    s_waitcnt lgkmcnt(6)
    v_mfma_f32_16x16x32_bf16 v[72:75], v[36:39], v[152:155], v[72:75]
    ds_read_b64_tr_b16 v[28:29], v10 offset:0
    v_mfma_f32_16x16x32_bf16 v[76:79], v[36:39], v[156:159], v[76:79]
    ds_read_b64_tr_b16 v[30:31], v10 offset:512
    s_waitcnt lgkmcnt(6)
    v_mfma_f32_16x16x32_bf16 v[88:91], v[16:19], v[152:155], v[88:91]
    ds_read_b64_tr_b16 v[32:33], v11 offset:0
    v_mfma_f32_16x16x32_bf16 v[92:95], v[16:19], v[156:159], v[92:95]
    ds_read_b64_tr_b16 v[34:35], v11 offset:512
    s_waitcnt lgkmcnt(6)
    v_mfma_f32_16x16x32_bf16 v[104:107], v[20:23], v[152:155], v[104:107]
    ds_read_b64_tr_b16 v[36:37], v47 offset:0
    v_mfma_f32_16x16x32_bf16 v[108:111], v[20:23], v[156:159], v[108:111]
    ds_read_b64_tr_b16 v[38:39], v47 offset:512
    s_waitcnt lgkmcnt(6)
    v_mfma_f32_16x16x32_bf16 v[48:51], v[24:27], v[160:163], v[48:51]
    ds_read_b64_tr_b16 v[16:17], v9 offset:8192
    v_mfma_f32_16x16x32_bf16 v[52:55], v[24:27], v[164:167], v[52:55]
    ds_read_b64_tr_b16 v[18:19], v9 offset:8704
    s_waitcnt lgkmcnt(6)
    v_mfma_f32_16x16x32_bf16 v[64:67], v[28:31], v[160:163], v[64:67]
    ds_read_b64_tr_b16 v[20:21], v10 offset:8192
    v_mfma_f32_16x16x32_bf16 v[68:71], v[28:31], v[164:167], v[68:71]
    ds_read_b64_tr_b16 v[22:23], v10 offset:8704
    s_waitcnt lgkmcnt(6)
    v_mfma_f32_16x16x32_bf16 v[80:83], v[32:35], v[160:163], v[80:83]
    ds_read_b64_tr_b16 v[24:25], v11 offset:8192
    v_mfma_f32_16x16x32_bf16 v[84:87], v[32:35], v[164:167], v[84:87]
    ds_read_b64_tr_b16 v[26:27], v11 offset:8704
    s_waitcnt lgkmcnt(6)
    v_mfma_f32_16x16x32_bf16 v[96:99], v[36:39], v[160:163], v[96:99]
    ds_read_b64_tr_b16 v[28:29], v47 offset:8192
    v_mfma_f32_16x16x32_bf16 v[100:103], v[36:39], v[164:167], v[100:103]
    ds_read_b64_tr_b16 v[30:31], v47 offset:8704
    s_waitcnt lgkmcnt(6)
    v_mfma_f32_16x16x32_bf16 v[56:59], v[16:19], v[160:163], v[56:59]
    ds_read_b64_tr_b16 v[32:33], v9 offset:4096
    v_mfma_f32_16x16x32_bf16 v[60:63], v[16:19], v[164:167], v[60:63]
    ds_read_b64_tr_b16 v[34:35], v9 offset:4608
    s_waitcnt lgkmcnt(6)
    v_mfma_f32_16x16x32_bf16 v[72:75], v[20:23], v[160:163], v[72:75]
    ds_read_b64_tr_b16 v[36:37], v10 offset:4096
    v_mfma_f32_16x16x32_bf16 v[76:79], v[20:23], v[164:167], v[76:79]
    ds_read_b64_tr_b16 v[38:39], v10 offset:4608
    s_waitcnt lgkmcnt(6)
    v_mfma_f32_16x16x32_bf16 v[88:91], v[24:27], v[160:163], v[88:91]
    ds_read_b64_tr_b16 v[16:17], v11 offset:4096
    v_mfma_f32_16x16x32_bf16 v[92:95], v[24:27], v[164:167], v[92:95]
    ds_read_b64_tr_b16 v[18:19], v11 offset:4608
    s_waitcnt lgkmcnt(6)
    v_mfma_f32_16x16x32_bf16 v[104:107], v[28:31], v[160:163], v[104:107]
    ds_read_b64_tr_b16 v[20:21], v47 offset:4096
    v_mfma_f32_16x16x32_bf16 v[108:111], v[28:31], v[164:167], v[108:111]
    ds_read_b64_tr_b16 v[22:23], v47 offset:4608
    s_waitcnt lgkmcnt(6)
    v_mfma_f32_16x16x32_bf16 v[48:51], v[32:35], v[168:171], v[48:51]
    ds_read_b64_tr_b16 v[24:25], v9 offset:12288
    v_mfma_f32_16x16x32_bf16 v[52:55], v[32:35], v[172:175], v[52:55]
    ds_read_b64_tr_b16 v[26:27], v9 offset:12800
    s_waitcnt lgkmcnt(6)
    v_mfma_f32_16x16x32_bf16 v[64:67], v[36:39], v[168:171], v[64:67]
    ds_read_b64_tr_b16 v[28:29], v10 offset:12288
    v_mfma_f32_16x16x32_bf16 v[68:71], v[36:39], v[172:175], v[68:71]
    ds_read_b64_tr_b16 v[30:31], v10 offset:12800
    s_waitcnt lgkmcnt(6)
    v_mfma_f32_16x16x32_bf16 v[80:83], v[16:19], v[168:171], v[80:83]
    ds_read_b64_tr_b16 v[32:33], v11 offset:12288
    v_mfma_f32_16x16x32_bf16 v[84:87], v[16:19], v[172:175], v[84:87]
    ds_read_b64_tr_b16 v[34:35], v11 offset:12800
    s_waitcnt lgkmcnt(6)
    v_mfma_f32_16x16x32_bf16 v[96:99], v[20:23], v[168:171], v[96:99]
    ds_read_b64_tr_b16 v[36:37], v47 offset:12288
    v_mfma_f32_16x16x32_bf16 v[100:103], v[20:23], v[172:175], v[100:103]
    ds_read_b64_tr_b16 v[38:39], v47 offset:12800
    s_setprio 0
    s_add_u32 m0, s59, 0
    s_add_u32 s58, s58, 229376
    s_cmp_eq_u32 s33, 4
    s_cselect_b32 s52, 1835008, 0
    s_sub_u32 s58, s58, s52
    buffer_load_dwordx4 v8, s[20:23], s58 offen offset:0 lds
    s_add_u32 m0, s59, 8192
    s_nop 0
    buffer_load_dwordx4 v8, s[24:27], s58 offen offset:0 lds
    s_add_u32 m0, s59, 16256
    s_nop 0
    buffer_load_dwordx4 v8, s[20:23], s58 offen offset:128 lds
    s_add_u32 m0, s59, 24448
    s_nop 0
    buffer_load_dwordx4 v8, s[24:27], s58 offen offset:128 lds
    v_lshrrev_b32 v5, 2, v1
    v_and_b32 v5, 64, v5
    v_lshrrev_b32 v3, 4, v1
    v_and_b32 v3, 32, v3
    v_xor_b32 v5, v5, v3
    v_and_b32 v3, 0x70, v1
    v_xor_b32 v5, v5, v3
    v_and_b32 v3, 0x380, v1
    v_lshl_add_u32 v6, v3, 3, v5
    v_and_b32 v3, 0x1c0, v1
    v_lshlrev_b32 v3, 1, v3
    v_and_b32 v5, 0x200, v1
    v_lshl_add_u32 v3, v5, 2, v3
    v_bfe_u32 v5, v1, 8, 1
    v_lshl_add_u32 v3, v5, 5, v3
    v_and_b32 v5, 0xb0, v1
    v_lshrrev_b32 v5, 1, v5
    v_add_u32 v7, v3, v5
    s_setprio 1
    s_waitcnt vmcnt(5)
    s_waitcnt vmcnt(4)
    s_barrier
    s_waitcnt lgkmcnt(6)
    v_mfma_f32_16x16x32_bf16 v[56:59], v[24:27], v[168:171], v[56:59]
    ds_read_b64_tr_b16 v[16:17], v9 offset:32768
    v_mfma_f32_16x16x32_bf16 v[60:63], v[24:27], v[172:175], v[60:63]
    ds_read_b64_tr_b16 v[18:19], v9 offset:33280
    s_waitcnt lgkmcnt(6)
    v_mfma_f32_16x16x32_bf16 v[72:75], v[28:31], v[168:171], v[72:75]
    ds_read_b64_tr_b16 v[20:21], v10 offset:32768
    v_mfma_f32_16x16x32_bf16 v[76:79], v[28:31], v[172:175], v[76:79]
    ds_read_b64_tr_b16 v[22:23], v10 offset:33280
    s_waitcnt lgkmcnt(6)
    v_mfma_f32_16x16x32_bf16 v[88:91], v[32:35], v[168:171], v[88:91]
    ds_read_b64_tr_b16 v[24:25], v11 offset:32768
    v_mfma_f32_16x16x32_bf16 v[92:95], v[32:35], v[172:175], v[92:95]
    ds_read_b64_tr_b16 v[26:27], v11 offset:33280
    s_waitcnt lgkmcnt(6)
    v_mfma_f32_16x16x32_bf16 v[104:107], v[36:39], v[168:171], v[104:107]
    ds_read_b64_tr_b16 v[28:29], v47 offset:32768
    v_mfma_f32_16x16x32_bf16 v[108:111], v[36:39], v[172:175], v[108:111]
    ds_read_b64_tr_b16 v[30:31], v47 offset:33280
    s_waitcnt lgkmcnt(6)
    v_mfma_f32_16x16x32_bf16 v[48:51], v[16:19], v[176:179], v[48:51]
    ds_read_b64_tr_b16 v[32:33], v9 offset:40960
    v_mfma_f32_16x16x32_bf16 v[52:55], v[16:19], v[180:183], v[52:55]
    ds_read_b64_tr_b16 v[34:35], v9 offset:41472
    s_waitcnt lgkmcnt(6)
    v_mfma_f32_16x16x32_bf16 v[64:67], v[20:23], v[176:179], v[64:67]
    ds_read_b64_tr_b16 v[36:37], v10 offset:40960
    v_mfma_f32_16x16x32_bf16 v[68:71], v[20:23], v[180:183], v[68:71]
    ds_read_b64_tr_b16 v[38:39], v10 offset:41472
    s_waitcnt lgkmcnt(6)
    v_mfma_f32_16x16x32_bf16 v[80:83], v[24:27], v[176:179], v[80:83]
    ds_read_b64_tr_b16 v[16:17], v11 offset:40960
    v_mfma_f32_16x16x32_bf16 v[84:87], v[24:27], v[180:183], v[84:87]
    ds_read_b64_tr_b16 v[18:19], v11 offset:41472
    s_waitcnt lgkmcnt(6)
    v_mfma_f32_16x16x32_bf16 v[96:99], v[28:31], v[176:179], v[96:99]
    ds_read_b64_tr_b16 v[20:21], v47 offset:40960
    v_mfma_f32_16x16x32_bf16 v[100:103], v[28:31], v[180:183], v[100:103]
    ds_read_b64_tr_b16 v[22:23], v47 offset:41472
    s_waitcnt lgkmcnt(6)
    v_mfma_f32_16x16x32_bf16 v[56:59], v[32:35], v[176:179], v[56:59]
    ds_read_b64_tr_b16 v[24:25], v9 offset:36864
    v_mfma_f32_16x16x32_bf16 v[60:63], v[32:35], v[180:183], v[60:63]
    ds_read_b64_tr_b16 v[26:27], v9 offset:37376
    s_waitcnt lgkmcnt(6)
    v_mfma_f32_16x16x32_bf16 v[72:75], v[36:39], v[176:179], v[72:75]
    ds_read_b64_tr_b16 v[28:29], v10 offset:36864
    v_mfma_f32_16x16x32_bf16 v[76:79], v[36:39], v[180:183], v[76:79]
    ds_read_b64_tr_b16 v[30:31], v10 offset:37376
    s_waitcnt lgkmcnt(6)
    v_mfma_f32_16x16x32_bf16 v[88:91], v[16:19], v[176:179], v[88:91]
    ds_read_b64_tr_b16 v[32:33], v11 offset:36864
    v_mfma_f32_16x16x32_bf16 v[92:95], v[16:19], v[180:183], v[92:95]
    ds_read_b64_tr_b16 v[34:35], v11 offset:37376
    s_waitcnt lgkmcnt(6)
    v_mfma_f32_16x16x32_bf16 v[104:107], v[20:23], v[176:179], v[104:107]
    ds_read_b64_tr_b16 v[36:37], v47 offset:36864
    v_mfma_f32_16x16x32_bf16 v[108:111], v[20:23], v[180:183], v[108:111]
    ds_read_b64_tr_b16 v[38:39], v47 offset:37376
    s_waitcnt lgkmcnt(6)
    v_mfma_f32_16x16x32_bf16 v[48:51], v[24:27], v[184:187], v[48:51]
    ds_read_b64_tr_b16 v[16:17], v9 offset:45056
    v_mfma_f32_16x16x32_bf16 v[52:55], v[24:27], v[188:191], v[52:55]
    ds_read_b64_tr_b16 v[18:19], v9 offset:45568
    s_waitcnt lgkmcnt(6)
    v_mfma_f32_16x16x32_bf16 v[64:67], v[28:31], v[184:187], v[64:67]
    ds_read_b64_tr_b16 v[20:21], v10 offset:45056
    v_mfma_f32_16x16x32_bf16 v[68:71], v[28:31], v[188:191], v[68:71]
    ds_read_b64_tr_b16 v[22:23], v10 offset:45568
    s_waitcnt lgkmcnt(6)
    v_mfma_f32_16x16x32_bf16 v[80:83], v[32:35], v[184:187], v[80:83]
    ds_read_b64_tr_b16 v[24:25], v11 offset:45056
    v_mfma_f32_16x16x32_bf16 v[84:87], v[32:35], v[188:191], v[84:87]
    ds_read_b64_tr_b16 v[26:27], v11 offset:45568
    s_waitcnt lgkmcnt(6)
    v_mfma_f32_16x16x32_bf16 v[96:99], v[36:39], v[184:187], v[96:99]
    ds_read_b64_tr_b16 v[28:29], v47 offset:45056
    v_mfma_f32_16x16x32_bf16 v[100:103], v[36:39], v[188:191], v[100:103]
    ds_read_b64_tr_b16 v[30:31], v47 offset:45568
    s_setprio 0
    s_add_u32 m0, s59, 32768
    s_add_u32 s58, s58, 229376
    buffer_load_dwordx4 v8, s[20:23], s58 offen offset:0 lds
    s_add_u32 m0, s59, 40960
    s_nop 0
    buffer_load_dwordx4 v8, s[24:27], s58 offen offset:0 lds
    s_add_u32 m0, s59, 49024
    s_nop 0
    buffer_load_dwordx4 v8, s[20:23], s58 offen offset:128 lds
    s_add_u32 m0, s59, 57216
    s_nop 0
    buffer_load_dwordx4 v8, s[24:27], s58 offen offset:128 lds
    v_lshlrev_b32 v44, 2, v1
    s_cmp_eq_u32 s32, 3
    s_cbranch_scc1 L_tchOGP
    s_mul_i32 s52, s2, 3
    s_add_u32 s52, s52, s32
    s_mul_i32 s52, s52, 2432
    s_mov_b32 exec_hi, 0x3f
    buffer_load_dword v128, v44, s[28:31], s52 offen
    s_branch L_tchXGP
L_tchOGP:
    s_lshl_b32 s52, s2, 11
    s_mov_b32 exec_hi, 0
    buffer_load_dword v128, v44, s[36:39], s52 offen
L_tchXGP:
    s_mov_b32 exec_hi, -1
    s_setprio 1
    v_add_u32 v9, 0xffff0000, v9
    v_add_u32 v10, 0xffff0000, v10
    v_add_u32 v11, 0xffff0000, v11
    v_add_u32 v47, 0xffff0000, v47
    s_waitcnt vmcnt(5)
    s_barrier
    s_waitcnt lgkmcnt(6)
    v_mfma_f32_16x16x32_bf16 v[56:59], v[16:19], v[184:187], v[56:59]
    ds_read_b64_tr_b16 v[32:33], v9 offset:0
    v_mfma_f32_16x16x32_bf16 v[60:63], v[16:19], v[188:191], v[60:63]
    ds_read_b64_tr_b16 v[34:35], v9 offset:512
    s_waitcnt lgkmcnt(6)
    v_mfma_f32_16x16x32_bf16 v[72:75], v[20:23], v[184:187], v[72:75]
    ds_read_b64_tr_b16 v[36:37], v10 offset:0
    v_mfma_f32_16x16x32_bf16 v[76:79], v[20:23], v[188:191], v[76:79]
    ds_read_b64_tr_b16 v[38:39], v10 offset:512
    s_waitcnt lgkmcnt(6)
    v_mfma_f32_16x16x32_bf16 v[88:91], v[24:27], v[184:187], v[88:91]
    ds_read_b64_tr_b16 v[16:17], v11 offset:0
    v_mfma_f32_16x16x32_bf16 v[92:95], v[24:27], v[188:191], v[92:95]
    ds_read_b64_tr_b16 v[18:19], v11 offset:512
    s_waitcnt lgkmcnt(6)
    v_mfma_f32_16x16x32_bf16 v[104:107], v[28:31], v[184:187], v[104:107]
    ds_read_b64_tr_b16 v[20:21], v47 offset:0
    v_mfma_f32_16x16x32_bf16 v[108:111], v[28:31], v[188:191], v[108:111]
    ds_read_b64_tr_b16 v[22:23], v47 offset:512
    s_waitcnt lgkmcnt(6)
    v_mfma_f32_16x16x32_bf16 v[48:51], v[32:35], v[192:195], v[48:51]
    ds_read_b64_tr_b16 v[24:25], v9 offset:8192
    v_mfma_f32_16x16x32_bf16 v[52:55], v[32:35], v[196:199], v[52:55]
    ds_read_b64_tr_b16 v[26:27], v9 offset:8704
    s_waitcnt lgkmcnt(6)
    v_mfma_f32_16x16x32_bf16 v[64:67], v[36:39], v[192:195], v[64:67]
    ds_read_b64_tr_b16 v[28:29], v10 offset:8192
    v_mfma_f32_16x16x32_bf16 v[68:71], v[36:39], v[196:199], v[68:71]
    ds_read_b64_tr_b16 v[30:31], v10 offset:8704
    s_waitcnt lgkmcnt(6)
    v_mfma_f32_16x16x32_bf16 v[80:83], v[16:19], v[192:195], v[80:83]
    ds_read_b64_tr_b16 v[32:33], v11 offset:8192
    v_mfma_f32_16x16x32_bf16 v[84:87], v[16:19], v[196:199], v[84:87]
    ds_read_b64_tr_b16 v[34:35], v11 offset:8704
    s_waitcnt lgkmcnt(6)
    v_mfma_f32_16x16x32_bf16 v[96:99], v[20:23], v[192:195], v[96:99]
    ds_read_b64_tr_b16 v[36:37], v47 offset:8192
    v_mfma_f32_16x16x32_bf16 v[100:103], v[20:23], v[196:199], v[100:103]
    ds_read_b64_tr_b16 v[38:39], v47 offset:8704
    s_waitcnt lgkmcnt(6)
    v_mfma_f32_16x16x32_bf16 v[56:59], v[24:27], v[192:195], v[56:59]
    ds_read_b64_tr_b16 v[16:17], v9 offset:4096
    v_mfma_f32_16x16x32_bf16 v[60:63], v[24:27], v[196:199], v[60:63]
    ds_read_b64_tr_b16 v[18:19], v9 offset:4608
    s_waitcnt lgkmcnt(6)
    v_mfma_f32_16x16x32_bf16 v[72:75], v[28:31], v[192:195], v[72:75]
    ds_read_b64_tr_b16 v[20:21], v10 offset:4096
    v_mfma_f32_16x16x32_bf16 v[76:79], v[28:31], v[196:199], v[76:79]
    ds_read_b64_tr_b16 v[22:23], v10 offset:4608
    s_waitcnt lgkmcnt(6)
    v_mfma_f32_16x16x32_bf16 v[88:91], v[32:35], v[192:195], v[88:91]
    ds_read_b64_tr_b16 v[24:25], v11 offset:4096
    v_mfma_f32_16x16x32_bf16 v[92:95], v[32:35], v[196:199], v[92:95]
    ds_read_b64_tr_b16 v[26:27], v11 offset:4608
    s_waitcnt lgkmcnt(6)
    v_mfma_f32_16x16x32_bf16 v[104:107], v[36:39], v[192:195], v[104:107]
    ds_read_b64_tr_b16 v[28:29], v47 offset:4096
    v_mfma_f32_16x16x32_bf16 v[108:111], v[36:39], v[196:199], v[108:111]
    ds_read_b64_tr_b16 v[30:31], v47 offset:4608
    s_waitcnt lgkmcnt(6)
    v_mfma_f32_16x16x32_bf16 v[48:51], v[16:19], v[200:203], v[48:51]
    ds_read_b64_tr_b16 v[32:33], v9 offset:12288
    v_mfma_f32_16x16x32_bf16 v[52:55], v[16:19], v[204:207], v[52:55]
    ds_read_b64_tr_b16 v[34:35], v9 offset:12800
    s_waitcnt lgkmcnt(6)
    v_mfma_f32_16x16x32_bf16 v[64:67], v[20:23], v[200:203], v[64:67]
    ds_read_b64_tr_b16 v[36:37], v10 offset:12288
    v_mfma_f32_16x16x32_bf16 v[68:71], v[20:23], v[204:207], v[68:71]
    ds_read_b64_tr_b16 v[38:39], v10 offset:12800
    s_waitcnt lgkmcnt(6)
    v_mfma_f32_16x16x32_bf16 v[80:83], v[24:27], v[200:203], v[80:83]
    ds_read_b64_tr_b16 v[16:17], v11 offset:12288
    v_mfma_f32_16x16x32_bf16 v[84:87], v[24:27], v[204:207], v[84:87]
    ds_read_b64_tr_b16 v[18:19], v11 offset:12800
    s_waitcnt lgkmcnt(6)
    v_mfma_f32_16x16x32_bf16 v[96:99], v[28:31], v[200:203], v[96:99]
    ds_read_b64_tr_b16 v[20:21], v47 offset:12288
    v_mfma_f32_16x16x32_bf16 v[100:103], v[28:31], v[204:207], v[100:103]
    ds_read_b64_tr_b16 v[22:23], v47 offset:12800
    s_setprio 0
    s_add_u32 m0, s59, 65536
    s_add_u32 s58, s58, 229376
    s_cmp_eq_u32 s33, 2
    s_cselect_b32 s52, 1835008, 0
    s_sub_u32 s58, s58, s52
    buffer_load_dwordx4 v8, s[20:23], s58 offen offset:0 lds
    s_add_u32 m0, s59, 73728
    s_nop 0
    buffer_load_dwordx4 v8, s[24:27], s58 offen offset:0 lds
    s_add_u32 m0, s59, 81792
    s_nop 0
    buffer_load_dwordx4 v8, s[20:23], s58 offen offset:128 lds
    s_add_u32 m0, s59, 89984
    s_nop 0
    buffer_load_dwordx4 v8, s[24:27], s58 offen offset:128 lds
    s_setprio 1
    s_waitcnt vmcnt(5)
    s_barrier
    s_waitcnt lgkmcnt(6)
    v_mfma_f32_16x16x32_bf16 v[56:59], v[32:35], v[200:203], v[56:59]
    ds_read_b64_tr_b16 v[24:25], v9 offset:32768
    v_mfma_f32_16x16x32_bf16 v[60:63], v[32:35], v[204:207], v[60:63]
    ds_read_b64_tr_b16 v[26:27], v9 offset:33280
    s_waitcnt lgkmcnt(6)
    v_mfma_f32_16x16x32_bf16 v[72:75], v[36:39], v[200:203], v[72:75]
    ds_read_b64_tr_b16 v[28:29], v10 offset:32768
    v_mfma_f32_16x16x32_bf16 v[76:79], v[36:39], v[204:207], v[76:79]
    ds_read_b64_tr_b16 v[30:31], v10 offset:33280
    s_waitcnt lgkmcnt(6)
    v_mfma_f32_16x16x32_bf16 v[88:91], v[16:19], v[200:203], v[88:91]
    ds_read_b64_tr_b16 v[32:33], v11 offset:32768
    v_mfma_f32_16x16x32_bf16 v[92:95], v[16:19], v[204:207], v[92:95]
    ds_read_b64_tr_b16 v[34:35], v11 offset:33280
    s_waitcnt lgkmcnt(6)
    v_mfma_f32_16x16x32_bf16 v[104:107], v[20:23], v[200:203], v[104:107]
    ds_read_b64_tr_b16 v[36:37], v47 offset:32768
    v_mfma_f32_16x16x32_bf16 v[108:111], v[20:23], v[204:207], v[108:111]
    ds_read_b64_tr_b16 v[38:39], v47 offset:33280
    s_waitcnt lgkmcnt(6)
    v_mfma_f32_16x16x32_bf16 v[48:51], v[24:27], v[208:211], v[48:51]
    ds_read_b64_tr_b16 v[16:17], v9 offset:40960
    v_mfma_f32_16x16x32_bf16 v[52:55], v[24:27], v[212:215], v[52:55]
    ds_read_b64_tr_b16 v[18:19], v9 offset:41472
    s_waitcnt lgkmcnt(6)
    v_mfma_f32_16x16x32_bf16 v[64:67], v[28:31], v[208:211], v[64:67]
    ds_read_b64_tr_b16 v[20:21], v10 offset:40960
    v_mfma_f32_16x16x32_bf16 v[68:71], v[28:31], v[212:215], v[68:71]
    ds_read_b64_tr_b16 v[22:23], v10 offset:41472
    s_waitcnt lgkmcnt(6)
    v_mfma_f32_16x16x32_bf16 v[80:83], v[32:35], v[208:211], v[80:83]
    ds_read_b64_tr_b16 v[24:25], v11 offset:40960
    v_mfma_f32_16x16x32_bf16 v[84:87], v[32:35], v[212:215], v[84:87]
    ds_read_b64_tr_b16 v[26:27], v11 offset:41472
    s_waitcnt lgkmcnt(6)
    v_mfma_f32_16x16x32_bf16 v[96:99], v[36:39], v[208:211], v[96:99]
    ds_read_b64_tr_b16 v[28:29], v47 offset:40960
    v_mfma_f32_16x16x32_bf16 v[100:103], v[36:39], v[212:215], v[100:103]
    ds_read_b64_tr_b16 v[30:31], v47 offset:41472
    s_waitcnt lgkmcnt(6)
    v_mfma_f32_16x16x32_bf16 v[56:59], v[16:19], v[208:211], v[56:59]
    ds_read_b64_tr_b16 v[32:33], v9 offset:36864
    v_mfma_f32_16x16x32_bf16 v[60:63], v[16:19], v[212:215], v[60:63]
    ds_read_b64_tr_b16 v[34:35], v9 offset:37376
    s_waitcnt lgkmcnt(6)
    v_mfma_f32_16x16x32_bf16 v[72:75], v[20:23], v[208:211], v[72:75]
    ds_read_b64_tr_b16 v[36:37], v10 offset:36864
    v_mfma_f32_16x16x32_bf16 v[76:79], v[20:23], v[212:215], v[76:79]
    ds_read_b64_tr_b16 v[38:39], v10 offset:37376
    s_waitcnt lgkmcnt(6)
    v_mfma_f32_16x16x32_bf16 v[88:91], v[24:27], v[208:211], v[88:91]
    ds_read_b64_tr_b16 v[16:17], v11 offset:36864
    v_mfma_f32_16x16x32_bf16 v[92:95], v[24:27], v[212:215], v[92:95]
    ds_read_b64_tr_b16 v[18:19], v11 offset:37376
    s_waitcnt lgkmcnt(6)
    v_mfma_f32_16x16x32_bf16 v[104:107], v[28:31], v[208:211], v[104:107]
    ds_read_b64_tr_b16 v[20:21], v47 offset:36864
    v_mfma_f32_16x16x32_bf16 v[108:111], v[28:31], v[212:215], v[108:111]
    ds_read_b64_tr_b16 v[22:23], v47 offset:37376
    s_waitcnt lgkmcnt(6)
    v_mfma_f32_16x16x32_bf16 v[48:51], v[32:35], v[216:219], v[48:51]
    ds_read_b64_tr_b16 v[24:25], v9 offset:45056
    v_mfma_f32_16x16x32_bf16 v[52:55], v[32:35], v[220:223], v[52:55]
    ds_read_b64_tr_b16 v[26:27], v9 offset:45568
    s_waitcnt lgkmcnt(6)
    v_mfma_f32_16x16x32_bf16 v[64:67], v[36:39], v[216:219], v[64:67]
    ds_read_b64_tr_b16 v[28:29], v10 offset:45056
    v_mfma_f32_16x16x32_bf16 v[68:71], v[36:39], v[220:223], v[68:71]
    ds_read_b64_tr_b16 v[30:31], v10 offset:45568
    s_waitcnt lgkmcnt(6)
    v_mfma_f32_16x16x32_bf16 v[80:83], v[16:19], v[216:219], v[80:83]
    ds_read_b64_tr_b16 v[32:33], v11 offset:45056
    v_mfma_f32_16x16x32_bf16 v[84:87], v[16:19], v[220:223], v[84:87]
    ds_read_b64_tr_b16 v[34:35], v11 offset:45568
    s_waitcnt lgkmcnt(6)
    v_mfma_f32_16x16x32_bf16 v[96:99], v[20:23], v[216:219], v[96:99]
    ds_read_b64_tr_b16 v[36:37], v47 offset:45056
    v_mfma_f32_16x16x32_bf16 v[100:103], v[20:23], v[220:223], v[100:103]
    ds_read_b64_tr_b16 v[38:39], v47 offset:45568
    s_setprio 0
    s_add_u32 m0, s59, 98304
    s_add_u32 s58, s58, 229376
    buffer_load_dwordx4 v8, s[20:23], s58 offen offset:0 lds
    s_add_u32 m0, s59, 106496
    s_nop 0
    buffer_load_dwordx4 v8, s[24:27], s58 offen offset:0 lds
    s_add_u32 m0, s59, 114560
    s_nop 0
    buffer_load_dwordx4 v8, s[20:23], s58 offen offset:128 lds
    s_add_u32 m0, s59, 122752
    s_nop 0
    buffer_load_dwordx4 v8, s[24:27], s58 offen offset:128 lds
    s_setprio 1
    v_add_u32 v9, 0x10000, v9
    v_add_u32 v10, 0x10000, v10
    v_add_u32 v11, 0x10000, v11
    v_add_u32 v47, 0x10000, v47
    s_waitcnt vmcnt(4)
    s_barrier
    s_waitcnt lgkmcnt(6)
    v_mfma_f32_16x16x32_bf16 v[56:59], v[24:27], v[216:219], v[56:59]
    ds_read_b64_tr_b16 v[16:17], v9 offset:0
    v_mfma_f32_16x16x32_bf16 v[60:63], v[24:27], v[220:223], v[60:63]
    ds_read_b64_tr_b16 v[18:19], v9 offset:512
    s_waitcnt lgkmcnt(6)
    v_mfma_f32_16x16x32_bf16 v[72:75], v[28:31], v[216:219], v[72:75]
    ds_read_b64_tr_b16 v[20:21], v10 offset:0
    v_mfma_f32_16x16x32_bf16 v[76:79], v[28:31], v[220:223], v[76:79]
    ds_read_b64_tr_b16 v[22:23], v10 offset:512
    s_waitcnt lgkmcnt(6)
    v_mfma_f32_16x16x32_bf16 v[88:91], v[32:35], v[216:219], v[88:91]
    ds_read_b64_tr_b16 v[24:25], v11 offset:0
    v_mfma_f32_16x16x32_bf16 v[92:95], v[32:35], v[220:223], v[92:95]
    ds_read_b64_tr_b16 v[26:27], v11 offset:512
    s_waitcnt lgkmcnt(6)
    v_mfma_f32_16x16x32_bf16 v[104:107], v[36:39], v[216:219], v[104:107]
    ds_read_b64_tr_b16 v[28:29], v47 offset:0
    v_mfma_f32_16x16x32_bf16 v[108:111], v[36:39], v[220:223], v[108:111]
    ds_read_b64_tr_b16 v[30:31], v47 offset:512
    s_waitcnt lgkmcnt(6)
    v_mfma_f32_16x16x32_bf16 v[48:51], v[16:19], v[224:227], v[48:51]
    ds_read_b64_tr_b16 v[32:33], v9 offset:8192
    v_mfma_f32_16x16x32_bf16 v[52:55], v[16:19], v[228:231], v[52:55]
    ds_read_b64_tr_b16 v[34:35], v9 offset:8704
    s_waitcnt lgkmcnt(6)
    v_mfma_f32_16x16x32_bf16 v[64:67], v[20:23], v[224:227], v[64:67]
    ds_read_b64_tr_b16 v[36:37], v10 offset:8192
    v_mfma_f32_16x16x32_bf16 v[68:71], v[20:23], v[228:231], v[68:71]
    ds_read_b64_tr_b16 v[38:39], v10 offset:8704
    s_waitcnt lgkmcnt(6)
    v_mfma_f32_16x16x32_bf16 v[80:83], v[24:27], v[224:227], v[80:83]
    ds_read_b64_tr_b16 v[16:17], v11 offset:8192
    v_mfma_f32_16x16x32_bf16 v[84:87], v[24:27], v[228:231], v[84:87]
    ds_read_b64_tr_b16 v[18:19], v11 offset:8704
    s_waitcnt lgkmcnt(6)
    v_mfma_f32_16x16x32_bf16 v[96:99], v[28:31], v[224:227], v[96:99]
    ds_read_b64_tr_b16 v[20:21], v47 offset:8192
    v_mfma_f32_16x16x32_bf16 v[100:103], v[28:31], v[228:231], v[100:103]
    ds_read_b64_tr_b16 v[22:23], v47 offset:8704
    s_waitcnt lgkmcnt(6)
    v_mfma_f32_16x16x32_bf16 v[56:59], v[32:35], v[224:227], v[56:59]
    ds_read_b64_tr_b16 v[24:25], v9 offset:4096
    v_mfma_f32_16x16x32_bf16 v[60:63], v[32:35], v[228:231], v[60:63]
    ds_read_b64_tr_b16 v[26:27], v9 offset:4608
    s_waitcnt lgkmcnt(6)
    v_mfma_f32_16x16x32_bf16 v[72:75], v[36:39], v[224:227], v[72:75]
    ds_read_b64_tr_b16 v[28:29], v10 offset:4096
    v_mfma_f32_16x16x32_bf16 v[76:79], v[36:39], v[228:231], v[76:79]
    ds_read_b64_tr_b16 v[30:31], v10 offset:4608
    s_waitcnt lgkmcnt(6)
    v_mfma_f32_16x16x32_bf16 v[88:91], v[16:19], v[224:227], v[88:91]
    ds_read_b64_tr_b16 v[32:33], v11 offset:4096
    v_mfma_f32_16x16x32_bf16 v[92:95], v[16:19], v[228:231], v[92:95]
    ds_read_b64_tr_b16 v[34:35], v11 offset:4608
    s_waitcnt lgkmcnt(6)
    v_mfma_f32_16x16x32_bf16 v[104:107], v[20:23], v[224:227], v[104:107]
    ds_read_b64_tr_b16 v[36:37], v47 offset:4096
    v_mfma_f32_16x16x32_bf16 v[108:111], v[20:23], v[228:231], v[108:111]
    ds_read_b64_tr_b16 v[38:39], v47 offset:4608
    s_waitcnt lgkmcnt(6)
    v_mfma_f32_16x16x32_bf16 v[48:51], v[24:27], v[232:235], v[48:51]
    ds_read_b64_tr_b16 v[16:17], v9 offset:12288
    v_mfma_f32_16x16x32_bf16 v[52:55], v[24:27], v[236:239], v[52:55]
    ds_read_b64_tr_b16 v[18:19], v9 offset:12800
    s_waitcnt lgkmcnt(6)
    v_mfma_f32_16x16x32_bf16 v[64:67], v[28:31], v[232:235], v[64:67]
    ds_read_b64_tr_b16 v[20:21], v10 offset:12288
    v_mfma_f32_16x16x32_bf16 v[68:71], v[28:31], v[236:239], v[68:71]
    ds_read_b64_tr_b16 v[22:23], v10 offset:12800
    s_waitcnt lgkmcnt(6)
    v_mfma_f32_16x16x32_bf16 v[80:83], v[32:35], v[232:235], v[80:83]
    ds_read_b64_tr_b16 v[24:25], v11 offset:12288
    v_mfma_f32_16x16x32_bf16 v[84:87], v[32:35], v[236:239], v[84:87]
    ds_read_b64_tr_b16 v[26:27], v11 offset:12800
    s_waitcnt lgkmcnt(6)
    v_mfma_f32_16x16x32_bf16 v[96:99], v[36:39], v[232:235], v[96:99]
    ds_read_b64_tr_b16 v[28:29], v47 offset:12288
    v_mfma_f32_16x16x32_bf16 v[100:103], v[36:39], v[236:239], v[100:103]
    ds_read_b64_tr_b16 v[30:31], v47 offset:12800
    s_setprio 0
    s_setprio 1
    s_waitcnt vmcnt(0)
    s_barrier
    v_and_b32 v44, 0x300, v1
    v_mad_u32_u24 v44, v44, 3, v1
    buffer_load_dwordx4 v[192:195], v44, s[16:19], s0 offen offset:0 sc1
    buffer_load_dwordx4 v[196:199], v44, s[16:19], s0 offen offset:512 sc1
    s_waitcnt lgkmcnt(6)
    v_mfma_f32_16x16x32_bf16 v[56:59], v[16:19], v[232:235], v[56:59]
    ds_read_b64_tr_b16 v[32:33], v9 offset:32768
    v_mfma_f32_16x16x32_bf16 v[60:63], v[16:19], v[236:239], v[60:63]
    ds_read_b64_tr_b16 v[34:35], v9 offset:33280
    s_waitcnt lgkmcnt(6)
    v_mfma_f32_16x16x32_bf16 v[72:75], v[20:23], v[232:235], v[72:75]
    ds_read_b64_tr_b16 v[36:37], v10 offset:32768
    v_mfma_f32_16x16x32_bf16 v[76:79], v[20:23], v[236:239], v[76:79]
    ds_read_b64_tr_b16 v[38:39], v10 offset:33280
    s_waitcnt lgkmcnt(6)
    v_mfma_f32_16x16x32_bf16 v[88:91], v[24:27], v[232:235], v[88:91]
    ds_read_b64_tr_b16 v[16:17], v11 offset:32768
    v_mfma_f32_16x16x32_bf16 v[92:95], v[24:27], v[236:239], v[92:95]
    ds_read_b64_tr_b16 v[18:19], v11 offset:33280
    s_waitcnt lgkmcnt(6)
    v_mfma_f32_16x16x32_bf16 v[104:107], v[28:31], v[232:235], v[104:107]
    ds_read_b64_tr_b16 v[20:21], v47 offset:32768
    v_mfma_f32_16x16x32_bf16 v[108:111], v[28:31], v[236:239], v[108:111]
    ds_read_b64_tr_b16 v[22:23], v47 offset:33280
    s_waitcnt lgkmcnt(6)
    v_mfma_f32_16x16x32_bf16 v[48:51], v[32:35], v[240:243], v[48:51]
    ds_read_b64_tr_b16 v[24:25], v9 offset:40960
    v_mfma_f32_16x16x32_bf16 v[52:55], v[32:35], v[244:247], v[52:55]
    ds_read_b64_tr_b16 v[26:27], v9 offset:41472
    s_waitcnt lgkmcnt(6)
    v_mfma_f32_16x16x32_bf16 v[64:67], v[36:39], v[240:243], v[64:67]
    ds_read_b64_tr_b16 v[28:29], v10 offset:40960
    v_mfma_f32_16x16x32_bf16 v[68:71], v[36:39], v[244:247], v[68:71]
    ds_read_b64_tr_b16 v[30:31], v10 offset:41472
    s_waitcnt lgkmcnt(6)
    v_mfma_f32_16x16x32_bf16 v[80:83], v[16:19], v[240:243], v[80:83]
    ds_read_b64_tr_b16 v[32:33], v11 offset:40960
    v_mfma_f32_16x16x32_bf16 v[84:87], v[16:19], v[244:247], v[84:87]
    ds_read_b64_tr_b16 v[34:35], v11 offset:41472
    s_waitcnt lgkmcnt(6)
    v_mfma_f32_16x16x32_bf16 v[96:99], v[20:23], v[240:243], v[96:99]
    ds_read_b64_tr_b16 v[36:37], v47 offset:40960
    v_mfma_f32_16x16x32_bf16 v[100:103], v[20:23], v[244:247], v[100:103]
    ds_read_b64_tr_b16 v[38:39], v47 offset:41472
    s_waitcnt lgkmcnt(6)
    v_mfma_f32_16x16x32_bf16 v[56:59], v[24:27], v[240:243], v[56:59]
    ds_read_b64_tr_b16 v[16:17], v9 offset:36864
    v_mfma_f32_16x16x32_bf16 v[60:63], v[24:27], v[244:247], v[60:63]
    ds_read_b64_tr_b16 v[18:19], v9 offset:37376
    s_waitcnt lgkmcnt(6)
    v_mfma_f32_16x16x32_bf16 v[72:75], v[28:31], v[240:243], v[72:75]
    ds_read_b64_tr_b16 v[20:21], v10 offset:36864
    v_mfma_f32_16x16x32_bf16 v[76:79], v[28:31], v[244:247], v[76:79]
    ds_read_b64_tr_b16 v[22:23], v10 offset:37376
    s_waitcnt lgkmcnt(6)
    v_mfma_f32_16x16x32_bf16 v[88:91], v[32:35], v[240:243], v[88:91]
    ds_read_b64_tr_b16 v[24:25], v11 offset:36864
    v_mfma_f32_16x16x32_bf16 v[92:95], v[32:35], v[244:247], v[92:95]
    ds_read_b64_tr_b16 v[26:27], v11 offset:37376
    s_waitcnt lgkmcnt(6)
    v_mfma_f32_16x16x32_bf16 v[104:107], v[36:39], v[240:243], v[104:107]
    ds_read_b64_tr_b16 v[28:29], v47 offset:36864
    v_mfma_f32_16x16x32_bf16 v[108:111], v[36:39], v[244:247], v[108:111]
    ds_read_b64_tr_b16 v[30:31], v47 offset:37376
    s_waitcnt lgkmcnt(6)
    v_mfma_f32_16x16x32_bf16 v[48:51], v[16:19], v[248:251], v[48:51]
    ds_read_b64_tr_b16 v[32:33], v9 offset:45056
    v_mfma_f32_16x16x32_bf16 v[52:55], v[16:19], v[252:255], v[52:55]
    ds_read_b64_tr_b16 v[34:35], v9 offset:45568
    s_waitcnt lgkmcnt(6)
    v_mfma_f32_16x16x32_bf16 v[64:67], v[20:23], v[248:251], v[64:67]
    ds_read_b64_tr_b16 v[36:37], v10 offset:45056
    v_mfma_f32_16x16x32_bf16 v[68:71], v[20:23], v[252:255], v[68:71]
    ds_read_b64_tr_b16 v[38:39], v10 offset:45568
    s_waitcnt lgkmcnt(6)
    v_mfma_f32_16x16x32_bf16 v[80:83], v[24:27], v[248:251], v[80:83]
    ds_read_b64_tr_b16 v[16:17], v11 offset:45056
    v_mfma_f32_16x16x32_bf16 v[84:87], v[24:27], v[252:255], v[84:87]
    ds_read_b64_tr_b16 v[18:19], v11 offset:45568
    s_waitcnt lgkmcnt(6)
    v_mfma_f32_16x16x32_bf16 v[96:99], v[28:31], v[248:251], v[96:99]
    ds_read_b64_tr_b16 v[20:21], v47 offset:45056
    v_mfma_f32_16x16x32_bf16 v[100:103], v[28:31], v[252:255], v[100:103]
    ds_read_b64_tr_b16 v[22:23], v47 offset:45568
    s_setprio 0
    s_waitcnt vmcnt(0)
    v_add_f32 v40, v192, v196
    v_add_f32 v41, v193, v197
    v_add_f32 v42, v194, v198
    v_add_f32 v43, v195, v199
    s_lshl_b32 s52, s32, 2
    s_add_u32 s52, s52, 155648
    v_add_u32 v4, s52, v1
    v_cvt_pk_bf16_f32 v3, v40, v40
    v_lshlrev_b32 v3, 16, v3
    v_sub_f32 v5, v40, v3
    v_cvt_pk_bf16_f32 v3, v3, v5
    ds_write_b32 v4, v3 offset:0
    v_cvt_pk_bf16_f32 v3, v41, v41
    v_lshlrev_b32 v3, 16, v3
    v_sub_f32 v5, v41, v3
    v_cvt_pk_bf16_f32 v3, v3, v5
    ds_write_b32 v4, v3 offset:1024
    v_cvt_pk_bf16_f32 v3, v42, v42
    v_lshlrev_b32 v3, 16, v3
    v_sub_f32 v5, v42, v3
    v_cvt_pk_bf16_f32 v3, v3, v5
    ds_write_b32 v4, v3 offset:2048
    v_cvt_pk_bf16_f32 v3, v43, v43
    v_lshlrev_b32 v3, 16, v3
    v_sub_f32 v5, v43, v3
    v_cvt_pk_bf16_f32 v3, v3, v5
    ds_write_b32 v4, v3 offset:3072
    v_mov_b32 v184, 0
    v_mov_b32 v185, 0
    v_mov_b32 v186, v12
    v_mov_b32 v187, v12
    v_mov_b32 v188, 0
    v_mov_b32 v189, 0
    v_mov_b32 v190, v14
    v_mov_b32 v191, v14
    v_mov_b32 v192, 0
    v_mov_b32 v193, 0
    v_mul_f32 v44, v13, v13
    v_mul_f32 v45, v15, v15
    s_waitcnt lgkmcnt(0)
    s_barrier
    v_add_u32 v4, 155648, v1
    ds_read_b128 v[112:115], v4 offset:0
    ds_read_b128 v[116:119], v4 offset:1024
    ds_read_b128 v[120:123], v4 offset:2048
    ds_read_b128 v[124:127], v4 offset:3072
    v_mfma_f32_16x16x32_bf16 v[56:59], v[32:35], v[248:251], v[56:59]
    v_mfma_f32_16x16x32_bf16 v[60:63], v[32:35], v[252:255], v[60:63]
    v_mfma_f32_16x16x32_bf16 v[72:75], v[36:39], v[248:251], v[72:75]
    v_mfma_f32_16x16x32_bf16 v[76:79], v[36:39], v[252:255], v[76:79]
    v_mfma_f32_16x16x32_bf16 v[88:91], v[16:19], v[248:251], v[88:91]
    v_mfma_f32_16x16x32_bf16 v[92:95], v[16:19], v[252:255], v[92:95]
    v_mfma_f32_16x16x32_bf16 v[104:107], v[20:23], v[248:251], v[104:107]
    v_mfma_f32_16x16x32_bf16 v[108:111], v[20:23], v[252:255], v[108:111]
    s_waitcnt lgkmcnt(3)
    v_mfma_f32_16x16x32_bf16 v[48:51], v[112:115], v[186:189], v[48:51]
    v_mfma_f32_16x16x32_bf16 v[52:55], v[112:115], v[190:193], v[52:55]
    v_mfma_f32_16x16x32_bf16 v[56:59], v[112:115], v[184:187], v[56:59]
    v_mfma_f32_16x16x32_bf16 v[60:63], v[112:115], v[188:191], v[60:63]
    s_waitcnt lgkmcnt(2)
    v_mfma_f32_16x16x32_bf16 v[64:67], v[116:119], v[186:189], v[64:67]
    v_mfma_f32_16x16x32_bf16 v[68:71], v[116:119], v[190:193], v[68:71]
    v_mfma_f32_16x16x32_bf16 v[72:75], v[116:119], v[184:187], v[72:75]
    v_mfma_f32_16x16x32_bf16 v[76:79], v[116:119], v[188:191], v[76:79]
    s_nop 1
    v_max_f32 v48, 0, v48
    v_max_f32 v49, 0, v49
    v_max_f32 v50, 0, v50
    v_max_f32 v51, 0, v51
    s_waitcnt lgkmcnt(1)
    v_mfma_f32_16x16x32_bf16 v[80:83], v[120:123], v[186:189], v[80:83]
    v_max_f32 v52, 0, v52
    v_max_f32 v53, 0, v53
    v_max_f32 v54, 0, v54
    v_max_f32 v55, 0, v55
    v_mfma_f32_16x16x32_bf16 v[84:87], v[120:123], v[190:193], v[84:87]
    v_mul_f32 v56, v44, v56
    v_mul_f32 v57, v44, v57
    v_mul_f32 v58, v44, v58
    v_mul_f32 v59, v44, v59
    v_mfma_f32_16x16x32_bf16 v[88:91], v[120:123], v[184:187], v[88:91]
    v_mul_f32 v60, v45, v60
    v_mul_f32 v61, v45, v61
    v_mul_f32 v62, v45, v62
    v_mul_f32 v63, v45, v63
    v_mfma_f32_16x16x32_bf16 v[92:95], v[120:123], v[188:191], v[92:95]
    v_mul_f32 v48, v48, v56
    v_mul_f32 v49, v49, v57
    v_mul_f32 v50, v50, v58
    v_mul_f32 v51, v51, v59
    v_mul_f32 v52, v52, v60
    v_mul_f32 v53, v53, v61
    v_mul_f32 v54, v54, v62
    v_mul_f32 v55, v55, v63
    v_cvt_pk_bf16_f32 v208, v48, v49
    v_cvt_pk_bf16_f32 v209, v50, v51
    v_cvt_pk_bf16_f32 v210, v52, v53
    v_cvt_pk_bf16_f32 v211, v54, v55
    v_max_f32 v64, 0, v64
    v_max_f32 v65, 0, v65
    v_permlane32_swap_b32 v208, v210
    v_permlane32_swap_b32 v209, v211
    buffer_store_dwordx4 v[208:211], v46, s[16:19], s77 offen offset:0 sc1
    v_max_f32 v66, 0, v66
    v_max_f32 v67, 0, v67
    s_waitcnt lgkmcnt(0)
    v_mfma_f32_16x16x32_bf16 v[96:99], v[124:127], v[186:189], v[96:99]
    v_max_f32 v68, 0, v68
    v_max_f32 v69, 0, v69
    v_max_f32 v70, 0, v70
    v_max_f32 v71, 0, v71
    v_mfma_f32_16x16x32_bf16 v[100:103], v[124:127], v[190:193], v[100:103]
    v_mul_f32 v72, v44, v72
    v_mul_f32 v73, v44, v73
    v_mul_f32 v74, v44, v74
    v_mul_f32 v75, v44, v75
    v_mfma_f32_16x16x32_bf16 v[104:107], v[124:127], v[184:187], v[104:107]
    v_mul_f32 v76, v45, v76
    v_mul_f32 v77, v45, v77
    v_mul_f32 v78, v45, v78
    v_mul_f32 v79, v45, v79
    v_mfma_f32_16x16x32_bf16 v[108:111], v[124:127], v[188:191], v[108:111]
    v_mul_f32 v64, v64, v72
    v_mul_f32 v65, v65, v73
    v_mul_f32 v66, v66, v74
    v_mul_f32 v67, v67, v75
    v_mul_f32 v68, v68, v76
    v_mul_f32 v69, v69, v77
    v_mul_f32 v70, v70, v78
    v_mul_f32 v71, v71, v79
    v_cvt_pk_bf16_f32 v212, v64, v65
    v_cvt_pk_bf16_f32 v213, v66, v67
    v_cvt_pk_bf16_f32 v214, v68, v69
    v_cvt_pk_bf16_f32 v215, v70, v71
    v_max_f32 v80, 0, v80
    v_max_f32 v81, 0, v81
    v_permlane32_swap_b32 v212, v214
    v_permlane32_swap_b32 v213, v215
    buffer_store_dwordx4 v[212:215], v46, s[16:19], s77 offen offset:1024 sc1
    v_max_f32 v82, 0, v82
    v_max_f32 v83, 0, v83
    v_max_f32 v84, 0, v84
    v_max_f32 v85, 0, v85
    v_max_f32 v86, 0, v86
    v_max_f32 v87, 0, v87
    v_mul_f32 v88, v44, v88
    v_mul_f32 v89, v44, v89
    v_mul_f32 v90, v44, v90
    v_mul_f32 v91, v44, v91
    v_mul_f32 v92, v45, v92
    v_mul_f32 v93, v45, v93
    v_mul_f32 v94, v45, v94
    v_mul_f32 v95, v45, v95
    v_mul_f32 v80, v80, v88
    v_mul_f32 v81, v81, v89
    v_mul_f32 v82, v82, v90
    v_mul_f32 v83, v83, v91
    v_mul_f32 v84, v84, v92
    v_mul_f32 v85, v85, v93
    v_mul_f32 v86, v86, v94
    v_mul_f32 v87, v87, v95
    v_cvt_pk_bf16_f32 v216, v80, v81
    v_cvt_pk_bf16_f32 v217, v82, v83
    v_cvt_pk_bf16_f32 v218, v84, v85
    v_cvt_pk_bf16_f32 v219, v86, v87
    v_max_f32 v96, 0, v96
    v_max_f32 v97, 0, v97
    v_permlane32_swap_b32 v216, v218
    v_permlane32_swap_b32 v217, v219
    buffer_store_dwordx4 v[216:219], v46, s[16:19], s77 offen offset:2048 sc1
    v_max_f32 v98, 0, v98
    v_max_f32 v99, 0, v99
    v_max_f32 v100, 0, v100
    v_max_f32 v101, 0, v101
    v_max_f32 v102, 0, v102
    v_max_f32 v103, 0, v103
    v_mul_f32 v104, v44, v104
    v_mul_f32 v105, v44, v105
    v_mul_f32 v106, v44, v106
    v_mul_f32 v107, v44, v107
    v_mul_f32 v108, v45, v108
    v_mul_f32 v109, v45, v109
    v_mul_f32 v110, v45, v110
    v_mul_f32 v111, v45, v111
    v_mul_f32 v96, v96, v104
    v_mul_f32 v97, v97, v105
    v_mul_f32 v98, v98, v106
    v_mul_f32 v99, v99, v107
    v_mul_f32 v100, v100, v108
    v_mul_f32 v101, v101, v109
    v_mul_f32 v102, v102, v110
    v_mul_f32 v103, v103, v111
    v_cvt_pk_bf16_f32 v220, v96, v97
    v_cvt_pk_bf16_f32 v221, v98, v99
    v_cvt_pk_bf16_f32 v222, v100, v101
    v_cvt_pk_bf16_f32 v223, v102, v103
    s_nop 1
    v_permlane32_swap_b32 v220, v222
    v_permlane32_swap_b32 v221, v223
    buffer_store_dwordx4 v[220:223], v46, s[16:19], s77 offen offset:3072 sc1
    s_branch L_Gx
L_GR:
    s_setprio 1
    s_waitcnt vmcnt(4)
    s_barrier
    s_add_u32 m0, s56, 65536
    s_add_u32 s54, s54, 196608
    s_cmp_eq_u32 s33, 6
    s_cselect_b32 s52, 1572864, 0
    s_sub_u32 s54, s54, s52
    buffer_load_dwordx4 v44, s[12:15], s54 offen lds
    buffer_load_dwordx4 v45, s[12:15], s54 offen offset:1024 lds
    s_add_u32 m0, s56, 72704
    s_nop 0
    buffer_load_dwordx4 v44, s[12:15], s54 offen offset:1024 lds
    buffer_load_dwordx4 v45, s[12:15], s54 offen offset:2048 lds
    ds_read_b128 v[128:131], v12 offset:0
    ds_read_b128 v[132:135], v12 offset:2048
    ds_read_b128 v[136:139], v13 offset:0
    ds_read_b128 v[140:143], v13 offset:2048
    ds_read_b64_tr_b16 v[16:17], v46 offset:16384
    ds_read_b64_tr_b16 v[18:19], v46 offset:16896
    ds_read_b64_tr_b16 v[20:21], v46 offset:24576
    ds_read_b64_tr_b16 v[22:23], v46 offset:25088
    ds_read_b64_tr_b16 v[24:25], v6 offset:16384
    ds_read_b64_tr_b16 v[26:27], v6 offset:16896
    ds_read_b64_tr_b16 v[28:29], v6 offset:24576
    ds_read_b64_tr_b16 v[30:31], v6 offset:25088
    ds_read_b64_tr_b16 v[32:33], v46 offset:20480
    ds_read_b64_tr_b16 v[34:35], v46 offset:20992
    ds_read_b64_tr_b16 v[36:37], v46 offset:28672
    ds_read_b64_tr_b16 v[38:39], v46 offset:29184
    ds_read_b64_tr_b16 v[48:49], v6 offset:20480
    ds_read_b64_tr_b16 v[50:51], v6 offset:20992
    ds_read_b64_tr_b16 v[52:53], v6 offset:28672
    ds_read_b64_tr_b16 v[54:55], v6 offset:29184
    ds_read_b64_tr_b16 v[88:89], v7 offset:16384
    ds_read_b64_tr_b16 v[90:91], v7 offset:16896
    ds_read_b64_tr_b16 v[92:93], v7 offset:24576
    ds_read_b64_tr_b16 v[94:95], v7 offset:25088
    s_and_b32 s4, s2, 7
    s_and_b32 s51, s5, 3
    s_and_b32 s52, s2, 6
    s_lshl1_add_u32 s6, s52, s51
    s_lshr_b32 s35, s5, 2
    s_and_b32 s52, s2, 1
    s_lshl3_add_u32 s7, s52, s35
    s_lshl2_add_u32 s34, s4, s51
    s_mov_b32 s72, 0xffff0000
    s_lshr_b32 s61, s3, 2
    s_lshl2_add_u32 s62, s6, s32
    s_mov_b32 s18, 0x1800000
    s_mov_b32 s19, 0x00020000
    s_mov_b32 s46, 0x100
    s_mov_b32 s47, 0x00020000
    s_mov_b32 s22, 0x1c0000
    s_mov_b32 s23, 0x00020000
    s_mov_b32 s26, 0x1c0000
    s_mov_b32 s27, 0x00020000
    s_mov_b32 s30, 0x1c0000
    s_mov_b32 s31, 0x00020000
    s_mov_b32 s38, 0x80000
    s_mov_b32 s39, 0x00020000
    s_mov_b32 s42, 0x200000
    s_mov_b32 s43, 0x00020000
    s_waitcnt lgkmcnt(0)
    s_waitcnt vmcnt(4)
    s_barrier
    v_dot2c_f32_bf16 v40, s71, v88
    v_dot2c_f32_bf16 v41, s71, v92
    v_dot2c_f32_bf16 v40, s71, v89
    v_dot2c_f32_bf16 v41, s71, v93
    v_dot2c_f32_bf16 v40, s71, v90
    v_dot2c_f32_bf16 v41, s71, v94
    v_dot2c_f32_bf16 v40, s71, v91
    v_dot2c_f32_bf16 v41, s71, v95
    v_dot2c_f32_bf16 v42, s71, v128
    v_dot2c_f32_bf16 v43, v128, v128
    v_dot2c_f32_bf16 v42, s71, v129
    v_dot2c_f32_bf16 v43, v129, v129
    v_dot2c_f32_bf16 v42, s71, v130
    v_dot2c_f32_bf16 v43, v130, v130
    v_dot2c_f32_bf16 v42, s71, v131
    v_dot2c_f32_bf16 v43, v131, v131
    v_dot2c_f32_bf16 v14, s71, v132
    v_dot2c_f32_bf16 v15, v132, v132
    v_dot2c_f32_bf16 v14, s71, v133
    v_dot2c_f32_bf16 v15, v133, v133
    v_dot2c_f32_bf16 v14, s71, v134
    v_dot2c_f32_bf16 v15, v134, v134
    v_dot2c_f32_bf16 v14, s71, v135
    v_dot2c_f32_bf16 v15, v135, v135
    v_dot2c_f32_bf16 v42, s71, v136
    v_dot2c_f32_bf16 v43, v136, v136
    v_dot2c_f32_bf16 v42, s71, v137
    v_dot2c_f32_bf16 v43, v137, v137
    v_dot2c_f32_bf16 v42, s71, v138
    v_dot2c_f32_bf16 v43, v138, v138
    v_dot2c_f32_bf16 v42, s71, v139
    v_dot2c_f32_bf16 v43, v139, v139
    v_dot2c_f32_bf16 v14, s71, v140
    v_dot2c_f32_bf16 v15, v140, v140
    v_dot2c_f32_bf16 v14, s71, v141
    v_dot2c_f32_bf16 v15, v141, v141
    v_dot2c_f32_bf16 v14, s71, v142
    v_dot2c_f32_bf16 v15, v142, v142
    v_dot2c_f32_bf16 v14, s71, v143
    v_dot2c_f32_bf16 v15, v143, v143
    v_mfma_f32_16x16x32_bf16 v[96:99], v[16:19], v[128:131], 0
    v_mfma_f32_16x16x32_bf16 v[100:103], v[16:19], v[132:135], 0
    ds_read_b128 v[144:147], v12 offset:32768
    ds_read_b64_tr_b16 v[56:57], v46 offset:49152
    ds_read_b64_tr_b16 v[58:59], v46 offset:49664
    v_mfma_f32_16x16x32_bf16 v[112:115], v[20:23], v[128:131], 0
    v_mfma_f32_16x16x32_bf16 v[116:119], v[20:23], v[132:135], 0
    ds_read_b128 v[148:151], v12 offset:34816
    ds_read_b64_tr_b16 v[60:61], v46 offset:57344
    ds_read_b64_tr_b16 v[62:63], v46 offset:57856
    v_mfma_f32_16x16x32_bf16 v[104:107], v[24:27], v[128:131], 0
    v_mfma_f32_16x16x32_bf16 v[108:111], v[24:27], v[132:135], 0
    ds_read_b128 v[152:155], v13 offset:32768
    ds_read_b64_tr_b16 v[64:65], v6 offset:49152
    ds_read_b64_tr_b16 v[66:67], v6 offset:49664
    v_mfma_f32_16x16x32_bf16 v[120:123], v[28:31], v[128:131], 0
    v_mfma_f32_16x16x32_bf16 v[124:127], v[28:31], v[132:135], 0
    ds_read_b128 v[156:159], v13 offset:34816
    ds_read_b64_tr_b16 v[68:69], v6 offset:57344
    ds_read_b64_tr_b16 v[70:71], v6 offset:57856
    v_mfma_f32_16x16x32_bf16 v[96:99], v[32:35], v[136:139], v[96:99]
    v_mfma_f32_16x16x32_bf16 v[100:103], v[32:35], v[140:143], v[100:103]
    ds_read_b64_tr_b16 v[88:89], v7 offset:49152
    ds_read_b64_tr_b16 v[90:91], v7 offset:49664
    ds_read_b64_tr_b16 v[72:73], v46 offset:53248
    ds_read_b64_tr_b16 v[74:75], v46 offset:53760
    v_mfma_f32_16x16x32_bf16 v[112:115], v[36:39], v[136:139], v[112:115]
    v_mfma_f32_16x16x32_bf16 v[116:119], v[36:39], v[140:143], v[116:119]
    ds_read_b64_tr_b16 v[92:93], v7 offset:57344
    ds_read_b64_tr_b16 v[94:95], v7 offset:57856
    ds_read_b64_tr_b16 v[76:77], v46 offset:61440
    ds_read_b64_tr_b16 v[78:79], v46 offset:61952
    v_mfma_f32_16x16x32_bf16 v[104:107], v[48:51], v[136:139], v[104:107]
    v_mfma_f32_16x16x32_bf16 v[108:111], v[48:51], v[140:143], v[108:111]
    ds_read_b64_tr_b16 v[80:81], v6 offset:53248
    ds_read_b64_tr_b16 v[82:83], v6 offset:53760
    v_mfma_f32_16x16x32_bf16 v[120:123], v[52:55], v[136:139], v[120:123]
    v_mfma_f32_16x16x32_bf16 v[124:127], v[52:55], v[140:143], v[124:127]
    ds_read_b64_tr_b16 v[84:85], v6 offset:61440
    ds_read_b64_tr_b16 v[86:87], v6 offset:61952
    s_add_u32 m0, s56, 98304
    s_add_u32 s54, s54, 196608
    buffer_load_dwordx4 v44, s[12:15], s54 offen lds
    buffer_load_dwordx4 v45, s[12:15], s54 offen offset:1024 lds
    s_add_u32 m0, s56, 105472
    s_nop 0
    buffer_load_dwordx4 v44, s[12:15], s54 offen offset:1024 lds
    buffer_load_dwordx4 v45, s[12:15], s54 offen offset:2048 lds
    s_lshr_b32 s51, s7, 2
    s_mul_i32 s51, s51, 7
    s_and_b32 s52, s7, 3
    s_lshl1_add_u32 s51, s52, s51
    s_cmp_eq_u32 s52, 3
    s_cselect_b32 s63, 2, 0
    s_subb_u32 s51, s51, 0
    s_bitcmp1_b32 s2, 6
    s_cselect_b32 s52, 3, 4
    s_mul_i32 s52, s52, s61
    s_add_u32 s63, s63, s52
    s_lshl3_add_u32 s52, s33, s3
    s_mul_i32 s52, s52, 224
    s_add_u32 s52, s52, s51
    s_lshl_b32 s58, s52, 7
    s_lshl_b32 s59, s3, 10
    s_lshl2_add_u32 s51, s51, s63
    s_mul_i32 s52, s62, 144
    s_add_u32 s51, s51, s52
    s_lshl_b32 s51, s51, 10
    s_add_u32 s77, s51, 8388608
    s_lshr_b32 s51, s7, 2
    s_and_b32 s52, s7, 1
    s_lshl1_add_u32 s51, s51, s52
    s_lshl1_add_u32 s51, s51, s61
    s_lshl_b32 s51, s51, 7
    s_add_u32 s51, s51, s62
    s_lshl_b32 s51, s51, 10
    s_add_u32 s74, s51, 2097152
    v_add_u32 v12, 0x10000, v12
    v_add_u32 v13, 0x10000, v13
    v_add_u32 v46, 0x10000, v46
    v_add_u32 v6, 0x10000, v6
    v_add_u32 v7, 0x10000, v7
    s_waitcnt lgkmcnt(0)
    s_waitcnt vmcnt(4)
    s_barrier
    v_dot2c_f32_bf16 v40, s71, v88
    v_dot2c_f32_bf16 v41, s71, v92
    v_dot2c_f32_bf16 v40, s71, v89
    v_dot2c_f32_bf16 v41, s71, v93
    v_dot2c_f32_bf16 v40, s71, v90
    v_dot2c_f32_bf16 v41, s71, v94
    v_dot2c_f32_bf16 v40, s71, v91
    v_dot2c_f32_bf16 v41, s71, v95
    v_dot2c_f32_bf16 v42, s71, v144
    v_dot2c_f32_bf16 v43, v144, v144
    v_dot2c_f32_bf16 v42, s71, v145
    v_dot2c_f32_bf16 v43, v145, v145
    v_dot2c_f32_bf16 v42, s71, v146
    v_dot2c_f32_bf16 v43, v146, v146
    v_dot2c_f32_bf16 v42, s71, v147
    v_dot2c_f32_bf16 v43, v147, v147
    v_dot2c_f32_bf16 v14, s71, v148
    v_dot2c_f32_bf16 v15, v148, v148
    v_dot2c_f32_bf16 v14, s71, v149
    v_dot2c_f32_bf16 v15, v149, v149
    v_dot2c_f32_bf16 v14, s71, v150
    v_dot2c_f32_bf16 v15, v150, v150
    v_dot2c_f32_bf16 v14, s71, v151
    v_dot2c_f32_bf16 v15, v151, v151
    v_dot2c_f32_bf16 v42, s71, v152
    v_dot2c_f32_bf16 v43, v152, v152
    v_dot2c_f32_bf16 v42, s71, v153
    v_dot2c_f32_bf16 v43, v153, v153
    v_dot2c_f32_bf16 v42, s71, v154
    v_dot2c_f32_bf16 v43, v154, v154
    v_dot2c_f32_bf16 v42, s71, v155
    v_dot2c_f32_bf16 v43, v155, v155
    v_dot2c_f32_bf16 v14, s71, v156
    v_dot2c_f32_bf16 v15, v156, v156
    v_dot2c_f32_bf16 v14, s71, v157
    v_dot2c_f32_bf16 v15, v157, v157
    v_dot2c_f32_bf16 v14, s71, v158
    v_dot2c_f32_bf16 v15, v158, v158
    v_dot2c_f32_bf16 v14, s71, v159
    v_dot2c_f32_bf16 v15, v159, v159
    v_mfma_f32_16x16x32_bf16 v[96:99], v[56:59], v[144:147], v[96:99]
    v_mfma_f32_16x16x32_bf16 v[100:103], v[56:59], v[148:151], v[100:103]
    ds_read_b128 v[160:163], v12 offset:0
    ds_read_b64_tr_b16 v[16:17], v46 offset:16384
    ds_read_b64_tr_b16 v[18:19], v46 offset:16896
    v_mfma_f32_16x16x32_bf16 v[112:115], v[60:63], v[144:147], v[112:115]
    v_mfma_f32_16x16x32_bf16 v[116:119], v[60:63], v[148:151], v[116:119]
    ds_read_b128 v[164:167], v12 offset:2048
    ds_read_b64_tr_b16 v[20:21], v46 offset:24576
    ds_read_b64_tr_b16 v[22:23], v46 offset:25088
    v_mfma_f32_16x16x32_bf16 v[104:107], v[64:67], v[144:147], v[104:107]
    v_mfma_f32_16x16x32_bf16 v[108:111], v[64:67], v[148:151], v[108:111]
    ds_read_b128 v[168:171], v13 offset:0
    ds_read_b64_tr_b16 v[24:25], v6 offset:16384
    ds_read_b64_tr_b16 v[26:27], v6 offset:16896
    v_mfma_f32_16x16x32_bf16 v[120:123], v[68:71], v[144:147], v[120:123]
    v_mfma_f32_16x16x32_bf16 v[124:127], v[68:71], v[148:151], v[124:127]
    ds_read_b128 v[172:175], v13 offset:2048
    ds_read_b64_tr_b16 v[28:29], v6 offset:24576
    ds_read_b64_tr_b16 v[30:31], v6 offset:25088
    v_mfma_f32_16x16x32_bf16 v[96:99], v[72:75], v[152:155], v[96:99]
    v_mfma_f32_16x16x32_bf16 v[100:103], v[72:75], v[156:159], v[100:103]
    ds_read_b64_tr_b16 v[88:89], v7 offset:16384
    ds_read_b64_tr_b16 v[90:91], v7 offset:16896
    ds_read_b64_tr_b16 v[32:33], v46 offset:20480
    ds_read_b64_tr_b16 v[34:35], v46 offset:20992
    v_mfma_f32_16x16x32_bf16 v[112:115], v[76:79], v[152:155], v[112:115]
    v_mfma_f32_16x16x32_bf16 v[116:119], v[76:79], v[156:159], v[116:119]
    ds_read_b64_tr_b16 v[92:93], v7 offset:24576
    ds_read_b64_tr_b16 v[94:95], v7 offset:25088
    ds_read_b64_tr_b16 v[36:37], v46 offset:28672
    ds_read_b64_tr_b16 v[38:39], v46 offset:29184
    v_mfma_f32_16x16x32_bf16 v[104:107], v[80:83], v[152:155], v[104:107]
    v_mfma_f32_16x16x32_bf16 v[108:111], v[80:83], v[156:159], v[108:111]
    ds_read_b64_tr_b16 v[48:49], v6 offset:20480
    ds_read_b64_tr_b16 v[50:51], v6 offset:20992
    v_mfma_f32_16x16x32_bf16 v[120:123], v[84:87], v[152:155], v[120:123]
    v_mfma_f32_16x16x32_bf16 v[124:127], v[84:87], v[156:159], v[124:127]
    ds_read_b64_tr_b16 v[52:53], v6 offset:28672
    ds_read_b64_tr_b16 v[54:55], v6 offset:29184
    s_add_u32 m0, s56, 0
    s_add_u32 s54, s54, 196608
    s_cmp_eq_u32 s33, 4
    s_cselect_b32 s52, 1572864, 0
    s_sub_u32 s54, s54, s52
    buffer_load_dwordx4 v44, s[12:15], s54 offen lds
    buffer_load_dwordx4 v45, s[12:15], s54 offen offset:1024 lds
    s_add_u32 m0, s56, 7168
    s_nop 0
    buffer_load_dwordx4 v44, s[12:15], s54 offen offset:1024 lds
    buffer_load_dwordx4 v45, s[12:15], s54 offen offset:2048 lds
    v_lshrrev_b32 v3, 2, v1
    v_and_b32 v3, 64, v3
    v_xor_b32 v3, v3, v1
    v_and_b32 v3, 0x70, v3
    s_and_b32 s51, s3, 1
    s_lshl_b32 s51, s51, 5
    v_xor_b32 v3, s51, v3
    v_lshrrev_b32 v4, 7, v1
    v_mul_u32_u24 v8, 3584, v4
    v_add_u32 v8, v8, v3
    v_mov_b32 v3, v9
    s_add_u32 s51, s63, 0
    s_and_b32 s52, s51, 3
    s_lshl_b32 s52, s52, 5
    s_lshr_b32 s51, s51, 2
    s_lshl_b32 s51, s51, 14
    s_or_b32 s51, s51, s52
    v_xor_b32 v9, s51, v3
    s_add_u32 s51, s63, 1
    s_and_b32 s52, s51, 3
    s_lshl_b32 s52, s52, 5
    s_lshr_b32 s51, s51, 2
    s_lshl_b32 s51, s51, 14
    s_or_b32 s51, s51, s52
    v_xor_b32 v10, s51, v3
    s_add_u32 s51, s63, 2
    s_and_b32 s52, s51, 3
    s_lshl_b32 s52, s52, 5
    s_lshr_b32 s51, s51, 2
    s_lshl_b32 s51, s51, 14
    s_or_b32 s51, s51, s52
    v_xor_b32 v11, s51, v3
    s_add_u32 s51, s63, 3
    s_and_b32 s52, s51, 3
    s_lshl_b32 s52, s52, 5
    s_lshr_b32 s51, s51, 2
    s_lshl_b32 s51, s51, 14
    s_or_b32 s51, s51, s52
    v_xor_b32 v47, s51, v3
    s_waitcnt lgkmcnt(0)
    s_waitcnt vmcnt(4)
    s_barrier
    v_dot2c_f32_bf16 v40, s71, v88
    v_dot2c_f32_bf16 v41, s71, v92
    v_dot2c_f32_bf16 v40, s71, v89
    v_dot2c_f32_bf16 v41, s71, v93
    v_dot2c_f32_bf16 v40, s71, v90
    v_dot2c_f32_bf16 v41, s71, v94
    v_dot2c_f32_bf16 v40, s71, v91
    v_dot2c_f32_bf16 v41, s71, v95
    v_dot2c_f32_bf16 v42, s71, v160
    v_dot2c_f32_bf16 v43, v160, v160
    v_dot2c_f32_bf16 v42, s71, v161
    v_dot2c_f32_bf16 v43, v161, v161
    v_dot2c_f32_bf16 v42, s71, v162
    v_dot2c_f32_bf16 v43, v162, v162
    v_dot2c_f32_bf16 v42, s71, v163
    v_dot2c_f32_bf16 v43, v163, v163
    v_dot2c_f32_bf16 v14, s71, v164
    v_dot2c_f32_bf16 v15, v164, v164
    v_dot2c_f32_bf16 v14, s71, v165
    v_dot2c_f32_bf16 v15, v165, v165
    v_dot2c_f32_bf16 v14, s71, v166
    v_dot2c_f32_bf16 v15, v166, v166
    v_dot2c_f32_bf16 v14, s71, v167
    v_dot2c_f32_bf16 v15, v167, v167
    v_dot2c_f32_bf16 v42, s71, v168
    v_dot2c_f32_bf16 v43, v168, v168
    v_dot2c_f32_bf16 v42, s71, v169
    v_dot2c_f32_bf16 v43, v169, v169
    v_dot2c_f32_bf16 v42, s71, v170
    v_dot2c_f32_bf16 v43, v170, v170
    v_dot2c_f32_bf16 v42, s71, v171
    v_dot2c_f32_bf16 v43, v171, v171
    v_dot2c_f32_bf16 v14, s71, v172
    v_dot2c_f32_bf16 v15, v172, v172
    v_dot2c_f32_bf16 v14, s71, v173
    v_dot2c_f32_bf16 v15, v173, v173
    v_dot2c_f32_bf16 v14, s71, v174
    v_dot2c_f32_bf16 v15, v174, v174
    v_dot2c_f32_bf16 v14, s71, v175
    v_dot2c_f32_bf16 v15, v175, v175
    v_mfma_f32_16x16x32_bf16 v[96:99], v[16:19], v[160:163], v[96:99]
    v_mfma_f32_16x16x32_bf16 v[100:103], v[16:19], v[164:167], v[100:103]
    ds_read_b128 v[176:179], v12 offset:32768
    ds_read_b64_tr_b16 v[56:57], v46 offset:49152
    ds_read_b64_tr_b16 v[58:59], v46 offset:49664
    v_mfma_f32_16x16x32_bf16 v[112:115], v[20:23], v[160:163], v[112:115]
    v_mfma_f32_16x16x32_bf16 v[116:119], v[20:23], v[164:167], v[116:119]
    ds_read_b128 v[180:183], v12 offset:34816
    ds_read_b64_tr_b16 v[60:61], v46 offset:57344
    ds_read_b64_tr_b16 v[62:63], v46 offset:57856
    v_mfma_f32_16x16x32_bf16 v[104:107], v[24:27], v[160:163], v[104:107]
    v_mfma_f32_16x16x32_bf16 v[108:111], v[24:27], v[164:167], v[108:111]
    ds_read_b128 v[184:187], v13 offset:32768
    ds_read_b64_tr_b16 v[64:65], v6 offset:49152
    ds_read_b64_tr_b16 v[66:67], v6 offset:49664
    v_mfma_f32_16x16x32_bf16 v[120:123], v[28:31], v[160:163], v[120:123]
    v_mfma_f32_16x16x32_bf16 v[124:127], v[28:31], v[164:167], v[124:127]
    ds_read_b128 v[188:191], v13 offset:34816
    ds_read_b64_tr_b16 v[68:69], v6 offset:57344
    ds_read_b64_tr_b16 v[70:71], v6 offset:57856
    v_mfma_f32_16x16x32_bf16 v[96:99], v[32:35], v[168:171], v[96:99]
    v_mfma_f32_16x16x32_bf16 v[100:103], v[32:35], v[172:175], v[100:103]
    ds_read_b64_tr_b16 v[88:89], v7 offset:49152
    ds_read_b64_tr_b16 v[90:91], v7 offset:49664
    ds_read_b64_tr_b16 v[72:73], v46 offset:53248
    ds_read_b64_tr_b16 v[74:75], v46 offset:53760
    v_mfma_f32_16x16x32_bf16 v[112:115], v[36:39], v[168:171], v[112:115]
    v_mfma_f32_16x16x32_bf16 v[116:119], v[36:39], v[172:175], v[116:119]
    ds_read_b64_tr_b16 v[92:93], v7 offset:57344
    ds_read_b64_tr_b16 v[94:95], v7 offset:57856
    ds_read_b64_tr_b16 v[76:77], v46 offset:61440
    ds_read_b64_tr_b16 v[78:79], v46 offset:61952
    v_mfma_f32_16x16x32_bf16 v[104:107], v[48:51], v[168:171], v[104:107]
    v_mfma_f32_16x16x32_bf16 v[108:111], v[48:51], v[172:175], v[108:111]
    ds_read_b64_tr_b16 v[80:81], v6 offset:53248
    ds_read_b64_tr_b16 v[82:83], v6 offset:53760
    v_mfma_f32_16x16x32_bf16 v[120:123], v[52:55], v[168:171], v[120:123]
    v_mfma_f32_16x16x32_bf16 v[124:127], v[52:55], v[172:175], v[124:127]
    ds_read_b64_tr_b16 v[84:85], v6 offset:61440
    ds_read_b64_tr_b16 v[86:87], v6 offset:61952
    s_add_u32 m0, s56, 32768
    s_add_u32 s54, s54, 196608
    buffer_load_dwordx4 v44, s[12:15], s54 offen lds
    buffer_load_dwordx4 v45, s[12:15], s54 offen offset:1024 lds
    s_add_u32 m0, s56, 39936
    s_nop 0
    buffer_load_dwordx4 v44, s[12:15], s54 offen offset:1024 lds
    buffer_load_dwordx4 v45, s[12:15], s54 offen offset:2048 lds
    s_lshr_b32 s51, s62, 1
    s_lshl4_add_u32 s51, s51, s7
    s_lshl1_add_u32 s51, s51, s61
    s_and_b32 s52, s62, 1
    s_lshl1_add_u32 s51, s51, s52
    s_lshl_b32 s51, s51, 3
    s_add_u32 s78, s51, 17891328
    s_lshl_b32 s94, s34, 16
    s_lshl_b32 s52, s35, 7
    s_add_u32 s94, s94, s52
    s_lshl1_add_u32 s0, s7, s61
    s_lshl_b32 s0, s0, 13
    s_add_u32 s0, s0, 18350080
    s_lshl_b32 s52, s6, 9
    s_add_u32 s1, s0, s52
    s_lshl_b32 s51, s61, 1
    s_cmp_eq_u32 s32, s51
    s_cselect_b32 s1, s1, 0x7ff00000
    s_and_b32 s52, s6, 1
    s_lshl_b32 s60, s52, 12
    s_bitcmp1_b32 s6, 1
    s_cselect_b32 s52, 32768, 0
    s_add_u32 s60, s60, s52
    s_and_b32 s52, s32, 1
    s_lshl_b32 s52, s52, 12
    s_add_u32 s0, s0, s52
    s_lshr_b32 s52, s32, 1
    s_lshl_b32 s52, s52, 8
    s_add_u32 s0, s0, s52
    v_add_u32 v12, 0xffff0000, v12
    v_add_u32 v13, 0xffff0000, v13
    v_add_u32 v46, 0xffff0000, v46
    v_add_u32 v6, 0xffff0000, v6
    v_add_u32 v7, 0xffff0000, v7
    s_waitcnt lgkmcnt(0)
    s_waitcnt vmcnt(4)
    s_barrier
    v_dot2c_f32_bf16 v40, s71, v88
    v_dot2c_f32_bf16 v41, s71, v92
    v_dot2c_f32_bf16 v40, s71, v89
    v_dot2c_f32_bf16 v41, s71, v93
    v_dot2c_f32_bf16 v40, s71, v90
    v_dot2c_f32_bf16 v41, s71, v94
    v_dot2c_f32_bf16 v40, s71, v91
    v_dot2c_f32_bf16 v41, s71, v95
    v_dot2c_f32_bf16 v42, s71, v176
    v_dot2c_f32_bf16 v43, v176, v176
    v_dot2c_f32_bf16 v42, s71, v177
    v_dot2c_f32_bf16 v43, v177, v177
    v_dot2c_f32_bf16 v42, s71, v178
    v_dot2c_f32_bf16 v43, v178, v178
    v_dot2c_f32_bf16 v42, s71, v179
    v_dot2c_f32_bf16 v43, v179, v179
    v_dot2c_f32_bf16 v14, s71, v180
    v_dot2c_f32_bf16 v15, v180, v180
    v_dot2c_f32_bf16 v14, s71, v181
    v_dot2c_f32_bf16 v15, v181, v181
    v_dot2c_f32_bf16 v14, s71, v182
    v_dot2c_f32_bf16 v15, v182, v182
    v_dot2c_f32_bf16 v14, s71, v183
    v_dot2c_f32_bf16 v15, v183, v183
    v_dot2c_f32_bf16 v42, s71, v184
    v_dot2c_f32_bf16 v43, v184, v184
    v_dot2c_f32_bf16 v42, s71, v185
    v_dot2c_f32_bf16 v43, v185, v185
    v_dot2c_f32_bf16 v42, s71, v186
    v_dot2c_f32_bf16 v43, v186, v186
    v_dot2c_f32_bf16 v42, s71, v187
    v_dot2c_f32_bf16 v43, v187, v187
    v_dot2c_f32_bf16 v14, s71, v188
    v_dot2c_f32_bf16 v15, v188, v188
    v_dot2c_f32_bf16 v14, s71, v189
    v_dot2c_f32_bf16 v15, v189, v189
    v_dot2c_f32_bf16 v14, s71, v190
    v_dot2c_f32_bf16 v15, v190, v190
    v_dot2c_f32_bf16 v14, s71, v191
    v_dot2c_f32_bf16 v15, v191, v191
    v_mfma_f32_16x16x32_bf16 v[96:99], v[56:59], v[176:179], v[96:99]
    v_mfma_f32_16x16x32_bf16 v[100:103], v[56:59], v[180:183], v[100:103]
    ds_read_b128 v[192:195], v12 offset:0
    ds_read_b64_tr_b16 v[16:17], v46 offset:16384
    ds_read_b64_tr_b16 v[18:19], v46 offset:16896
    v_mfma_f32_16x16x32_bf16 v[112:115], v[60:63], v[176:179], v[112:115]
    v_mfma_f32_16x16x32_bf16 v[116:119], v[60:63], v[180:183], v[116:119]
    ds_read_b128 v[196:199], v12 offset:2048
    ds_read_b64_tr_b16 v[20:21], v46 offset:24576
    ds_read_b64_tr_b16 v[22:23], v46 offset:25088
    v_mfma_f32_16x16x32_bf16 v[104:107], v[64:67], v[176:179], v[104:107]
    v_mfma_f32_16x16x32_bf16 v[108:111], v[64:67], v[180:183], v[108:111]
    ds_read_b128 v[200:203], v13 offset:0
    ds_read_b64_tr_b16 v[24:25], v6 offset:16384
    ds_read_b64_tr_b16 v[26:27], v6 offset:16896
    v_mfma_f32_16x16x32_bf16 v[120:123], v[68:71], v[176:179], v[120:123]
    v_mfma_f32_16x16x32_bf16 v[124:127], v[68:71], v[180:183], v[124:127]
    ds_read_b128 v[204:207], v13 offset:2048
    ds_read_b64_tr_b16 v[28:29], v6 offset:24576
    ds_read_b64_tr_b16 v[30:31], v6 offset:25088
    v_mfma_f32_16x16x32_bf16 v[96:99], v[72:75], v[184:187], v[96:99]
    v_mfma_f32_16x16x32_bf16 v[100:103], v[72:75], v[188:191], v[100:103]
    ds_read_b64_tr_b16 v[88:89], v7 offset:16384
    ds_read_b64_tr_b16 v[90:91], v7 offset:16896
    ds_read_b64_tr_b16 v[32:33], v46 offset:20480
    ds_read_b64_tr_b16 v[34:35], v46 offset:20992
    v_mfma_f32_16x16x32_bf16 v[112:115], v[76:79], v[184:187], v[112:115]
    v_mfma_f32_16x16x32_bf16 v[116:119], v[76:79], v[188:191], v[116:119]
    ds_read_b64_tr_b16 v[92:93], v7 offset:24576
    ds_read_b64_tr_b16 v[94:95], v7 offset:25088
    ds_read_b64_tr_b16 v[36:37], v46 offset:28672
    ds_read_b64_tr_b16 v[38:39], v46 offset:29184
    v_mfma_f32_16x16x32_bf16 v[104:107], v[80:83], v[184:187], v[104:107]
    v_mfma_f32_16x16x32_bf16 v[108:111], v[80:83], v[188:191], v[108:111]
    ds_read_b64_tr_b16 v[48:49], v6 offset:20480
    ds_read_b64_tr_b16 v[50:51], v6 offset:20992
    v_mfma_f32_16x16x32_bf16 v[120:123], v[84:87], v[184:187], v[120:123]
    v_mfma_f32_16x16x32_bf16 v[124:127], v[84:87], v[188:191], v[124:127]
    ds_read_b64_tr_b16 v[52:53], v6 offset:28672
    ds_read_b64_tr_b16 v[54:55], v6 offset:29184
    s_add_u32 m0, s56, 65536
    s_add_u32 s54, s54, 196608
    s_cmp_eq_u32 s33, 2
    s_cselect_b32 s52, 1572864, 0
    s_sub_u32 s54, s54, s52
    buffer_load_dwordx4 v44, s[12:15], s54 offen lds
    buffer_load_dwordx4 v45, s[12:15], s54 offen offset:1024 lds
    s_add_u32 m0, s56, 72704
    s_nop 0
    buffer_load_dwordx4 v44, s[12:15], s54 offen offset:1024 lds
    buffer_load_dwordx4 v45, s[12:15], s54 offen offset:2048 lds
    s_waitcnt lgkmcnt(0)
    s_waitcnt vmcnt(4)
    s_barrier
    s_load_dwordx2 s[48:49], s[44:45], 0
    v_dot2c_f32_bf16 v40, s71, v88
    v_dot2c_f32_bf16 v41, s71, v92
    v_dot2c_f32_bf16 v40, s71, v89
    v_dot2c_f32_bf16 v41, s71, v93
    v_dot2c_f32_bf16 v40, s71, v90
    v_dot2c_f32_bf16 v41, s71, v94
    v_dot2c_f32_bf16 v40, s71, v91
    v_dot2c_f32_bf16 v41, s71, v95
    v_dot2c_f32_bf16 v42, s71, v192
    v_dot2c_f32_bf16 v43, v192, v192
    v_dot2c_f32_bf16 v42, s71, v193
    v_dot2c_f32_bf16 v43, v193, v193
    v_dot2c_f32_bf16 v42, s71, v194
    v_dot2c_f32_bf16 v43, v194, v194
    v_dot2c_f32_bf16 v42, s71, v195
    v_dot2c_f32_bf16 v43, v195, v195
    v_dot2c_f32_bf16 v14, s71, v196
    v_dot2c_f32_bf16 v15, v196, v196
    v_dot2c_f32_bf16 v14, s71, v197
    v_dot2c_f32_bf16 v15, v197, v197
    v_dot2c_f32_bf16 v14, s71, v198
    v_dot2c_f32_bf16 v15, v198, v198
    v_dot2c_f32_bf16 v14, s71, v199
    v_dot2c_f32_bf16 v15, v199, v199
    v_dot2c_f32_bf16 v42, s71, v200
    v_dot2c_f32_bf16 v43, v200, v200
    v_dot2c_f32_bf16 v42, s71, v201
    v_dot2c_f32_bf16 v43, v201, v201
    v_dot2c_f32_bf16 v42, s71, v202
    v_dot2c_f32_bf16 v43, v202, v202
    v_dot2c_f32_bf16 v42, s71, v203
    v_dot2c_f32_bf16 v43, v203, v203
    v_dot2c_f32_bf16 v14, s71, v204
    v_dot2c_f32_bf16 v15, v204, v204
    v_dot2c_f32_bf16 v14, s71, v205
    v_dot2c_f32_bf16 v15, v205, v205
    v_dot2c_f32_bf16 v14, s71, v206
    v_dot2c_f32_bf16 v15, v206, v206
    v_dot2c_f32_bf16 v14, s71, v207
    v_dot2c_f32_bf16 v15, v207, v207
    v_mfma_f32_16x16x32_bf16 v[96:99], v[16:19], v[192:195], v[96:99]
    v_mfma_f32_16x16x32_bf16 v[100:103], v[16:19], v[196:199], v[100:103]
    ds_read_b128 v[208:211], v12 offset:32768
    ds_read_b64_tr_b16 v[56:57], v46 offset:49152
    ds_read_b64_tr_b16 v[58:59], v46 offset:49664
    v_mfma_f32_16x16x32_bf16 v[112:115], v[20:23], v[192:195], v[112:115]
    v_mfma_f32_16x16x32_bf16 v[116:119], v[20:23], v[196:199], v[116:119]
    ds_read_b128 v[212:215], v12 offset:34816
    ds_read_b64_tr_b16 v[60:61], v46 offset:57344
    ds_read_b64_tr_b16 v[62:63], v46 offset:57856
    v_mfma_f32_16x16x32_bf16 v[104:107], v[24:27], v[192:195], v[104:107]
    v_mfma_f32_16x16x32_bf16 v[108:111], v[24:27], v[196:199], v[108:111]
    ds_read_b128 v[216:219], v13 offset:32768
    ds_read_b64_tr_b16 v[64:65], v6 offset:49152
    ds_read_b64_tr_b16 v[66:67], v6 offset:49664
    v_mfma_f32_16x16x32_bf16 v[120:123], v[28:31], v[192:195], v[120:123]
    v_mfma_f32_16x16x32_bf16 v[124:127], v[28:31], v[196:199], v[124:127]
    ds_read_b128 v[220:223], v13 offset:34816
    ds_read_b64_tr_b16 v[68:69], v6 offset:57344
    ds_read_b64_tr_b16 v[70:71], v6 offset:57856
    v_mfma_f32_16x16x32_bf16 v[96:99], v[32:35], v[200:203], v[96:99]
    v_mfma_f32_16x16x32_bf16 v[100:103], v[32:35], v[204:207], v[100:103]
    ds_read_b64_tr_b16 v[88:89], v7 offset:49152
    ds_read_b64_tr_b16 v[90:91], v7 offset:49664
    ds_read_b64_tr_b16 v[72:73], v46 offset:53248
    ds_read_b64_tr_b16 v[74:75], v46 offset:53760
    v_mfma_f32_16x16x32_bf16 v[112:115], v[36:39], v[200:203], v[112:115]
    v_mfma_f32_16x16x32_bf16 v[116:119], v[36:39], v[204:207], v[116:119]
    ds_read_b64_tr_b16 v[92:93], v7 offset:57344
    ds_read_b64_tr_b16 v[94:95], v7 offset:57856
    ds_read_b64_tr_b16 v[76:77], v46 offset:61440
    ds_read_b64_tr_b16 v[78:79], v46 offset:61952
    v_mfma_f32_16x16x32_bf16 v[104:107], v[48:51], v[200:203], v[104:107]
    v_mfma_f32_16x16x32_bf16 v[108:111], v[48:51], v[204:207], v[108:111]
    ds_read_b64_tr_b16 v[80:81], v6 offset:53248
    ds_read_b64_tr_b16 v[82:83], v6 offset:53760
    v_mfma_f32_16x16x32_bf16 v[120:123], v[52:55], v[200:203], v[120:123]
    v_mfma_f32_16x16x32_bf16 v[124:127], v[52:55], v[204:207], v[124:127]
    ds_read_b64_tr_b16 v[84:85], v6 offset:61440
    ds_read_b64_tr_b16 v[86:87], v6 offset:61952
    s_add_u32 m0, s56, 98304
    s_add_u32 s54, s54, 196608
    buffer_load_dwordx4 v44, s[12:15], s54 offen lds
    buffer_load_dwordx4 v45, s[12:15], s54 offen offset:1024 lds
    s_add_u32 m0, s56, 105472
    s_nop 0
    buffer_load_dwordx4 v44, s[12:15], s54 offen offset:1024 lds
    buffer_load_dwordx4 v45, s[12:15], s54 offen offset:2048 lds
    v_add_u32 v12, 0x10000, v12
    v_add_u32 v13, 0x10000, v13
    v_add_u32 v46, 0x10000, v46
    v_add_u32 v6, 0x10000, v6
    v_add_u32 v7, 0x10000, v7
    s_waitcnt lgkmcnt(0)
    s_waitcnt vmcnt(4)
    s_barrier
    v_dot2c_f32_bf16 v40, s71, v88
    v_dot2c_f32_bf16 v41, s71, v92
    v_dot2c_f32_bf16 v40, s71, v89
    v_dot2c_f32_bf16 v41, s71, v93
    v_dot2c_f32_bf16 v40, s71, v90
    v_dot2c_f32_bf16 v41, s71, v94
    v_dot2c_f32_bf16 v40, s71, v91
    v_dot2c_f32_bf16 v41, s71, v95
    v_dot2c_f32_bf16 v42, s71, v208
    v_dot2c_f32_bf16 v43, v208, v208
    v_dot2c_f32_bf16 v42, s71, v209
    v_dot2c_f32_bf16 v43, v209, v209
    v_dot2c_f32_bf16 v42, s71, v210
    v_dot2c_f32_bf16 v43, v210, v210
    v_dot2c_f32_bf16 v42, s71, v211
    v_dot2c_f32_bf16 v43, v211, v211
    v_dot2c_f32_bf16 v14, s71, v212
    v_dot2c_f32_bf16 v15, v212, v212
    v_dot2c_f32_bf16 v14, s71, v213
    v_dot2c_f32_bf16 v15, v213, v213
    v_dot2c_f32_bf16 v14, s71, v214
    v_dot2c_f32_bf16 v15, v214, v214
    v_dot2c_f32_bf16 v14, s71, v215
    v_dot2c_f32_bf16 v15, v215, v215
    v_dot2c_f32_bf16 v42, s71, v216
    v_dot2c_f32_bf16 v43, v216, v216
    v_dot2c_f32_bf16 v42, s71, v217
    v_dot2c_f32_bf16 v43, v217, v217
    v_dot2c_f32_bf16 v42, s71, v218
    v_dot2c_f32_bf16 v43, v218, v218
    v_dot2c_f32_bf16 v42, s71, v219
    v_dot2c_f32_bf16 v43, v219, v219
    v_dot2c_f32_bf16 v14, s71, v220
    v_dot2c_f32_bf16 v15, v220, v220
    v_dot2c_f32_bf16 v14, s71, v221
    v_dot2c_f32_bf16 v15, v221, v221
    v_dot2c_f32_bf16 v14, s71, v222
    v_dot2c_f32_bf16 v15, v222, v222
    v_dot2c_f32_bf16 v14, s71, v223
    v_dot2c_f32_bf16 v15, v223, v223
    v_mfma_f32_16x16x32_bf16 v[96:99], v[56:59], v[208:211], v[96:99]
    v_mfma_f32_16x16x32_bf16 v[100:103], v[56:59], v[212:215], v[100:103]
    ds_read_b128 v[224:227], v12 offset:0
    ds_read_b64_tr_b16 v[16:17], v46 offset:16384
    ds_read_b64_tr_b16 v[18:19], v46 offset:16896
    v_mfma_f32_16x16x32_bf16 v[112:115], v[60:63], v[208:211], v[112:115]
    v_mfma_f32_16x16x32_bf16 v[116:119], v[60:63], v[212:215], v[116:119]
    ds_read_b128 v[228:231], v12 offset:2048
    ds_read_b64_tr_b16 v[20:21], v46 offset:24576
    ds_read_b64_tr_b16 v[22:23], v46 offset:25088
    v_mfma_f32_16x16x32_bf16 v[104:107], v[64:67], v[208:211], v[104:107]
    v_mfma_f32_16x16x32_bf16 v[108:111], v[64:67], v[212:215], v[108:111]
    ds_read_b128 v[232:235], v13 offset:0
    ds_read_b64_tr_b16 v[24:25], v6 offset:16384
    ds_read_b64_tr_b16 v[26:27], v6 offset:16896
    v_mfma_f32_16x16x32_bf16 v[120:123], v[68:71], v[208:211], v[120:123]
    v_mfma_f32_16x16x32_bf16 v[124:127], v[68:71], v[212:215], v[124:127]
    ds_read_b128 v[236:239], v13 offset:2048
    ds_read_b64_tr_b16 v[28:29], v6 offset:24576
    ds_read_b64_tr_b16 v[30:31], v6 offset:25088
    v_mfma_f32_16x16x32_bf16 v[96:99], v[72:75], v[216:219], v[96:99]
    v_mfma_f32_16x16x32_bf16 v[100:103], v[72:75], v[220:223], v[100:103]
    ds_read_b64_tr_b16 v[88:89], v7 offset:16384
    ds_read_b64_tr_b16 v[90:91], v7 offset:16896
    ds_read_b64_tr_b16 v[32:33], v46 offset:20480
    ds_read_b64_tr_b16 v[34:35], v46 offset:20992
    v_mfma_f32_16x16x32_bf16 v[112:115], v[76:79], v[216:219], v[112:115]
    v_mfma_f32_16x16x32_bf16 v[116:119], v[76:79], v[220:223], v[116:119]
    ds_read_b64_tr_b16 v[92:93], v7 offset:24576
    ds_read_b64_tr_b16 v[94:95], v7 offset:25088
    ds_read_b64_tr_b16 v[36:37], v46 offset:28672
    ds_read_b64_tr_b16 v[38:39], v46 offset:29184
    v_mfma_f32_16x16x32_bf16 v[104:107], v[80:83], v[216:219], v[104:107]
    v_mfma_f32_16x16x32_bf16 v[108:111], v[80:83], v[220:223], v[108:111]
    ds_read_b64_tr_b16 v[48:49], v6 offset:20480
    ds_read_b64_tr_b16 v[50:51], v6 offset:20992
    v_mfma_f32_16x16x32_bf16 v[120:123], v[84:87], v[216:219], v[120:123]
    v_mfma_f32_16x16x32_bf16 v[124:127], v[84:87], v[220:223], v[124:127]
    ds_read_b64_tr_b16 v[52:53], v6 offset:28672
    ds_read_b64_tr_b16 v[54:55], v6 offset:29184
    s_add_u32 m0, s59, 0
    s_nop 0
    buffer_load_dwordx4 v8, s[20:23], s58 offen offset:0 lds
    s_add_u32 m0, s59, 8192
    s_nop 0
    buffer_load_dwordx4 v8, s[24:27], s58 offen offset:0 lds
    s_add_u32 m0, s59, 16256
    s_nop 0
    buffer_load_dwordx4 v8, s[20:23], s58 offen offset:128 lds
    s_add_u32 m0, s59, 24448
    s_nop 0
    buffer_load_dwordx4 v8, s[24:27], s58 offen offset:128 lds
    s_waitcnt lgkmcnt(0)
    s_waitcnt vmcnt(4)
    s_barrier
    v_dot2c_f32_bf16 v40, s71, v88
    v_dot2c_f32_bf16 v41, s71, v92
    v_dot2c_f32_bf16 v40, s71, v89
    v_dot2c_f32_bf16 v41, s71, v93
    v_dot2c_f32_bf16 v40, s71, v90
    v_dot2c_f32_bf16 v41, s71, v94
    v_dot2c_f32_bf16 v40, s71, v91
    v_dot2c_f32_bf16 v41, s71, v95
    v_dot2c_f32_bf16 v42, s71, v224
    v_dot2c_f32_bf16 v43, v224, v224
    v_dot2c_f32_bf16 v42, s71, v225
    v_dot2c_f32_bf16 v43, v225, v225
    v_dot2c_f32_bf16 v42, s71, v226
    v_dot2c_f32_bf16 v43, v226, v226
    v_dot2c_f32_bf16 v42, s71, v227
    v_dot2c_f32_bf16 v43, v227, v227
    v_dot2c_f32_bf16 v14, s71, v228
    v_dot2c_f32_bf16 v15, v228, v228
    v_dot2c_f32_bf16 v14, s71, v229
    v_dot2c_f32_bf16 v15, v229, v229
    v_dot2c_f32_bf16 v14, s71, v230
    v_dot2c_f32_bf16 v15, v230, v230
    v_dot2c_f32_bf16 v14, s71, v231
    v_dot2c_f32_bf16 v15, v231, v231
    v_dot2c_f32_bf16 v42, s71, v232
    v_dot2c_f32_bf16 v43, v232, v232
    v_dot2c_f32_bf16 v42, s71, v233
    v_dot2c_f32_bf16 v43, v233, v233
    v_dot2c_f32_bf16 v42, s71, v234
    v_dot2c_f32_bf16 v43, v234, v234
    v_dot2c_f32_bf16 v42, s71, v235
    v_dot2c_f32_bf16 v43, v235, v235
    v_dot2c_f32_bf16 v14, s71, v236
    v_dot2c_f32_bf16 v15, v236, v236
    v_dot2c_f32_bf16 v14, s71, v237
    v_dot2c_f32_bf16 v15, v237, v237
    v_dot2c_f32_bf16 v14, s71, v238
    v_dot2c_f32_bf16 v15, v238, v238
    v_dot2c_f32_bf16 v14, s71, v239
    v_dot2c_f32_bf16 v15, v239, v239
    v_mfma_f32_16x16x32_bf16 v[96:99], v[16:19], v[224:227], v[96:99]
    v_mfma_f32_16x16x32_bf16 v[100:103], v[16:19], v[228:231], v[100:103]
    ds_read_b128 v[240:243], v12 offset:32768
    ds_read_b64_tr_b16 v[56:57], v46 offset:49152
    ds_read_b64_tr_b16 v[58:59], v46 offset:49664
    v_mfma_f32_16x16x32_bf16 v[112:115], v[20:23], v[224:227], v[112:115]
    v_mfma_f32_16x16x32_bf16 v[116:119], v[20:23], v[228:231], v[116:119]
    ds_read_b128 v[244:247], v12 offset:34816
    ds_read_b64_tr_b16 v[60:61], v46 offset:57344
    ds_read_b64_tr_b16 v[62:63], v46 offset:57856
    v_mfma_f32_16x16x32_bf16 v[104:107], v[24:27], v[224:227], v[104:107]
    v_mfma_f32_16x16x32_bf16 v[108:111], v[24:27], v[228:231], v[108:111]
    ds_read_b128 v[248:251], v13 offset:32768
    ds_read_b64_tr_b16 v[64:65], v6 offset:49152
    ds_read_b64_tr_b16 v[66:67], v6 offset:49664
    v_mfma_f32_16x16x32_bf16 v[120:123], v[28:31], v[224:227], v[120:123]
    v_mfma_f32_16x16x32_bf16 v[124:127], v[28:31], v[228:231], v[124:127]
    ds_read_b128 v[252:255], v13 offset:34816
    ds_read_b64_tr_b16 v[68:69], v6 offset:57344
    ds_read_b64_tr_b16 v[70:71], v6 offset:57856
    v_mfma_f32_16x16x32_bf16 v[96:99], v[32:35], v[232:235], v[96:99]
    v_mfma_f32_16x16x32_bf16 v[100:103], v[32:35], v[236:239], v[100:103]
    ds_read_b64_tr_b16 v[88:89], v7 offset:49152
    ds_read_b64_tr_b16 v[90:91], v7 offset:49664
    ds_read_b64_tr_b16 v[72:73], v46 offset:53248
    ds_read_b64_tr_b16 v[74:75], v46 offset:53760
    v_mfma_f32_16x16x32_bf16 v[112:115], v[36:39], v[232:235], v[112:115]
    v_mfma_f32_16x16x32_bf16 v[116:119], v[36:39], v[236:239], v[116:119]
    ds_read_b64_tr_b16 v[92:93], v7 offset:57344
    ds_read_b64_tr_b16 v[94:95], v7 offset:57856
    ds_read_b64_tr_b16 v[76:77], v46 offset:61440
    ds_read_b64_tr_b16 v[78:79], v46 offset:61952
    v_mfma_f32_16x16x32_bf16 v[104:107], v[48:51], v[232:235], v[104:107]
    v_mfma_f32_16x16x32_bf16 v[108:111], v[48:51], v[236:239], v[108:111]
    ds_read_b64_tr_b16 v[80:81], v6 offset:53248
    ds_read_b64_tr_b16 v[82:83], v6 offset:53760
    v_mfma_f32_16x16x32_bf16 v[120:123], v[52:55], v[232:235], v[120:123]
    v_mfma_f32_16x16x32_bf16 v[124:127], v[52:55], v[236:239], v[124:127]
    ds_read_b64_tr_b16 v[84:85], v6 offset:61440
    ds_read_b64_tr_b16 v[86:87], v6 offset:61952
    s_add_u32 m0, s59, 32768
    s_add_u32 s58, s58, 229376
    buffer_load_dwordx4 v8, s[20:23], s58 offen offset:0 lds
    s_add_u32 m0, s59, 40960
    s_nop 0
    buffer_load_dwordx4 v8, s[24:27], s58 offen offset:0 lds
    s_add_u32 m0, s59, 49024
    s_nop 0
    buffer_load_dwordx4 v8, s[20:23], s58 offen offset:128 lds
    s_add_u32 m0, s59, 57216
    s_nop 0
    buffer_load_dwordx4 v8, s[24:27], s58 offen offset:128 lds
    s_cmp_lg_u32 s48, 0
    s_cbranch_scc1 L_tokGR_x
    s_mov_b32 s50, 131072
L_tokGR:
    buffer_load_dwordx2 v[44:45], off, s[44:47], 0 sc1
    s_waitcnt vmcnt(0)
    v_readfirstlane_b32 s48, v44
    v_readfirstlane_b32 s49, v45
    s_sub_u32 s50, s50, 1
    s_cbranch_scc1 L_tokGR_x
    s_cmp_eq_u32 s48, 0
    s_cbranch_scc1 L_tokGR
L_tokGR_x:
    s_waitcnt lgkmcnt(0)
    v_dot2c_f32_bf16 v40, s71, v88
    v_dot2c_f32_bf16 v41, s71, v92
    v_dot2c_f32_bf16 v40, s71, v89
    v_dot2c_f32_bf16 v41, s71, v93
    v_dot2c_f32_bf16 v40, s71, v90
    v_dot2c_f32_bf16 v41, s71, v94
    v_dot2c_f32_bf16 v40, s71, v91
    v_dot2c_f32_bf16 v41, s71, v95
    v_dot2c_f32_bf16 v42, s71, v240
    v_dot2c_f32_bf16 v43, v240, v240
    v_dot2c_f32_bf16 v42, s71, v241
    v_dot2c_f32_bf16 v43, v241, v241
    v_dot2c_f32_bf16 v42, s71, v242
    v_dot2c_f32_bf16 v43, v242, v242
    v_dot2c_f32_bf16 v42, s71, v243
    v_dot2c_f32_bf16 v43, v243, v243
    v_dot2c_f32_bf16 v14, s71, v244
    v_dot2c_f32_bf16 v15, v244, v244
    v_dot2c_f32_bf16 v14, s71, v245
    v_dot2c_f32_bf16 v15, v245, v245
    v_dot2c_f32_bf16 v14, s71, v246
    v_dot2c_f32_bf16 v15, v246, v246
    v_dot2c_f32_bf16 v14, s71, v247
    v_dot2c_f32_bf16 v15, v247, v247
    v_dot2c_f32_bf16 v42, s71, v248
    v_dot2c_f32_bf16 v43, v248, v248
    v_dot2c_f32_bf16 v42, s71, v249
    v_dot2c_f32_bf16 v43, v249, v249
    v_dot2c_f32_bf16 v42, s71, v250
    v_dot2c_f32_bf16 v43, v250, v250
    v_dot2c_f32_bf16 v42, s71, v251
    v_dot2c_f32_bf16 v43, v251, v251
    v_dot2c_f32_bf16 v14, s71, v252
    v_dot2c_f32_bf16 v15, v252, v252
    v_dot2c_f32_bf16 v14, s71, v253
    v_dot2c_f32_bf16 v15, v253, v253
    v_dot2c_f32_bf16 v14, s71, v254
    v_dot2c_f32_bf16 v15, v254, v254
    v_dot2c_f32_bf16 v14, s71, v255
    v_dot2c_f32_bf16 v15, v255, v255
    s_lshl_b32 s52, s32, 2
    s_add_u32 s52, s52, 155648
    v_add_u32 v4, s52, v1
    v_cvt_pk_bf16_f32 v3, v40, v40
    v_lshlrev_b32 v3, 16, v3
    v_sub_f32 v5, v40, v3
    v_cvt_pk_bf16_f32 v3, v3, v5
    ds_write_b32 v4, v3 offset:0
    v_cvt_pk_bf16_f32 v3, v41, v41
    v_lshlrev_b32 v3, 16, v3
    v_sub_f32 v5, v41, v3
    v_cvt_pk_bf16_f32 v3, v3, v5
    ds_write_b32 v4, v3 offset:1024
    v_permlane32_swap_b32 v42, v14
    v_permlane32_swap_b32 v43, v15
    s_nop 1
    v_add_f32 v42, v42, v14
    v_add_f32 v43, v43, v15
    v_mov_b32 v3, v42
    v_mov_b32 v5, v43
    s_nop 1
    v_permlane16_swap_b32 v42, v3
    v_permlane16_swap_b32 v43, v5
    s_nop 1
    v_add_f32 v42, v42, v3
    v_add_f32 v43, v43, v5
    v_mul_f32 v42, 0x3b000000, v42
    v_mul_f32 v43, 0x3b000000, v43
    v_fma_f32 v43, -v42, v42, v43
    v_max_f32 v43, 0, v43
    v_cvt_pk_bf16_f32 v42, -v42, -v42
    v_cvt_pk_bf16_f32 v43, v43, v43
    v_and_b32 v43, s72, v43
    v_add_f32 v43, 0x3727c5ac, v43
    v_cvt_pk_bf16_f32 v43, v43, v43
    v_and_b32 v43, s72, v43
    v_sqrt_f32 v43, v43
    v_and_b32 v3, 0xf0, v1
    v_cvt_pk_bf16_f32 v43, v43, v43
    v_lshrrev_b32 v5, 9, v1
    v_and_b32 v43, s72, v43
    v_lshl_add_u32 v3, v5, 8, v3
    v_rcp_f32 v43, v43
    v_lshrrev_b32 v3, 1, v3
    s_lshl_b32 s52, s32, 9
    s_add_u32 s52, s52, 159744
    v_add_u32 v5, s52, v3
    ds_write_b64 v5, v[42:43]
    s_waitcnt lgkmcnt(0)
    s_waitcnt vmcnt(4)
    s_barrier
    s_setprio 1
    v_mfma_f32_16x16x32_bf16 v[96:99], v[56:59], v[240:243], v[96:99]
    v_mfma_f32_16x16x32_bf16 v[100:103], v[56:59], v[244:247], v[100:103]
    s_lshl_b32 s52, s32, 9
    s_add_u32 s52, s52, 159744
    v_bfe_u32 v3, v1, 4, 4
    v_lshl_add_u32 v3, v3, 3, s52
    ds_read_b64 v[12:13], v3
    ds_read_b64 v[14:15], v3 offset:128
    v_add_u32 v4, 155648, v1
    ds_read_b128 v[28:31], v4 offset:0
    ds_read_b128 v[32:35], v4 offset:1024
    v_mfma_f32_16x16x32_bf16 v[112:115], v[60:63], v[240:243], v[112:115]
    v_mfma_f32_16x16x32_bf16 v[116:119], v[60:63], v[244:247], v[116:119]
    ds_read_b64_tr_b16 v[16:17], v9 offset:0
    ds_read_b64_tr_b16 v[18:19], v9 offset:512
    ds_read_b64_tr_b16 v[20:21], v10 offset:0
    ds_read_b64_tr_b16 v[22:23], v10 offset:512
    ds_read_b64_tr_b16 v[24:25], v11 offset:0
    ds_read_b64_tr_b16 v[26:27], v11 offset:512
    v_mfma_f32_16x16x32_bf16 v[104:107], v[64:67], v[240:243], v[104:107]
    v_mfma_f32_16x16x32_bf16 v[108:111], v[64:67], v[244:247], v[108:111]
    s_waitcnt lgkmcnt(8)
    v_mov_b32 v88, 0
    v_mov_b32 v89, 0
    v_mov_b32 v90, v12
    v_mov_b32 v91, v12
    v_mov_b32 v92, 0
    v_mov_b32 v93, 0
    v_mov_b32 v48, 0
    v_mov_b32 v49, 0
    v_mov_b32 v50, v14
    v_mov_b32 v51, v14
    v_mov_b32 v52, 0
    v_mov_b32 v53, 0
    v_mul_f32 v44, 0x3eb8aa3b, v13
    v_mul_f32 v45, 0x3eb8aa3b, v15
    v_mfma_f32_16x16x32_bf16 v[120:123], v[68:71], v[240:243], v[120:123]
    v_mfma_f32_16x16x32_bf16 v[124:127], v[68:71], v[244:247], v[124:127]
    v_mfma_f32_16x16x32_bf16 v[96:99], v[72:75], v[248:251], v[96:99]
    v_mfma_f32_16x16x32_bf16 v[100:103], v[72:75], v[252:255], v[100:103]
    v_mfma_f32_16x16x32_bf16 v[112:115], v[76:79], v[248:251], v[112:115]
    v_mfma_f32_16x16x32_bf16 v[116:119], v[76:79], v[252:255], v[116:119]
    v_mfma_f32_16x16x32_bf16 v[104:107], v[80:83], v[248:251], v[104:107]
    v_mfma_f32_16x16x32_bf16 v[108:111], v[80:83], v[252:255], v[108:111]
    v_mfma_f32_16x16x32_bf16 v[120:123], v[84:87], v[248:251], v[120:123]
    v_mfma_f32_16x16x32_bf16 v[124:127], v[84:87], v[252:255], v[124:127]
    s_waitcnt lgkmcnt(7)
    v_mfma_f32_16x16x32_bf16 v[96:99], v[28:31], v[90:93], v[96:99]
    v_mfma_f32_16x16x32_bf16 v[100:103], v[28:31], v[50:53], v[100:103]
    v_mfma_f32_16x16x32_bf16 v[104:107], v[28:31], v[88:91], v[104:107]
    v_mfma_f32_16x16x32_bf16 v[108:111], v[28:31], v[48:51], v[108:111]
    s_waitcnt lgkmcnt(6)
    v_mfma_f32_16x16x32_bf16 v[112:115], v[32:35], v[90:93], v[112:115]
    v_mfma_f32_16x16x32_bf16 v[116:119], v[32:35], v[50:53], v[116:119]
    v_mfma_f32_16x16x32_bf16 v[120:123], v[32:35], v[88:91], v[120:123]
    v_mfma_f32_16x16x32_bf16 v[124:127], v[32:35], v[48:51], v[124:127]
    s_setprio 0
    s_add_u32 m0, s59, 65536
    s_add_u32 s58, s58, 229376
    s_cmp_eq_u32 s33, 6
    s_cselect_b32 s52, 1835008, 0
    s_sub_u32 s58, s58, s52
    buffer_load_dwordx4 v8, s[20:23], s58 offen offset:0 lds
    s_add_u32 m0, s59, 73728
    s_nop 0
    buffer_load_dwordx4 v8, s[24:27], s58 offen offset:0 lds
    s_add_u32 m0, s59, 81792
    s_nop 0
    buffer_load_dwordx4 v8, s[20:23], s58 offen offset:128 lds
    s_add_u32 m0, s59, 89984
    s_nop 0
    buffer_load_dwordx4 v8, s[24:27], s58 offen offset:128 lds
    v_lshrrev_b32 v46, 1, v1
    v_xor_b32 v46, v46, v1
    v_and_b32 v46, 0x100, v46
    v_mul_u32_u24 v46, 3, v46
    v_xor_b32 v46, v46, v1
    v_lshrrev_b32 v5, 1, v1
    v_xor_b32 v5, v5, v1
    v_and_b32 v5, 64, v5
    v_mul_u32_u24 v5, 3, v5
    v_xor_b32 v5, v5, v46
    v_mul_f32 v112, v13, v112
    v_mul_f32 v113, v13, v113
    v_mul_f32 v114, v13, v114
    v_mul_f32 v115, v13, v115
    v_mul_f32 v116, v15, v116
    v_mul_f32 v117, v15, v117
    v_mul_f32 v118, v15, v118
    v_mul_f32 v119, v15, v119
    v_mul_f32 v120, v13, v120
    v_mul_f32 v121, v13, v121
    v_mul_f32 v122, v13, v122
    v_mul_f32 v123, v13, v123
    v_mul_f32 v124, v15, v124
    v_mul_f32 v125, v15, v125
    v_mul_f32 v126, v15, v126
    v_mul_f32 v127, v15, v127
    v_cvt_pk_bf16_f32 v112, v112, v113
    v_cvt_pk_bf16_f32 v113, v114, v115
    v_cvt_pk_bf16_f32 v114, v116, v117
    v_cvt_pk_bf16_f32 v115, v118, v119
    v_cvt_pk_bf16_f32 v116, v120, v121
    v_cvt_pk_bf16_f32 v117, v122, v123
    v_cvt_pk_bf16_f32 v118, v124, v125
    v_cvt_pk_bf16_f32 v119, v126, v127
    v_permlane32_swap_b32 v112, v114
    v_permlane32_swap_b32 v113, v115
    v_permlane32_swap_b32 v116, v118
    v_permlane32_swap_b32 v117, v119
    s_add_u32 s52, s74, 2097152
    s_add_u32 s53, s74, 2162688
    buffer_store_dwordx4 v[112:115], v5, s[16:19], s52 offen sc1
    buffer_store_dwordx4 v[116:119], v5, s[16:19], s53 offen sc1
    v_mul_f32 v96, v44, v96
    v_mul_f32 v97, v44, v97
    v_mul_f32 v98, v44, v98
    v_mul_f32 v99, v44, v99
    v_mul_f32 v100, v45, v100
    v_mul_f32 v101, v45, v101
    v_mul_f32 v102, v45, v102
    v_mul_f32 v103, v45, v103
    v_mul_f32 v104, v44, v104
    v_mul_f32 v105, v44, v105
    v_mul_f32 v106, v44, v106
    v_mul_f32 v107, v44, v107
    v_mul_f32 v108, v45, v108
    v_mul_f32 v109, v45, v109
    v_mul_f32 v110, v45, v110
    v_mul_f32 v111, v45, v111
    v_cvt_pk_bf16_f32 v96, v96, v97
    v_cvt_pk_bf16_f32 v97, v98, v99
    v_cvt_pk_bf16_f32 v98, v100, v101
    v_cvt_pk_bf16_f32 v99, v102, v103
    v_cvt_pk_bf16_f32 v100, v104, v105
    v_cvt_pk_bf16_f32 v101, v106, v107
    v_cvt_pk_bf16_f32 v102, v108, v109
    v_cvt_pk_bf16_f32 v103, v110, v111
    v_permlane32_swap_b32 v96, v98
    v_permlane32_swap_b32 v97, v99
    v_permlane32_swap_b32 v100, v102
    v_permlane32_swap_b32 v101, v103
    s_setprio 1
    s_waitcnt lgkmcnt(4)
    v_mfma_f32_16x16x32_bf16 v[48:51], v[16:19], v[128:131], 0
    ds_read_b64_tr_b16 v[28:29], v9 offset:8192
    v_mfma_f32_16x16x32_bf16 v[52:55], v[16:19], v[132:135], 0
    ds_read_b64_tr_b16 v[30:31], v9 offset:8704
    s_waitcnt lgkmcnt(4)
    v_mfma_f32_16x16x32_bf16 v[64:67], v[20:23], v[128:131], 0
    ds_read_b64_tr_b16 v[32:33], v10 offset:8192
    v_mfma_f32_16x16x32_bf16 v[68:71], v[20:23], v[132:135], 0
    ds_read_b64_tr_b16 v[34:35], v10 offset:8704
    s_waitcnt lgkmcnt(4)
    v_mfma_f32_16x16x32_bf16 v[80:83], v[24:27], v[128:131], 0
    ds_read_b64_tr_b16 v[36:37], v11 offset:8192
    v_mfma_f32_16x16x32_bf16 v[84:87], v[24:27], v[132:135], 0
    ds_read_b64_tr_b16 v[38:39], v11 offset:8704
    s_waitcnt lgkmcnt(4)
    v_mfma_f32_16x16x32_bf16 v[56:59], v[28:31], v[128:131], 0
    ds_read_b64_tr_b16 v[16:17], v9 offset:4096
    v_mfma_f32_16x16x32_bf16 v[60:63], v[28:31], v[132:135], 0
    ds_read_b64_tr_b16 v[18:19], v9 offset:4608
    s_waitcnt lgkmcnt(4)
    v_mfma_f32_16x16x32_bf16 v[72:75], v[32:35], v[128:131], 0
    ds_read_b64_tr_b16 v[20:21], v10 offset:4096
    v_mfma_f32_16x16x32_bf16 v[76:79], v[32:35], v[132:135], 0
    ds_read_b64_tr_b16 v[22:23], v10 offset:4608
    s_waitcnt lgkmcnt(4)
    v_mfma_f32_16x16x32_bf16 v[88:91], v[36:39], v[128:131], 0
    ds_read_b64_tr_b16 v[24:25], v11 offset:4096
    v_mfma_f32_16x16x32_bf16 v[92:95], v[36:39], v[132:135], 0
    ds_read_b64_tr_b16 v[26:27], v11 offset:4608
    s_waitcnt lgkmcnt(4)
    v_mfma_f32_16x16x32_bf16 v[48:51], v[16:19], v[136:139], v[48:51]
    ds_read_b64_tr_b16 v[28:29], v9 offset:12288
    v_mfma_f32_16x16x32_bf16 v[52:55], v[16:19], v[140:143], v[52:55]
    ds_read_b64_tr_b16 v[30:31], v9 offset:12800
    s_waitcnt lgkmcnt(4)
    v_mfma_f32_16x16x32_bf16 v[64:67], v[20:23], v[136:139], v[64:67]
    ds_read_b64_tr_b16 v[32:33], v10 offset:12288
    v_mfma_f32_16x16x32_bf16 v[68:71], v[20:23], v[140:143], v[68:71]
    ds_read_b64_tr_b16 v[34:35], v10 offset:12800
    s_waitcnt lgkmcnt(4)
    v_mfma_f32_16x16x32_bf16 v[80:83], v[24:27], v[136:139], v[80:83]
    ds_read_b64_tr_b16 v[36:37], v11 offset:12288
    v_mfma_f32_16x16x32_bf16 v[84:87], v[24:27], v[140:143], v[84:87]
    ds_read_b64_tr_b16 v[38:39], v11 offset:12800
    s_setprio 0
    s_add_u32 s52, s74, 0
    s_add_u32 s53, s74, 65536
    buffer_store_dwordx4 v[96:99], v46, s[16:19], s52 offen sc1
    buffer_store_dwordx4 v[100:103], v46, s[16:19], s53 offen sc1
    s_setprio 1
    s_waitcnt vmcnt(8)
    s_barrier
    s_waitcnt lgkmcnt(4)
    v_mfma_f32_16x16x32_bf16 v[56:59], v[28:31], v[136:139], v[56:59]
    ds_read_b64_tr_b16 v[16:17], v9 offset:32768
    v_mfma_f32_16x16x32_bf16 v[60:63], v[28:31], v[140:143], v[60:63]
    ds_read_b64_tr_b16 v[18:19], v9 offset:33280
    s_waitcnt lgkmcnt(4)
    v_mfma_f32_16x16x32_bf16 v[72:75], v[32:35], v[136:139], v[72:75]
    ds_read_b64_tr_b16 v[20:21], v10 offset:32768
    v_mfma_f32_16x16x32_bf16 v[76:79], v[32:35], v[140:143], v[76:79]
    ds_read_b64_tr_b16 v[22:23], v10 offset:33280
    s_waitcnt lgkmcnt(4)
    v_mfma_f32_16x16x32_bf16 v[88:91], v[36:39], v[136:139], v[88:91]
    ds_read_b64_tr_b16 v[24:25], v11 offset:32768
    v_mfma_f32_16x16x32_bf16 v[92:95], v[36:39], v[140:143], v[92:95]
    ds_read_b64_tr_b16 v[26:27], v11 offset:33280
    s_waitcnt lgkmcnt(4)
    v_mfma_f32_16x16x32_bf16 v[48:51], v[16:19], v[144:147], v[48:51]
    ds_read_b64_tr_b16 v[28:29], v9 offset:40960
    v_mfma_f32_16x16x32_bf16 v[52:55], v[16:19], v[148:151], v[52:55]
    ds_read_b64_tr_b16 v[30:31], v9 offset:41472
    s_waitcnt lgkmcnt(4)
    v_mfma_f32_16x16x32_bf16 v[64:67], v[20:23], v[144:147], v[64:67]
    ds_read_b64_tr_b16 v[32:33], v10 offset:40960
    v_mfma_f32_16x16x32_bf16 v[68:71], v[20:23], v[148:151], v[68:71]
    ds_read_b64_tr_b16 v[34:35], v10 offset:41472
    s_waitcnt lgkmcnt(4)
    v_mfma_f32_16x16x32_bf16 v[80:83], v[24:27], v[144:147], v[80:83]
    ds_read_b64_tr_b16 v[36:37], v11 offset:40960
    v_mfma_f32_16x16x32_bf16 v[84:87], v[24:27], v[148:151], v[84:87]
    ds_read_b64_tr_b16 v[38:39], v11 offset:41472
    s_waitcnt lgkmcnt(4)
    v_mfma_f32_16x16x32_bf16 v[56:59], v[28:31], v[144:147], v[56:59]
    ds_read_b64_tr_b16 v[16:17], v9 offset:36864
    v_mfma_f32_16x16x32_bf16 v[60:63], v[28:31], v[148:151], v[60:63]
    ds_read_b64_tr_b16 v[18:19], v9 offset:37376
    s_waitcnt lgkmcnt(4)
    v_mfma_f32_16x16x32_bf16 v[72:75], v[32:35], v[144:147], v[72:75]
    ds_read_b64_tr_b16 v[20:21], v10 offset:36864
    v_mfma_f32_16x16x32_bf16 v[76:79], v[32:35], v[148:151], v[76:79]
    ds_read_b64_tr_b16 v[22:23], v10 offset:37376
    s_waitcnt lgkmcnt(4)
    v_mfma_f32_16x16x32_bf16 v[88:91], v[36:39], v[144:147], v[88:91]
    ds_read_b64_tr_b16 v[24:25], v11 offset:36864
    v_mfma_f32_16x16x32_bf16 v[92:95], v[36:39], v[148:151], v[92:95]
    ds_read_b64_tr_b16 v[26:27], v11 offset:37376
    s_waitcnt lgkmcnt(4)
    v_mfma_f32_16x16x32_bf16 v[48:51], v[16:19], v[152:155], v[48:51]
    ds_read_b64_tr_b16 v[28:29], v9 offset:45056
    v_mfma_f32_16x16x32_bf16 v[52:55], v[16:19], v[156:159], v[52:55]
    ds_read_b64_tr_b16 v[30:31], v9 offset:45568
    s_waitcnt lgkmcnt(4)
    v_mfma_f32_16x16x32_bf16 v[64:67], v[20:23], v[152:155], v[64:67]
    ds_read_b64_tr_b16 v[32:33], v10 offset:45056
    v_mfma_f32_16x16x32_bf16 v[68:71], v[20:23], v[156:159], v[68:71]
    ds_read_b64_tr_b16 v[34:35], v10 offset:45568
    s_waitcnt lgkmcnt(4)
    v_mfma_f32_16x16x32_bf16 v[80:83], v[24:27], v[152:155], v[80:83]
    ds_read_b64_tr_b16 v[36:37], v11 offset:45056
    v_mfma_f32_16x16x32_bf16 v[84:87], v[24:27], v[156:159], v[84:87]
    ds_read_b64_tr_b16 v[38:39], v11 offset:45568
    s_setprio 0
    s_add_u32 m0, s59, 98304
    s_add_u32 s58, s58, 229376
    buffer_load_dwordx4 v8, s[20:23], s58 offen offset:0 lds
    s_add_u32 m0, s59, 106496
    s_nop 0
    buffer_load_dwordx4 v8, s[24:27], s58 offen offset:0 lds
    s_add_u32 m0, s59, 114560
    s_nop 0
    buffer_load_dwordx4 v8, s[20:23], s58 offen offset:128 lds
    s_add_u32 m0, s59, 122752
    s_nop 0
    buffer_load_dwordx4 v8, s[24:27], s58 offen offset:128 lds
    s_cmp_lg_u32 s32, 2
    s_cbranch_scc1 L_ncsGR
    v_mov_b32 v40, 0
    v_mov_b32 v44, 0
    v_mov_b32 v41, 0
    v_mov_b32 v45, 0
    v_mov_b32 v42, 0
    v_mov_b32 v4, 0
    v_add_u32 v3, s60, v9
    ds_read_b64_tr_b16 v[128:129], v3 offset:0
    ds_read_b64_tr_b16 v[130:131], v3 offset:512
    ds_read_b64_tr_b16 v[132:133], v3 offset:8192
    ds_read_b64_tr_b16 v[134:135], v3 offset:8704
    v_add_u32 v3, s60, v10
    ds_read_b64_tr_b16 v[120:121], v3 offset:0
    ds_read_b64_tr_b16 v[122:123], v3 offset:512
    ds_read_b64_tr_b16 v[124:125], v3 offset:8192
    ds_read_b64_tr_b16 v[126:127], v3 offset:8704
    s_waitcnt lgkmcnt(0)
    v_dot2c_f32_bf16 v40, s71, v128
    v_dot2c_f32_bf16 v40, s71, v129
    v_dot2c_f32_bf16 v40, s71, v130
    v_dot2c_f32_bf16 v40, s71, v131
    v_dot2c_f32_bf16 v44, s71, v132
    v_dot2c_f32_bf16 v44, s71, v133
    v_dot2c_f32_bf16 v44, s71, v134
    v_dot2c_f32_bf16 v44, s71, v135
    v_dot2c_f32_bf16 v41, s71, v120
    v_dot2c_f32_bf16 v41, s71, v121
    v_dot2c_f32_bf16 v41, s71, v122
    v_dot2c_f32_bf16 v41, s71, v123
    v_dot2c_f32_bf16 v45, s71, v124
    v_dot2c_f32_bf16 v45, s71, v125
    v_dot2c_f32_bf16 v45, s71, v126
    v_dot2c_f32_bf16 v45, s71, v127
    v_add_u32 v3, s60, v11
    ds_read_b64_tr_b16 v[128:129], v3 offset:0
    ds_read_b64_tr_b16 v[130:131], v3 offset:512
    ds_read_b64_tr_b16 v[132:133], v3 offset:8192
    ds_read_b64_tr_b16 v[134:135], v3 offset:8704
    s_waitcnt lgkmcnt(0)
    v_dot2c_f32_bf16 v42, s71, v128
    v_dot2c_f32_bf16 v42, s71, v129
    v_dot2c_f32_bf16 v42, s71, v130
    v_dot2c_f32_bf16 v42, s71, v131
    v_dot2c_f32_bf16 v4, s71, v132
    v_dot2c_f32_bf16 v4, s71, v133
    v_dot2c_f32_bf16 v4, s71, v134
    v_dot2c_f32_bf16 v4, s71, v135
    s_nop 2
    v_permlane32_swap_b32 v40, v44
    v_permlane32_swap_b32 v41, v45
    v_permlane32_swap_b32 v42, v4
    s_nop 0
    v_add_f32 v40, v40, v44
    v_add_f32 v41, v41, v45
    v_add_f32 v42, v42, v4
    v_mov_b32 v44, v40
    v_mov_b32 v45, v41
    v_mov_b32 v4, v42
    s_nop 1
    v_permlane16_swap_b32 v40, v44
    v_permlane16_swap_b32 v41, v45
    v_permlane16_swap_b32 v42, v4
    s_nop 0
    v_add_f32 v40, v40, v44
    v_add_f32 v41, v41, v45
    v_add_f32 v42, v42, v4
L_ncsGR:
    s_mov_b32 exec_lo, 0xffff
    s_mov_b32 exec_hi, 0xffff
    buffer_store_dwordx4 v[40:43], v46, s[16:19], s1 offen sc1
    s_mov_b64 exec, -1
    s_nop 0
    s_setprio 1
    v_add_u32 v9, 0x10000, v9
    v_add_u32 v10, 0x10000, v10
    v_add_u32 v11, 0x10000, v11
    s_waitcnt vmcnt(9)
    s_waitcnt vmcnt(5)
    s_barrier
    s_waitcnt lgkmcnt(4)
    v_mfma_f32_16x16x32_bf16 v[56:59], v[28:31], v[152:155], v[56:59]
    ds_read_b64_tr_b16 v[16:17], v9 offset:0
    v_mfma_f32_16x16x32_bf16 v[60:63], v[28:31], v[156:159], v[60:63]
    ds_read_b64_tr_b16 v[18:19], v9 offset:512
    s_waitcnt lgkmcnt(4)
    v_mfma_f32_16x16x32_bf16 v[72:75], v[32:35], v[152:155], v[72:75]
    ds_read_b64_tr_b16 v[20:21], v10 offset:0
    v_mfma_f32_16x16x32_bf16 v[76:79], v[32:35], v[156:159], v[76:79]
    ds_read_b64_tr_b16 v[22:23], v10 offset:512
    s_waitcnt lgkmcnt(4)
    v_mfma_f32_16x16x32_bf16 v[88:91], v[36:39], v[152:155], v[88:91]
    ds_read_b64_tr_b16 v[24:25], v11 offset:0
    v_mfma_f32_16x16x32_bf16 v[92:95], v[36:39], v[156:159], v[92:95]
    ds_read_b64_tr_b16 v[26:27], v11 offset:512
    s_waitcnt lgkmcnt(4)
    v_mfma_f32_16x16x32_bf16 v[48:51], v[16:19], v[160:163], v[48:51]
    ds_read_b64_tr_b16 v[28:29], v9 offset:8192
    v_mfma_f32_16x16x32_bf16 v[52:55], v[16:19], v[164:167], v[52:55]
    ds_read_b64_tr_b16 v[30:31], v9 offset:8704
    s_waitcnt lgkmcnt(4)
    v_mfma_f32_16x16x32_bf16 v[64:67], v[20:23], v[160:163], v[64:67]
    ds_read_b64_tr_b16 v[32:33], v10 offset:8192
    v_mfma_f32_16x16x32_bf16 v[68:71], v[20:23], v[164:167], v[68:71]
    ds_read_b64_tr_b16 v[34:35], v10 offset:8704
    s_waitcnt lgkmcnt(4)
    v_mfma_f32_16x16x32_bf16 v[80:83], v[24:27], v[160:163], v[80:83]
    ds_read_b64_tr_b16 v[36:37], v11 offset:8192
    v_mfma_f32_16x16x32_bf16 v[84:87], v[24:27], v[164:167], v[84:87]
    ds_read_b64_tr_b16 v[38:39], v11 offset:8704
    s_waitcnt lgkmcnt(4)
    v_mfma_f32_16x16x32_bf16 v[56:59], v[28:31], v[160:163], v[56:59]
    ds_read_b64_tr_b16 v[16:17], v9 offset:4096
    v_mfma_f32_16x16x32_bf16 v[60:63], v[28:31], v[164:167], v[60:63]
    ds_read_b64_tr_b16 v[18:19], v9 offset:4608
    s_waitcnt lgkmcnt(4)
    v_mfma_f32_16x16x32_bf16 v[72:75], v[32:35], v[160:163], v[72:75]
    ds_read_b64_tr_b16 v[20:21], v10 offset:4096
    v_mfma_f32_16x16x32_bf16 v[76:79], v[32:35], v[164:167], v[76:79]
    ds_read_b64_tr_b16 v[22:23], v10 offset:4608
    s_waitcnt lgkmcnt(4)
    v_mfma_f32_16x16x32_bf16 v[88:91], v[36:39], v[160:163], v[88:91]
    ds_read_b64_tr_b16 v[24:25], v11 offset:4096
    v_mfma_f32_16x16x32_bf16 v[92:95], v[36:39], v[164:167], v[92:95]
    ds_read_b64_tr_b16 v[26:27], v11 offset:4608
    s_waitcnt lgkmcnt(4)
    v_mfma_f32_16x16x32_bf16 v[48:51], v[16:19], v[168:171], v[48:51]
    ds_read_b64_tr_b16 v[28:29], v9 offset:12288
    v_mfma_f32_16x16x32_bf16 v[52:55], v[16:19], v[172:175], v[52:55]
    ds_read_b64_tr_b16 v[30:31], v9 offset:12800
    s_waitcnt lgkmcnt(4)
    v_mfma_f32_16x16x32_bf16 v[64:67], v[20:23], v[168:171], v[64:67]
    ds_read_b64_tr_b16 v[32:33], v10 offset:12288
    v_mfma_f32_16x16x32_bf16 v[68:71], v[20:23], v[172:175], v[68:71]
    ds_read_b64_tr_b16 v[34:35], v10 offset:12800
    s_waitcnt lgkmcnt(4)
    v_mfma_f32_16x16x32_bf16 v[80:83], v[24:27], v[168:171], v[80:83]
    ds_read_b64_tr_b16 v[36:37], v11 offset:12288
    v_mfma_f32_16x16x32_bf16 v[84:87], v[24:27], v[172:175], v[84:87]
    ds_read_b64_tr_b16 v[38:39], v11 offset:12800
    s_setprio 0
    s_add_u32 m0, s59, 0
    s_add_u32 s58, s58, 229376
    s_cmp_eq_u32 s33, 4
    s_cselect_b32 s52, 1835008, 0
    s_sub_u32 s58, s58, s52
    buffer_load_dwordx4 v8, s[20:23], s58 offen offset:0 lds
    s_add_u32 m0, s59, 8192
    s_nop 0
    buffer_load_dwordx4 v8, s[24:27], s58 offen offset:0 lds
    s_add_u32 m0, s59, 16256
    s_nop 0
    buffer_load_dwordx4 v8, s[20:23], s58 offen offset:128 lds
    s_add_u32 m0, s59, 24448
    s_nop 0
    buffer_load_dwordx4 v8, s[24:27], s58 offen offset:128 lds
    v_lshrrev_b32 v5, 2, v1
    v_and_b32 v5, 64, v5
    v_lshrrev_b32 v3, 4, v1
    v_and_b32 v3, 32, v3
    v_xor_b32 v5, v5, v3
    v_and_b32 v3, 0x70, v1
    v_xor_b32 v5, v5, v3
    v_and_b32 v3, 0x380, v1
    v_lshl_add_u32 v6, v3, 3, v5
    v_and_b32 v3, 0x1c0, v1
    v_lshlrev_b32 v3, 1, v3
    v_and_b32 v5, 0x200, v1
    v_lshl_add_u32 v3, v5, 2, v3
    v_bfe_u32 v5, v1, 8, 1
    v_lshl_add_u32 v3, v5, 5, v3
    v_and_b32 v5, 0xb0, v1
    v_lshrrev_b32 v5, 1, v5
    v_add_u32 v7, v3, v5
    s_setprio 1
    s_waitcnt vmcnt(5)
    s_waitcnt vmcnt(4)
    s_barrier
    s_waitcnt lgkmcnt(4)
    v_mfma_f32_16x16x32_bf16 v[56:59], v[28:31], v[168:171], v[56:59]
    ds_read_b64_tr_b16 v[16:17], v9 offset:32768
    v_mfma_f32_16x16x32_bf16 v[60:63], v[28:31], v[172:175], v[60:63]
    ds_read_b64_tr_b16 v[18:19], v9 offset:33280
    s_waitcnt lgkmcnt(4)
    v_mfma_f32_16x16x32_bf16 v[72:75], v[32:35], v[168:171], v[72:75]
    ds_read_b64_tr_b16 v[20:21], v10 offset:32768
    v_mfma_f32_16x16x32_bf16 v[76:79], v[32:35], v[172:175], v[76:79]
    ds_read_b64_tr_b16 v[22:23], v10 offset:33280
    s_waitcnt lgkmcnt(4)
    v_mfma_f32_16x16x32_bf16 v[88:91], v[36:39], v[168:171], v[88:91]
    ds_read_b64_tr_b16 v[24:25], v11 offset:32768
    v_mfma_f32_16x16x32_bf16 v[92:95], v[36:39], v[172:175], v[92:95]
    ds_read_b64_tr_b16 v[26:27], v11 offset:33280
    s_waitcnt lgkmcnt(4)
    v_mfma_f32_16x16x32_bf16 v[48:51], v[16:19], v[176:179], v[48:51]
    ds_read_b64_tr_b16 v[28:29], v9 offset:40960
    v_mfma_f32_16x16x32_bf16 v[52:55], v[16:19], v[180:183], v[52:55]
    ds_read_b64_tr_b16 v[30:31], v9 offset:41472
    s_waitcnt lgkmcnt(4)
    v_mfma_f32_16x16x32_bf16 v[64:67], v[20:23], v[176:179], v[64:67]
    ds_read_b64_tr_b16 v[32:33], v10 offset:40960
    v_mfma_f32_16x16x32_bf16 v[68:71], v[20:23], v[180:183], v[68:71]
    ds_read_b64_tr_b16 v[34:35], v10 offset:41472
    s_waitcnt lgkmcnt(4)
    v_mfma_f32_16x16x32_bf16 v[80:83], v[24:27], v[176:179], v[80:83]
    ds_read_b64_tr_b16 v[36:37], v11 offset:40960
    v_mfma_f32_16x16x32_bf16 v[84:87], v[24:27], v[180:183], v[84:87]
    ds_read_b64_tr_b16 v[38:39], v11 offset:41472
    s_waitcnt lgkmcnt(4)
    v_mfma_f32_16x16x32_bf16 v[56:59], v[28:31], v[176:179], v[56:59]
    ds_read_b64_tr_b16 v[16:17], v9 offset:36864
    v_mfma_f32_16x16x32_bf16 v[60:63], v[28:31], v[180:183], v[60:63]
    ds_read_b64_tr_b16 v[18:19], v9 offset:37376
    s_waitcnt lgkmcnt(4)
    v_mfma_f32_16x16x32_bf16 v[72:75], v[32:35], v[176:179], v[72:75]
    ds_read_b64_tr_b16 v[20:21], v10 offset:36864
    v_mfma_f32_16x16x32_bf16 v[76:79], v[32:35], v[180:183], v[76:79]
    ds_read_b64_tr_b16 v[22:23], v10 offset:37376
    s_waitcnt lgkmcnt(4)
    v_mfma_f32_16x16x32_bf16 v[88:91], v[36:39], v[176:179], v[88:91]
    ds_read_b64_tr_b16 v[24:25], v11 offset:36864
    v_mfma_f32_16x16x32_bf16 v[92:95], v[36:39], v[180:183], v[92:95]
    ds_read_b64_tr_b16 v[26:27], v11 offset:37376
    s_waitcnt lgkmcnt(4)
    v_mfma_f32_16x16x32_bf16 v[48:51], v[16:19], v[184:187], v[48:51]
    ds_read_b64_tr_b16 v[28:29], v9 offset:45056
    v_mfma_f32_16x16x32_bf16 v[52:55], v[16:19], v[188:191], v[52:55]
    ds_read_b64_tr_b16 v[30:31], v9 offset:45568
    s_waitcnt lgkmcnt(4)
    v_mfma_f32_16x16x32_bf16 v[64:67], v[20:23], v[184:187], v[64:67]
    ds_read_b64_tr_b16 v[32:33], v10 offset:45056
    v_mfma_f32_16x16x32_bf16 v[68:71], v[20:23], v[188:191], v[68:71]
    ds_read_b64_tr_b16 v[34:35], v10 offset:45568
    s_waitcnt lgkmcnt(4)
    v_mfma_f32_16x16x32_bf16 v[80:83], v[24:27], v[184:187], v[80:83]
    ds_read_b64_tr_b16 v[36:37], v11 offset:45056
    v_mfma_f32_16x16x32_bf16 v[84:87], v[24:27], v[188:191], v[84:87]
    ds_read_b64_tr_b16 v[38:39], v11 offset:45568
    s_setprio 0
    s_add_u32 m0, s59, 32768
    s_add_u32 s58, s58, 229376
    buffer_load_dwordx4 v8, s[20:23], s58 offen offset:0 lds
    s_add_u32 m0, s59, 40960
    s_nop 0
    buffer_load_dwordx4 v8, s[24:27], s58 offen offset:0 lds
    s_add_u32 m0, s59, 49024
    s_nop 0
    buffer_load_dwordx4 v8, s[20:23], s58 offen offset:128 lds
    s_add_u32 m0, s59, 57216
    s_nop 0
    buffer_load_dwordx4 v8, s[24:27], s58 offen offset:128 lds
    v_lshlrev_b32 v44, 2, v1
    s_cmp_eq_u32 s32, 3
    s_cbranch_scc1 L_tchOGR
    s_mul_i32 s52, s2, 3
    s_add_u32 s52, s52, s32
    s_mul_i32 s52, s52, 2432
    s_mov_b32 exec_hi, 0x3f
    buffer_load_dword v128, v44, s[28:31], s52 offen
    s_branch L_tchXGR
L_tchOGR:
    s_lshl_b32 s52, s2, 11
    s_mov_b32 exec_hi, 0
    buffer_load_dword v128, v44, s[36:39], s52 offen
L_tchXGR:
    s_mov_b32 exec_hi, -1
    s_setprio 1
    v_add_u32 v9, 0xffff0000, v9
    v_add_u32 v10, 0xffff0000, v10
    v_add_u32 v11, 0xffff0000, v11
    s_waitcnt vmcnt(5)
    s_barrier
    s_waitcnt lgkmcnt(4)
    v_mfma_f32_16x16x32_bf16 v[56:59], v[28:31], v[184:187], v[56:59]
    ds_read_b64_tr_b16 v[16:17], v9 offset:0
    v_mfma_f32_16x16x32_bf16 v[60:63], v[28:31], v[188:191], v[60:63]
    ds_read_b64_tr_b16 v[18:19], v9 offset:512
    s_waitcnt lgkmcnt(4)
    v_mfma_f32_16x16x32_bf16 v[72:75], v[32:35], v[184:187], v[72:75]
    ds_read_b64_tr_b16 v[20:21], v10 offset:0
    v_mfma_f32_16x16x32_bf16 v[76:79], v[32:35], v[188:191], v[76:79]
    ds_read_b64_tr_b16 v[22:23], v10 offset:512
    s_waitcnt lgkmcnt(4)
    v_mfma_f32_16x16x32_bf16 v[88:91], v[36:39], v[184:187], v[88:91]
    ds_read_b64_tr_b16 v[24:25], v11 offset:0
    v_mfma_f32_16x16x32_bf16 v[92:95], v[36:39], v[188:191], v[92:95]
    ds_read_b64_tr_b16 v[26:27], v11 offset:512
    s_waitcnt lgkmcnt(4)
    v_mfma_f32_16x16x32_bf16 v[48:51], v[16:19], v[192:195], v[48:51]
    ds_read_b64_tr_b16 v[28:29], v9 offset:8192
    v_mfma_f32_16x16x32_bf16 v[52:55], v[16:19], v[196:199], v[52:55]
    ds_read_b64_tr_b16 v[30:31], v9 offset:8704
    s_waitcnt lgkmcnt(4)
    v_mfma_f32_16x16x32_bf16 v[64:67], v[20:23], v[192:195], v[64:67]
    ds_read_b64_tr_b16 v[32:33], v10 offset:8192
    v_mfma_f32_16x16x32_bf16 v[68:71], v[20:23], v[196:199], v[68:71]
    ds_read_b64_tr_b16 v[34:35], v10 offset:8704
    s_waitcnt lgkmcnt(4)
    v_mfma_f32_16x16x32_bf16 v[80:83], v[24:27], v[192:195], v[80:83]
    ds_read_b64_tr_b16 v[36:37], v11 offset:8192
    v_mfma_f32_16x16x32_bf16 v[84:87], v[24:27], v[196:199], v[84:87]
    ds_read_b64_tr_b16 v[38:39], v11 offset:8704
    s_waitcnt lgkmcnt(4)
    v_mfma_f32_16x16x32_bf16 v[56:59], v[28:31], v[192:195], v[56:59]
    ds_read_b64_tr_b16 v[16:17], v9 offset:4096
    v_mfma_f32_16x16x32_bf16 v[60:63], v[28:31], v[196:199], v[60:63]
    ds_read_b64_tr_b16 v[18:19], v9 offset:4608
    s_waitcnt lgkmcnt(4)
    v_mfma_f32_16x16x32_bf16 v[72:75], v[32:35], v[192:195], v[72:75]
    ds_read_b64_tr_b16 v[20:21], v10 offset:4096
    v_mfma_f32_16x16x32_bf16 v[76:79], v[32:35], v[196:199], v[76:79]
    ds_read_b64_tr_b16 v[22:23], v10 offset:4608
    s_waitcnt lgkmcnt(4)
    v_mfma_f32_16x16x32_bf16 v[88:91], v[36:39], v[192:195], v[88:91]
    ds_read_b64_tr_b16 v[24:25], v11 offset:4096
    v_mfma_f32_16x16x32_bf16 v[92:95], v[36:39], v[196:199], v[92:95]
    ds_read_b64_tr_b16 v[26:27], v11 offset:4608
    s_waitcnt lgkmcnt(4)
    v_mfma_f32_16x16x32_bf16 v[48:51], v[16:19], v[200:203], v[48:51]
    ds_read_b64_tr_b16 v[28:29], v9 offset:12288
    v_mfma_f32_16x16x32_bf16 v[52:55], v[16:19], v[204:207], v[52:55]
    ds_read_b64_tr_b16 v[30:31], v9 offset:12800
    s_waitcnt lgkmcnt(4)
    v_mfma_f32_16x16x32_bf16 v[64:67], v[20:23], v[200:203], v[64:67]
    ds_read_b64_tr_b16 v[32:33], v10 offset:12288
    v_mfma_f32_16x16x32_bf16 v[68:71], v[20:23], v[204:207], v[68:71]
    ds_read_b64_tr_b16 v[34:35], v10 offset:12800
    s_waitcnt lgkmcnt(4)
    v_mfma_f32_16x16x32_bf16 v[80:83], v[24:27], v[200:203], v[80:83]
    ds_read_b64_tr_b16 v[36:37], v11 offset:12288
    v_mfma_f32_16x16x32_bf16 v[84:87], v[24:27], v[204:207], v[84:87]
    ds_read_b64_tr_b16 v[38:39], v11 offset:12800
    s_setprio 0
    s_add_u32 m0, s59, 65536
    s_add_u32 s58, s58, 229376
    s_cmp_eq_u32 s33, 2
    s_cselect_b32 s52, 1835008, 0
    s_sub_u32 s58, s58, s52
    buffer_load_dwordx4 v8, s[20:23], s58 offen offset:0 lds
    s_add_u32 m0, s59, 73728
    s_nop 0
    buffer_load_dwordx4 v8, s[24:27], s58 offen offset:0 lds
    s_add_u32 m0, s59, 81792
    s_nop 0
    buffer_load_dwordx4 v8, s[20:23], s58 offen offset:128 lds
    s_add_u32 m0, s59, 89984
    s_nop 0
    buffer_load_dwordx4 v8, s[24:27], s58 offen offset:128 lds
    s_setprio 1
    s_waitcnt vmcnt(5)
    s_barrier
    s_waitcnt lgkmcnt(4)
    v_mfma_f32_16x16x32_bf16 v[56:59], v[28:31], v[200:203], v[56:59]
    ds_read_b64_tr_b16 v[16:17], v9 offset:32768
    v_mfma_f32_16x16x32_bf16 v[60:63], v[28:31], v[204:207], v[60:63]
    ds_read_b64_tr_b16 v[18:19], v9 offset:33280
    s_waitcnt lgkmcnt(4)
    v_mfma_f32_16x16x32_bf16 v[72:75], v[32:35], v[200:203], v[72:75]
    ds_read_b64_tr_b16 v[20:21], v10 offset:32768
    v_mfma_f32_16x16x32_bf16 v[76:79], v[32:35], v[204:207], v[76:79]
    ds_read_b64_tr_b16 v[22:23], v10 offset:33280
    s_waitcnt lgkmcnt(4)
    v_mfma_f32_16x16x32_bf16 v[88:91], v[36:39], v[200:203], v[88:91]
    ds_read_b64_tr_b16 v[24:25], v11 offset:32768
    v_mfma_f32_16x16x32_bf16 v[92:95], v[36:39], v[204:207], v[92:95]
    ds_read_b64_tr_b16 v[26:27], v11 offset:33280
    s_waitcnt lgkmcnt(4)
    v_mfma_f32_16x16x32_bf16 v[48:51], v[16:19], v[208:211], v[48:51]
    ds_read_b64_tr_b16 v[28:29], v9 offset:40960
    v_mfma_f32_16x16x32_bf16 v[52:55], v[16:19], v[212:215], v[52:55]
    ds_read_b64_tr_b16 v[30:31], v9 offset:41472
    s_waitcnt lgkmcnt(4)
    v_mfma_f32_16x16x32_bf16 v[64:67], v[20:23], v[208:211], v[64:67]
    ds_read_b64_tr_b16 v[32:33], v10 offset:40960
    v_mfma_f32_16x16x32_bf16 v[68:71], v[20:23], v[212:215], v[68:71]
    ds_read_b64_tr_b16 v[34:35], v10 offset:41472
    s_waitcnt lgkmcnt(4)
    v_mfma_f32_16x16x32_bf16 v[80:83], v[24:27], v[208:211], v[80:83]
    ds_read_b64_tr_b16 v[36:37], v11 offset:40960
    v_mfma_f32_16x16x32_bf16 v[84:87], v[24:27], v[212:215], v[84:87]
    ds_read_b64_tr_b16 v[38:39], v11 offset:41472
    s_waitcnt lgkmcnt(4)
    v_mfma_f32_16x16x32_bf16 v[56:59], v[28:31], v[208:211], v[56:59]
    ds_read_b64_tr_b16 v[16:17], v9 offset:36864
    v_mfma_f32_16x16x32_bf16 v[60:63], v[28:31], v[212:215], v[60:63]
    ds_read_b64_tr_b16 v[18:19], v9 offset:37376
    s_waitcnt lgkmcnt(4)
    v_mfma_f32_16x16x32_bf16 v[72:75], v[32:35], v[208:211], v[72:75]
    ds_read_b64_tr_b16 v[20:21], v10 offset:36864
    v_mfma_f32_16x16x32_bf16 v[76:79], v[32:35], v[212:215], v[76:79]
    ds_read_b64_tr_b16 v[22:23], v10 offset:37376
    s_waitcnt lgkmcnt(4)
    v_mfma_f32_16x16x32_bf16 v[88:91], v[36:39], v[208:211], v[88:91]
    ds_read_b64_tr_b16 v[24:25], v11 offset:36864
    v_mfma_f32_16x16x32_bf16 v[92:95], v[36:39], v[212:215], v[92:95]
    ds_read_b64_tr_b16 v[26:27], v11 offset:37376
    s_waitcnt lgkmcnt(4)
    v_mfma_f32_16x16x32_bf16 v[48:51], v[16:19], v[216:219], v[48:51]
    ds_read_b64_tr_b16 v[28:29], v9 offset:45056
    v_mfma_f32_16x16x32_bf16 v[52:55], v[16:19], v[220:223], v[52:55]
    ds_read_b64_tr_b16 v[30:31], v9 offset:45568
    s_waitcnt lgkmcnt(4)
    v_mfma_f32_16x16x32_bf16 v[64:67], v[20:23], v[216:219], v[64:67]
    ds_read_b64_tr_b16 v[32:33], v10 offset:45056
    v_mfma_f32_16x16x32_bf16 v[68:71], v[20:23], v[220:223], v[68:71]
    ds_read_b64_tr_b16 v[34:35], v10 offset:45568
    s_waitcnt lgkmcnt(4)
    v_mfma_f32_16x16x32_bf16 v[80:83], v[24:27], v[216:219], v[80:83]
    ds_read_b64_tr_b16 v[36:37], v11 offset:45056
    v_mfma_f32_16x16x32_bf16 v[84:87], v[24:27], v[220:223], v[84:87]
    ds_read_b64_tr_b16 v[38:39], v11 offset:45568
    s_setprio 0
    s_add_u32 m0, s59, 98304
    s_add_u32 s58, s58, 229376
    buffer_load_dwordx4 v8, s[20:23], s58 offen offset:0 lds
    s_add_u32 m0, s59, 106496
    s_nop 0
    buffer_load_dwordx4 v8, s[24:27], s58 offen offset:0 lds
    s_add_u32 m0, s59, 114560
    s_nop 0
    buffer_load_dwordx4 v8, s[20:23], s58 offen offset:128 lds
    s_add_u32 m0, s59, 122752
    s_nop 0
    buffer_load_dwordx4 v8, s[24:27], s58 offen offset:128 lds
    s_setprio 1
    v_add_u32 v9, 0x10000, v9
    v_add_u32 v10, 0x10000, v10
    v_add_u32 v11, 0x10000, v11
    s_waitcnt vmcnt(4)
    s_barrier
    s_waitcnt lgkmcnt(4)
    v_mfma_f32_16x16x32_bf16 v[56:59], v[28:31], v[216:219], v[56:59]
    ds_read_b64_tr_b16 v[16:17], v9 offset:0
    v_mfma_f32_16x16x32_bf16 v[60:63], v[28:31], v[220:223], v[60:63]
    ds_read_b64_tr_b16 v[18:19], v9 offset:512
    s_waitcnt lgkmcnt(4)
    v_mfma_f32_16x16x32_bf16 v[72:75], v[32:35], v[216:219], v[72:75]
    ds_read_b64_tr_b16 v[20:21], v10 offset:0
    v_mfma_f32_16x16x32_bf16 v[76:79], v[32:35], v[220:223], v[76:79]
    ds_read_b64_tr_b16 v[22:23], v10 offset:512
    s_waitcnt lgkmcnt(4)
    v_mfma_f32_16x16x32_bf16 v[88:91], v[36:39], v[216:219], v[88:91]
    ds_read_b64_tr_b16 v[24:25], v11 offset:0
    v_mfma_f32_16x16x32_bf16 v[92:95], v[36:39], v[220:223], v[92:95]
    ds_read_b64_tr_b16 v[26:27], v11 offset:512
    s_waitcnt lgkmcnt(4)
    v_mfma_f32_16x16x32_bf16 v[48:51], v[16:19], v[224:227], v[48:51]
    ds_read_b64_tr_b16 v[28:29], v9 offset:8192
    v_mfma_f32_16x16x32_bf16 v[52:55], v[16:19], v[228:231], v[52:55]
    ds_read_b64_tr_b16 v[30:31], v9 offset:8704
    s_waitcnt lgkmcnt(4)
    v_mfma_f32_16x16x32_bf16 v[64:67], v[20:23], v[224:227], v[64:67]
    ds_read_b64_tr_b16 v[32:33], v10 offset:8192
    v_mfma_f32_16x16x32_bf16 v[68:71], v[20:23], v[228:231], v[68:71]
    ds_read_b64_tr_b16 v[34:35], v10 offset:8704
    s_waitcnt lgkmcnt(4)
    v_mfma_f32_16x16x32_bf16 v[80:83], v[24:27], v[224:227], v[80:83]
    ds_read_b64_tr_b16 v[36:37], v11 offset:8192
    v_mfma_f32_16x16x32_bf16 v[84:87], v[24:27], v[228:231], v[84:87]
    ds_read_b64_tr_b16 v[38:39], v11 offset:8704
    s_waitcnt lgkmcnt(4)
    v_mfma_f32_16x16x32_bf16 v[56:59], v[28:31], v[224:227], v[56:59]
    ds_read_b64_tr_b16 v[16:17], v9 offset:4096
    v_mfma_f32_16x16x32_bf16 v[60:63], v[28:31], v[228:231], v[60:63]
    ds_read_b64_tr_b16 v[18:19], v9 offset:4608
    s_waitcnt lgkmcnt(4)
    v_mfma_f32_16x16x32_bf16 v[72:75], v[32:35], v[224:227], v[72:75]
    ds_read_b64_tr_b16 v[20:21], v10 offset:4096
    v_mfma_f32_16x16x32_bf16 v[76:79], v[32:35], v[228:231], v[76:79]
    ds_read_b64_tr_b16 v[22:23], v10 offset:4608
    s_waitcnt lgkmcnt(4)
    v_mfma_f32_16x16x32_bf16 v[88:91], v[36:39], v[224:227], v[88:91]
    ds_read_b64_tr_b16 v[24:25], v11 offset:4096
    v_mfma_f32_16x16x32_bf16 v[92:95], v[36:39], v[228:231], v[92:95]
    ds_read_b64_tr_b16 v[26:27], v11 offset:4608
    s_waitcnt lgkmcnt(4)
    v_mfma_f32_16x16x32_bf16 v[48:51], v[16:19], v[232:235], v[48:51]
    ds_read_b64_tr_b16 v[28:29], v9 offset:12288
    v_mfma_f32_16x16x32_bf16 v[52:55], v[16:19], v[236:239], v[52:55]
    ds_read_b64_tr_b16 v[30:31], v9 offset:12800
    s_waitcnt lgkmcnt(4)
    v_mfma_f32_16x16x32_bf16 v[64:67], v[20:23], v[232:235], v[64:67]
    ds_read_b64_tr_b16 v[32:33], v10 offset:12288
    v_mfma_f32_16x16x32_bf16 v[68:71], v[20:23], v[236:239], v[68:71]
    ds_read_b64_tr_b16 v[34:35], v10 offset:12800
    s_waitcnt lgkmcnt(4)
    v_mfma_f32_16x16x32_bf16 v[80:83], v[24:27], v[232:235], v[80:83]
    ds_read_b64_tr_b16 v[36:37], v11 offset:12288
    v_mfma_f32_16x16x32_bf16 v[84:87], v[24:27], v[236:239], v[84:87]
    ds_read_b64_tr_b16 v[38:39], v11 offset:12800
    s_setprio 0
    s_setprio 1
    s_waitcnt vmcnt(0)
    s_barrier
    v_and_b32 v44, 0x300, v1
    v_mad_u32_u24 v44, v44, 3, v1
    buffer_load_dwordx4 v[192:195], v44, s[16:19], s0 offen offset:0 sc1
    buffer_load_dwordx4 v[196:199], v44, s[16:19], s0 offen offset:512 sc1
    s_waitcnt lgkmcnt(4)
    v_mfma_f32_16x16x32_bf16 v[56:59], v[28:31], v[232:235], v[56:59]
    ds_read_b64_tr_b16 v[16:17], v9 offset:32768
    v_mfma_f32_16x16x32_bf16 v[60:63], v[28:31], v[236:239], v[60:63]
    ds_read_b64_tr_b16 v[18:19], v9 offset:33280
    s_waitcnt lgkmcnt(4)
    v_mfma_f32_16x16x32_bf16 v[72:75], v[32:35], v[232:235], v[72:75]
    ds_read_b64_tr_b16 v[20:21], v10 offset:32768
    v_mfma_f32_16x16x32_bf16 v[76:79], v[32:35], v[236:239], v[76:79]
    ds_read_b64_tr_b16 v[22:23], v10 offset:33280
    s_waitcnt lgkmcnt(4)
    v_mfma_f32_16x16x32_bf16 v[88:91], v[36:39], v[232:235], v[88:91]
    ds_read_b64_tr_b16 v[24:25], v11 offset:32768
    v_mfma_f32_16x16x32_bf16 v[92:95], v[36:39], v[236:239], v[92:95]
    ds_read_b64_tr_b16 v[26:27], v11 offset:33280
    s_waitcnt lgkmcnt(4)
    v_mfma_f32_16x16x32_bf16 v[48:51], v[16:19], v[240:243], v[48:51]
    ds_read_b64_tr_b16 v[28:29], v9 offset:40960
    v_mfma_f32_16x16x32_bf16 v[52:55], v[16:19], v[244:247], v[52:55]
    ds_read_b64_tr_b16 v[30:31], v9 offset:41472
    s_waitcnt lgkmcnt(4)
    v_mfma_f32_16x16x32_bf16 v[64:67], v[20:23], v[240:243], v[64:67]
    ds_read_b64_tr_b16 v[32:33], v10 offset:40960
    v_mfma_f32_16x16x32_bf16 v[68:71], v[20:23], v[244:247], v[68:71]
    ds_read_b64_tr_b16 v[34:35], v10 offset:41472
    s_waitcnt lgkmcnt(4)
    v_mfma_f32_16x16x32_bf16 v[80:83], v[24:27], v[240:243], v[80:83]
    ds_read_b64_tr_b16 v[36:37], v11 offset:40960
    v_mfma_f32_16x16x32_bf16 v[84:87], v[24:27], v[244:247], v[84:87]
    ds_read_b64_tr_b16 v[38:39], v11 offset:41472
    s_waitcnt lgkmcnt(4)
    v_mfma_f32_16x16x32_bf16 v[56:59], v[28:31], v[240:243], v[56:59]
    ds_read_b64_tr_b16 v[16:17], v9 offset:36864
    v_mfma_f32_16x16x32_bf16 v[60:63], v[28:31], v[244:247], v[60:63]
    ds_read_b64_tr_b16 v[18:19], v9 offset:37376
    s_waitcnt lgkmcnt(4)
    v_mfma_f32_16x16x32_bf16 v[72:75], v[32:35], v[240:243], v[72:75]
    ds_read_b64_tr_b16 v[20:21], v10 offset:36864
    v_mfma_f32_16x16x32_bf16 v[76:79], v[32:35], v[244:247], v[76:79]
    ds_read_b64_tr_b16 v[22:23], v10 offset:37376
    s_waitcnt lgkmcnt(4)
    v_mfma_f32_16x16x32_bf16 v[88:91], v[36:39], v[240:243], v[88:91]
    ds_read_b64_tr_b16 v[24:25], v11 offset:36864
    v_mfma_f32_16x16x32_bf16 v[92:95], v[36:39], v[244:247], v[92:95]
    ds_read_b64_tr_b16 v[26:27], v11 offset:37376
    s_waitcnt lgkmcnt(4)
    v_mfma_f32_16x16x32_bf16 v[48:51], v[16:19], v[248:251], v[48:51]
    ds_read_b64_tr_b16 v[28:29], v9 offset:45056
    v_mfma_f32_16x16x32_bf16 v[52:55], v[16:19], v[252:255], v[52:55]
    ds_read_b64_tr_b16 v[30:31], v9 offset:45568
    s_waitcnt lgkmcnt(4)
    v_mfma_f32_16x16x32_bf16 v[64:67], v[20:23], v[248:251], v[64:67]
    ds_read_b64_tr_b16 v[32:33], v10 offset:45056
    v_mfma_f32_16x16x32_bf16 v[68:71], v[20:23], v[252:255], v[68:71]
    ds_read_b64_tr_b16 v[34:35], v10 offset:45568
    s_waitcnt lgkmcnt(4)
    v_mfma_f32_16x16x32_bf16 v[80:83], v[24:27], v[248:251], v[80:83]
    ds_read_b64_tr_b16 v[36:37], v11 offset:45056
    v_mfma_f32_16x16x32_bf16 v[84:87], v[24:27], v[252:255], v[84:87]
    ds_read_b64_tr_b16 v[38:39], v11 offset:45568
    s_setprio 0
    s_waitcnt vmcnt(0)
    v_add_f32 v40, v192, v196
    v_add_f32 v41, v193, v197
    v_add_f32 v42, v194, v198
    s_lshl_b32 s52, s32, 2
    s_add_u32 s52, s52, 155648
    v_add_u32 v4, s52, v1
    v_cvt_pk_bf16_f32 v3, v40, v40
    v_lshlrev_b32 v3, 16, v3
    v_sub_f32 v5, v40, v3
    v_cvt_pk_bf16_f32 v3, v3, v5
    ds_write_b32 v4, v3 offset:0
    v_cvt_pk_bf16_f32 v3, v41, v41
    v_lshlrev_b32 v3, 16, v3
    v_sub_f32 v5, v41, v3
    v_cvt_pk_bf16_f32 v3, v3, v5
    ds_write_b32 v4, v3 offset:1024
    v_cvt_pk_bf16_f32 v3, v42, v42
    v_lshlrev_b32 v3, 16, v3
    v_sub_f32 v5, v42, v3
    v_cvt_pk_bf16_f32 v3, v3, v5
    ds_write_b32 v4, v3 offset:2048
    v_mov_b32 v184, 0
    v_mov_b32 v185, 0
    v_mov_b32 v186, v12
    v_mov_b32 v187, v12
    v_mov_b32 v188, 0
    v_mov_b32 v189, 0
    v_mov_b32 v190, v14
    v_mov_b32 v191, v14
    v_mov_b32 v192, 0
    v_mov_b32 v193, 0
    v_mul_f32 v44, v13, v13
    v_mul_f32 v45, v15, v15
    s_waitcnt lgkmcnt(0)
    s_barrier
    v_add_u32 v4, 155648, v1
    ds_read_b128 v[96:99], v4 offset:0
    ds_read_b128 v[100:103], v4 offset:1024
    ds_read_b128 v[104:107], v4 offset:2048
    v_mfma_f32_16x16x32_bf16 v[56:59], v[28:31], v[248:251], v[56:59]
    v_mfma_f32_16x16x32_bf16 v[60:63], v[28:31], v[252:255], v[60:63]
    v_mfma_f32_16x16x32_bf16 v[72:75], v[32:35], v[248:251], v[72:75]
    v_mfma_f32_16x16x32_bf16 v[76:79], v[32:35], v[252:255], v[76:79]
    v_mfma_f32_16x16x32_bf16 v[88:91], v[36:39], v[248:251], v[88:91]
    v_mfma_f32_16x16x32_bf16 v[92:95], v[36:39], v[252:255], v[92:95]
    s_waitcnt lgkmcnt(2)
    v_mfma_f32_16x16x32_bf16 v[48:51], v[96:99], v[186:189], v[48:51]
    v_mfma_f32_16x16x32_bf16 v[52:55], v[96:99], v[190:193], v[52:55]
    v_mfma_f32_16x16x32_bf16 v[56:59], v[96:99], v[184:187], v[56:59]
    v_mfma_f32_16x16x32_bf16 v[60:63], v[96:99], v[188:191], v[60:63]
    s_waitcnt lgkmcnt(1)
    v_mfma_f32_16x16x32_bf16 v[64:67], v[100:103], v[186:189], v[64:67]
    v_mfma_f32_16x16x32_bf16 v[68:71], v[100:103], v[190:193], v[68:71]
    v_mfma_f32_16x16x32_bf16 v[72:75], v[100:103], v[184:187], v[72:75]
    v_mfma_f32_16x16x32_bf16 v[76:79], v[100:103], v[188:191], v[76:79]
    s_nop 1
    v_max_f32 v48, 0, v48
    v_max_f32 v49, 0, v49
    v_max_f32 v50, 0, v50
    v_max_f32 v51, 0, v51
    s_waitcnt lgkmcnt(0)
    v_mfma_f32_16x16x32_bf16 v[80:83], v[104:107], v[186:189], v[80:83]
    v_max_f32 v52, 0, v52
    v_max_f32 v53, 0, v53
    v_max_f32 v54, 0, v54
    v_max_f32 v55, 0, v55
    v_mfma_f32_16x16x32_bf16 v[84:87], v[104:107], v[190:193], v[84:87]
    v_mul_f32 v56, v44, v56
    v_mul_f32 v57, v44, v57
    v_mul_f32 v58, v44, v58
    v_mul_f32 v59, v44, v59
    v_mfma_f32_16x16x32_bf16 v[88:91], v[104:107], v[184:187], v[88:91]
    v_mul_f32 v60, v45, v60
    v_mul_f32 v61, v45, v61
    v_mul_f32 v62, v45, v62
    v_mul_f32 v63, v45, v63
    v_mfma_f32_16x16x32_bf16 v[92:95], v[104:107], v[188:191], v[92:95]
    v_mul_f32 v48, v48, v56
    v_mul_f32 v49, v49, v57
    v_mul_f32 v50, v50, v58
    v_mul_f32 v51, v51, v59
    v_mul_f32 v52, v52, v60
    v_mul_f32 v53, v53, v61
    v_mul_f32 v54, v54, v62
    v_mul_f32 v55, v55, v63
    v_cvt_pk_bf16_f32 v208, v48, v49
    v_cvt_pk_bf16_f32 v209, v50, v51
    v_cvt_pk_bf16_f32 v210, v52, v53
    v_cvt_pk_bf16_f32 v211, v54, v55
    v_max_f32 v64, 0, v64
    v_max_f32 v65, 0, v65
    v_permlane32_swap_b32 v208, v210
    v_permlane32_swap_b32 v209, v211
    buffer_store_dwordx4 v[208:211], v46, s[16:19], s77 offen offset:0 sc1
    v_max_f32 v66, 0, v66
    v_max_f32 v67, 0, v67
    v_max_f32 v68, 0, v68
    v_max_f32 v69, 0, v69
    v_max_f32 v70, 0, v70
    v_max_f32 v71, 0, v71
    v_mul_f32 v72, v44, v72
    v_mul_f32 v73, v44, v73
    v_mul_f32 v74, v44, v74
    v_mul_f32 v75, v44, v75
    v_mul_f32 v76, v45, v76
    v_mul_f32 v77, v45, v77
    v_mul_f32 v78, v45, v78
    v_mul_f32 v79, v45, v79
    v_mul_f32 v64, v64, v72
    v_mul_f32 v65, v65, v73
    v_mul_f32 v66, v66, v74
    v_mul_f32 v67, v67, v75
    v_mul_f32 v68, v68, v76
    v_mul_f32 v69, v69, v77
    v_mul_f32 v70, v70, v78
    v_mul_f32 v71, v71, v79
    v_cvt_pk_bf16_f32 v212, v64, v65
    v_cvt_pk_bf16_f32 v213, v66, v67
    v_cvt_pk_bf16_f32 v214, v68, v69
    v_cvt_pk_bf16_f32 v215, v70, v71
    v_max_f32 v80, 0, v80
    v_max_f32 v81, 0, v81
    v_permlane32_swap_b32 v212, v214
    v_permlane32_swap_b32 v213, v215
    buffer_store_dwordx4 v[212:215], v46, s[16:19], s77 offen offset:1024 sc1
    v_max_f32 v82, 0, v82
    v_max_f32 v83, 0, v83
    v_max_f32 v84, 0, v84
    v_max_f32 v85, 0, v85
    v_max_f32 v86, 0, v86
    v_max_f32 v87, 0, v87
    v_mul_f32 v88, v44, v88
    v_mul_f32 v89, v44, v89
    v_mul_f32 v90, v44, v90
    v_mul_f32 v91, v44, v91
    v_mul_f32 v92, v45, v92
    v_mul_f32 v93, v45, v93
    v_mul_f32 v94, v45, v94
    v_mul_f32 v95, v45, v95
    v_mul_f32 v80, v80, v88
    v_mul_f32 v81, v81, v89
    v_mul_f32 v82, v82, v90
    v_mul_f32 v83, v83, v91
    v_mul_f32 v84, v84, v92
    v_mul_f32 v85, v85, v93
    v_mul_f32 v86, v86, v94
    v_mul_f32 v87, v87, v95
    v_cvt_pk_bf16_f32 v216, v80, v81
    v_cvt_pk_bf16_f32 v217, v82, v83
    v_cvt_pk_bf16_f32 v218, v84, v85
    v_cvt_pk_bf16_f32 v219, v86, v87
    s_nop 1
    v_permlane32_swap_b32 v216, v218
    v_permlane32_swap_b32 v217, v219
    buffer_store_dwordx4 v[216:219], v46, s[16:19], s77 offen offset:2048 sc1
L_Gx:
    s_mul_i32 s79, s32, 18432
    s_lshl_b32 s51, s35, 7
    s_lshl_b32 s80, s32, 17
    s_add_u32 s80, s80, s51
    s_mul_i32 s81, s32, 458752
    s_add_u32 s81, s81, s51
    s_mul_i32 s51, s34, 294912
    s_add_u32 s51, s51, 8388608
    s_mul_i32 s84, s32, 28672
    s_add_u32 s84, s84, s51
    s_add_u32 s85, s84, 147456
    s_lshl_b32 s86, s32, 13
    s_add_u32 s86, s86, s51
    s_add_u32 s86, s86, 114688
    s_add_u32 s87, s86, 147456
    s_lshl_b32 s88, s34, 9
    s_add_u32 s88, s88, 17891328
    s_lshl_b32 s89, s34, 12
    s_add_u32 s89, s89, 17956864
    s_lshl_b32 s51, s32, 4
    s_mov_b64 s[82:83], 0xffff
    s_lshl_b64 s[82:83], s[82:83], s51
    s_lshl_b32 s51, s32, 3
    s_mov_b64 s[90:91], 0xff
    s_lshl_b64 s[90:91], s[90:91], s51
    s_setprio 2
    v_mov_b32 v128, v6
    v_add_u32 v129, 7168, v6
    v_add_u32 v16, s79, v7
    v_xor_b32 v17, 32, v16
    v_xor_b32 v18, 64, v16
    v_xor_b32 v19, 32, v18
    v_and_b32 v135, 0x300, v1
    v_add_u32 v135, v135, v1
    v_lshrrev_b32 v132, 1, v1
    v_lshlrev_b32 v133, 3, v1
    v_lshrrev_b32 v134, 9, v1
    v_lshl_add_u32 v134, v134, 6, v1
    v_add_u32 v134, s79, v134
    v_mov_b32 v6, s48
    v_mov_b32 v7, s49
    v_lshrrev_b32 v3, 3, v0
    v_and_b32 v4, 7, v0
    v_lshlrev_b32 v137, 10, v3
    v_lshl_add_u32 v137, v4, 4, v137
    v_lshrrev_b32 v136, 4, v3
    v_lshl_add_u32 v136, v136, 3, v4
    v_mul_u32_u24 v136, 576, v136
    v_and_b32 v3, 15, v3
    v_lshl_add_u32 v136, v3, 4, v136
    s_setprio 2
    s_waitcnt vmcnt(0)
    s_mov_b64 exec, 1
    buffer_store_dwordx2 v[6:7], off, s[16:19], s78 sc1
    s_mov_b64 exec, -1
    s_add_u32 m0, s79, 0
    s_nop 0
    buffer_load_dwordx4 v128, s[36:39], s80 offen lds
    buffer_load_dwordx4 v129, s[36:39], s80 offen offset:1024 lds
    s_add_u32 s80, s80, 16384
    s_add_u32 m0, s79, 2048
    s_nop 0
    buffer_load_dwordx4 v128, s[36:39], s80 offen lds
    buffer_load_dwordx4 v129, s[36:39], s80 offen offset:1024 lds
    s_add_u32 s80, s80, 16384
    s_add_u32 m0, s79, 4096
    s_nop 0
    buffer_load_dwordx4 v128, s[36:39], s80 offen lds
    buffer_load_dwordx4 v129, s[36:39], s80 offen offset:1024 lds
    s_add_u32 s80, s80, 16384
    s_waitcnt vmcnt(5)
    s_add_u32 m0, s79, 6144
    s_nop 0
    buffer_load_dwordx4 v128, s[36:39], s80 offen lds
    buffer_load_dwordx4 v129, s[36:39], s80 offen offset:1024 lds
    s_add_u32 s80, s80, 16384
    s_waitcnt vmcnt(5)
    s_add_u32 m0, s79, 8192
    s_nop 0
    buffer_load_dwordx4 v128, s[36:39], s80 offen lds
    buffer_load_dwordx4 v129, s[36:39], s80 offen offset:1024 lds
    s_add_u32 s80, s80, 16384
    s_waitcnt vmcnt(5)
    s_add_u32 m0, s79, 10240
    s_nop 0
    buffer_load_dwordx4 v128, s[36:39], s80 offen lds
    buffer_load_dwordx4 v129, s[36:39], s80 offen offset:1024 lds
    s_add_u32 s80, s80, 16384
    s_waitcnt vmcnt(5)
    s_add_u32 m0, s79, 12288
    s_nop 0
    buffer_load_dwordx4 v128, s[36:39], s80 offen lds
    buffer_load_dwordx4 v129, s[36:39], s80 offen offset:1024 lds
    s_add_u32 s80, s80, 16384
    s_waitcnt vmcnt(5)
    s_add_u32 m0, s79, 14336
    s_nop 0
    buffer_load_dwordx4 v128, s[36:39], s80 offen lds
    buffer_load_dwordx4 v129, s[36:39], s80 offen offset:1024 lds
    s_add_u32 s80, s80, 16384
    buffer_load_dwordx4 v[140:143], v137, s[8:11], s94 offen
    ds_read_b64_tr_b16 v[144:145], v16 offset:0
    ds_read_b64_tr_b16 v[146:147], v16 offset:1024
    ds_read_b64_tr_b16 v[148:149], v17 offset:0
    ds_read_b64_tr_b16 v[150:151], v17 offset:1024
    ds_read_b64_tr_b16 v[152:153], v18 offset:0
    ds_read_b64_tr_b16 v[154:155], v18 offset:1024
    ds_read_b64_tr_b16 v[156:157], v19 offset:0
    ds_read_b64_tr_b16 v[158:159], v19 offset:1024
    s_waitcnt lgkmcnt(0)
    ds_read_b64_tr_b16 v[160:161], v16 offset:4096
    ds_read_b64_tr_b16 v[162:163], v16 offset:5120
    ds_read_b64_tr_b16 v[164:165], v17 offset:4096
    ds_read_b64_tr_b16 v[166:167], v17 offset:5120
    ds_read_b64_tr_b16 v[168:169], v18 offset:4096
    ds_read_b64_tr_b16 v[170:171], v18 offset:5120
    ds_read_b64_tr_b16 v[172:173], v19 offset:4096
    ds_read_b64_tr_b16 v[174:175], v19 offset:5120
    s_waitcnt lgkmcnt(0)
    s_waitcnt vmcnt(5)
    ds_read_b64_tr_b16 v[176:177], v16 offset:8192
    ds_read_b64_tr_b16 v[178:179], v16 offset:9216
    ds_read_b64_tr_b16 v[180:181], v17 offset:8192
    ds_read_b64_tr_b16 v[182:183], v17 offset:9216
    ds_read_b64_tr_b16 v[184:185], v18 offset:8192
    ds_read_b64_tr_b16 v[186:187], v18 offset:9216
    ds_read_b64_tr_b16 v[188:189], v19 offset:8192
    ds_read_b64_tr_b16 v[190:191], v19 offset:9216
    s_waitcnt lgkmcnt(0)
    s_waitcnt vmcnt(1)
    ds_read_b64_tr_b16 v[48:49], v16 offset:12288
    ds_read_b64_tr_b16 v[50:51], v16 offset:13312
    ds_read_b64_tr_b16 v[52:53], v17 offset:12288
    ds_read_b64_tr_b16 v[54:55], v17 offset:13312
    ds_read_b64_tr_b16 v[56:57], v18 offset:12288
    ds_read_b64_tr_b16 v[58:59], v18 offset:13312
    ds_read_b64_tr_b16 v[60:61], v19 offset:12288
    ds_read_b64_tr_b16 v[62:63], v19 offset:13312
    s_waitcnt lgkmcnt(0)
    s_add_u32 m0, s79, 0
    s_nop 0
    buffer_load_dwordx4 v128, s[28:31], s81 offen lds
    buffer_load_dwordx4 v129, s[28:31], s81 offen offset:1024 lds
    s_add_u32 s81, s81, 16384
    s_add_u32 m0, s79, 2048
    s_nop 0
    buffer_load_dwordx4 v128, s[28:31], s81 offen lds
    buffer_load_dwordx4 v129, s[28:31], s81 offen offset:1024 lds
    s_add_u32 s81, s81, 16384
    s_add_u32 m0, s79, 4096
    s_nop 0
    buffer_load_dwordx4 v128, s[28:31], s81 offen lds
    buffer_load_dwordx4 v129, s[28:31], s81 offen offset:1024 lds
    s_add_u32 s81, s81, 16384
    s_waitcnt vmcnt(5)
    s_add_u32 m0, s79, 6144
    s_nop 0
    buffer_load_dwordx4 v128, s[28:31], s81 offen lds
    buffer_load_dwordx4 v129, s[28:31], s81 offen offset:1024 lds
    s_add_u32 s81, s81, 16384
    s_waitcnt vmcnt(5)
    s_add_u32 m0, s79, 8192
    s_nop 0
    buffer_load_dwordx4 v128, s[28:31], s81 offen lds
    buffer_load_dwordx4 v129, s[28:31], s81 offen offset:1024 lds
    s_add_u32 s81, s81, 16384
    s_waitcnt vmcnt(5)
    s_add_u32 m0, s79, 10240
    s_nop 0
    buffer_load_dwordx4 v128, s[28:31], s81 offen lds
    buffer_load_dwordx4 v129, s[28:31], s81 offen offset:1024 lds
    s_add_u32 s81, s81, 16384
    s_waitcnt vmcnt(5)
    s_add_u32 m0, s79, 12288
    s_nop 0
    buffer_load_dwordx4 v128, s[28:31], s81 offen lds
    buffer_load_dwordx4 v129, s[28:31], s81 offen offset:1024 lds
    s_add_u32 s81, s81, 16384
    s_waitcnt vmcnt(5)
    s_add_u32 m0, s79, 14336
    s_nop 0
    buffer_load_dwordx4 v128, s[28:31], s81 offen lds
    buffer_load_dwordx4 v129, s[28:31], s81 offen offset:1024 lds
    s_add_u32 s81, s81, 16384
    s_mov_b32 s50, 131072
L_pollH:
    s_mov_b64 exec, s[82:83]
    buffer_load_dwordx2 v[8:9], v132, s[16:19], s88 offen sc1
    s_mov_b64 exec, -1
    s_waitcnt vmcnt(0)
L_pollH_w:
    v_cmp_eq_u64 vcc, s[48:49], v[8:9]
    s_sub_u32 s50, s50, 1
    s_cbranch_scc1 L_pollH_x
    s_and_b64 vcc, vcc, s[82:83]
    s_cmp_eq_u64 vcc, s[82:83]
    s_cbranch_scc0 L_pollH
L_pollH_x:
    s_setprio 0
    buffer_load_dwordx4 v[64:67], v135, s[16:19], s84 offen offset:0 sc1
    buffer_load_dwordx4 v[68:71], v135, s[16:19], s84 offen offset:256 sc1
    buffer_load_dwordx4 v[72:75], v135, s[16:19], s85 offen offset:0 sc1
    buffer_load_dwordx4 v[76:79], v135, s[16:19], s85 offen offset:256 sc1
    buffer_load_dwordx4 v[80:83], v135, s[16:19], s84 offen offset:2048 sc1
    buffer_load_dwordx4 v[84:87], v135, s[16:19], s84 offen offset:2304 sc1
    s_waitcnt vmcnt(5)
    buffer_load_dwordx4 v[88:91], v135, s[16:19], s85 offen offset:2048 sc1
    buffer_load_dwordx4 v[92:95], v135, s[16:19], s85 offen offset:2304 sc1
    s_waitcnt vmcnt(5)
    s_add_u32 s84, s84, 4096
    buffer_load_dwordx4 v[96:99], v135, s[16:19], s84 offen offset:0 sc1
    buffer_load_dwordx4 v[100:103], v135, s[16:19], s84 offen offset:256 sc1
    s_waitcnt vmcnt(5)
    s_add_u32 s85, s85, 4096
    buffer_load_dwordx4 v[104:107], v135, s[16:19], s85 offen offset:0 sc1
    buffer_load_dwordx4 v[108:111], v135, s[16:19], s85 offen offset:256 sc1
    s_waitcnt vmcnt(5)
    buffer_load_dwordx4 v[112:115], v135, s[16:19], s84 offen offset:2048 sc1
    buffer_load_dwordx4 v[116:119], v135, s[16:19], s84 offen offset:2304 sc1
    s_waitcnt vmcnt(5)
    buffer_load_dwordx4 v[120:123], v135, s[16:19], s85 offen offset:2048 sc1
    buffer_load_dwordx4 v[124:127], v135, s[16:19], s85 offen offset:2304 sc1
    ds_read_b64_tr_b16 v[32:33], v16 offset:0
    ds_read_b64_tr_b16 v[34:35], v16 offset:1024
    ds_read_b64_tr_b16 v[36:37], v17 offset:0
    ds_read_b64_tr_b16 v[38:39], v17 offset:1024
    s_waitcnt lgkmcnt(0)
    v_mfma_f32_16x16x32_bf16 v[192:195], v[32:35], v[64:67], 0
    ds_read_b64_tr_b16 v[40:41], v18 offset:0
    v_mfma_f32_16x16x32_bf16 v[208:211], v[32:35], v[68:71], 0
    ds_read_b64_tr_b16 v[42:43], v18 offset:1024
    v_mfma_f32_16x16x32_bf16 v[224:227], v[32:35], v[72:75], 0
    ds_read_b64_tr_b16 v[44:45], v19 offset:0
    v_mfma_f32_16x16x32_bf16 v[240:243], v[32:35], v[76:79], 0
    ds_read_b64_tr_b16 v[46:47], v19 offset:1024
    v_mfma_f32_16x16x32_bf16 v[196:199], v[36:39], v[64:67], 0
    v_mfma_f32_16x16x32_bf16 v[212:215], v[36:39], v[68:71], 0
    v_mfma_f32_16x16x32_bf16 v[228:231], v[36:39], v[72:75], 0
    v_mfma_f32_16x16x32_bf16 v[244:247], v[36:39], v[76:79], 0
    s_waitcnt vmcnt(5)
    s_waitcnt lgkmcnt(0)
    v_mfma_f32_16x16x32_bf16 v[200:203], v[40:43], v[64:67], 0
    ds_read_b64_tr_b16 v[32:33], v16 offset:4096
    v_mfma_f32_16x16x32_bf16 v[216:219], v[40:43], v[68:71], 0
    ds_read_b64_tr_b16 v[34:35], v16 offset:5120
    v_mfma_f32_16x16x32_bf16 v[232:235], v[40:43], v[72:75], 0
    ds_read_b64_tr_b16 v[36:37], v17 offset:4096
    v_mfma_f32_16x16x32_bf16 v[248:251], v[40:43], v[76:79], 0
    ds_read_b64_tr_b16 v[38:39], v17 offset:5120
    v_mfma_f32_16x16x32_bf16 v[204:207], v[44:47], v[64:67], 0
    s_add_u32 m0, s79, 0
    s_nop 0
    buffer_load_dwordx4 v128, s[28:31], s81 offen lds
    buffer_load_dwordx4 v129, s[28:31], s81 offen offset:1024 lds
    s_add_u32 s81, s81, 16384
    v_mfma_f32_16x16x32_bf16 v[220:223], v[44:47], v[68:71], 0
    v_mfma_f32_16x16x32_bf16 v[236:239], v[44:47], v[72:75], 0
    v_mfma_f32_16x16x32_bf16 v[252:255], v[44:47], v[76:79], 0
    s_add_u32 s84, s84, 4096
    buffer_load_dwordx4 v[64:67], v135, s[16:19], s84 offen offset:0 sc1
    buffer_load_dwordx4 v[68:71], v135, s[16:19], s84 offen offset:256 sc1
    s_waitcnt vmcnt(5)
    s_waitcnt lgkmcnt(0)
    v_mfma_f32_16x16x32_bf16 v[192:195], v[32:35], v[80:83], v[192:195]
    ds_read_b64_tr_b16 v[40:41], v18 offset:4096
    v_mfma_f32_16x16x32_bf16 v[208:211], v[32:35], v[84:87], v[208:211]
    ds_read_b64_tr_b16 v[42:43], v18 offset:5120
    v_mfma_f32_16x16x32_bf16 v[224:227], v[32:35], v[88:91], v[224:227]
    ds_read_b64_tr_b16 v[44:45], v19 offset:4096
    v_mfma_f32_16x16x32_bf16 v[240:243], v[32:35], v[92:95], v[240:243]
    ds_read_b64_tr_b16 v[46:47], v19 offset:5120
    v_mfma_f32_16x16x32_bf16 v[196:199], v[36:39], v[80:83], v[196:199]
    s_add_u32 m0, s79, 2048
    s_nop 0
    buffer_load_dwordx4 v128, s[28:31], s81 offen lds
    buffer_load_dwordx4 v129, s[28:31], s81 offen offset:1024 lds
    s_add_u32 s81, s81, 16384
    v_mfma_f32_16x16x32_bf16 v[212:215], v[36:39], v[84:87], v[212:215]
    v_mfma_f32_16x16x32_bf16 v[228:231], v[36:39], v[88:91], v[228:231]
    v_mfma_f32_16x16x32_bf16 v[244:247], v[36:39], v[92:95], v[244:247]
    s_add_u32 s85, s85, 4096
    buffer_load_dwordx4 v[72:75], v135, s[16:19], s85 offen offset:0 sc1
    buffer_load_dwordx4 v[76:79], v135, s[16:19], s85 offen offset:256 sc1
    s_waitcnt vmcnt(5)
    s_waitcnt lgkmcnt(0)
    v_mfma_f32_16x16x32_bf16 v[200:203], v[40:43], v[80:83], v[200:203]
    ds_read_b64_tr_b16 v[32:33], v16 offset:8192
    v_mfma_f32_16x16x32_bf16 v[216:219], v[40:43], v[84:87], v[216:219]
    ds_read_b64_tr_b16 v[34:35], v16 offset:9216
    v_mfma_f32_16x16x32_bf16 v[232:235], v[40:43], v[88:91], v[232:235]
    ds_read_b64_tr_b16 v[36:37], v17 offset:8192
    v_mfma_f32_16x16x32_bf16 v[248:251], v[40:43], v[92:95], v[248:251]
    ds_read_b64_tr_b16 v[38:39], v17 offset:9216
    v_mfma_f32_16x16x32_bf16 v[204:207], v[44:47], v[80:83], v[204:207]
    s_add_u32 m0, s79, 4096
    s_nop 0
    buffer_load_dwordx4 v128, s[28:31], s81 offen lds
    buffer_load_dwordx4 v129, s[28:31], s81 offen offset:1024 lds
    s_add_u32 s81, s81, 16384
    v_mfma_f32_16x16x32_bf16 v[220:223], v[44:47], v[84:87], v[220:223]
    v_mfma_f32_16x16x32_bf16 v[236:239], v[44:47], v[88:91], v[236:239]
    v_mfma_f32_16x16x32_bf16 v[252:255], v[44:47], v[92:95], v[252:255]
    buffer_load_dwordx4 v[80:83], v135, s[16:19], s84 offen offset:2048 sc1
    buffer_load_dwordx4 v[84:87], v135, s[16:19], s84 offen offset:2304 sc1
    s_waitcnt vmcnt(5)
    s_waitcnt lgkmcnt(0)
    v_mfma_f32_16x16x32_bf16 v[192:195], v[32:35], v[96:99], v[192:195]
    ds_read_b64_tr_b16 v[40:41], v18 offset:8192
    v_mfma_f32_16x16x32_bf16 v[208:211], v[32:35], v[100:103], v[208:211]
    ds_read_b64_tr_b16 v[42:43], v18 offset:9216
    v_mfma_f32_16x16x32_bf16 v[224:227], v[32:35], v[104:107], v[224:227]
    ds_read_b64_tr_b16 v[44:45], v19 offset:8192
    v_mfma_f32_16x16x32_bf16 v[240:243], v[32:35], v[108:111], v[240:243]
    ds_read_b64_tr_b16 v[46:47], v19 offset:9216
    v_mfma_f32_16x16x32_bf16 v[196:199], v[36:39], v[96:99], v[196:199]
    s_add_u32 m0, s79, 6144
    s_nop 0
    buffer_load_dwordx4 v128, s[28:31], s81 offen lds
    buffer_load_dwordx4 v129, s[28:31], s81 offen offset:1024 lds
    s_add_u32 s81, s81, 16384
    v_mfma_f32_16x16x32_bf16 v[212:215], v[36:39], v[100:103], v[212:215]
    v_mfma_f32_16x16x32_bf16 v[228:231], v[36:39], v[104:107], v[228:231]
    v_mfma_f32_16x16x32_bf16 v[244:247], v[36:39], v[108:111], v[244:247]
    buffer_load_dwordx4 v[88:91], v135, s[16:19], s85 offen offset:2048 sc1
    buffer_load_dwordx4 v[92:95], v135, s[16:19], s85 offen offset:2304 sc1
    s_waitcnt vmcnt(5)
    s_waitcnt lgkmcnt(0)
    v_mfma_f32_16x16x32_bf16 v[200:203], v[40:43], v[96:99], v[200:203]
    ds_read_b64_tr_b16 v[32:33], v16 offset:12288
    v_mfma_f32_16x16x32_bf16 v[216:219], v[40:43], v[100:103], v[216:219]
    ds_read_b64_tr_b16 v[34:35], v16 offset:13312
    v_mfma_f32_16x16x32_bf16 v[232:235], v[40:43], v[104:107], v[232:235]
    ds_read_b64_tr_b16 v[36:37], v17 offset:12288
    v_mfma_f32_16x16x32_bf16 v[248:251], v[40:43], v[108:111], v[248:251]
    ds_read_b64_tr_b16 v[38:39], v17 offset:13312
    v_mfma_f32_16x16x32_bf16 v[204:207], v[44:47], v[96:99], v[204:207]
    s_add_u32 m0, s79, 8192
    s_nop 0
    buffer_load_dwordx4 v128, s[28:31], s81 offen lds
    buffer_load_dwordx4 v129, s[28:31], s81 offen offset:1024 lds
    s_add_u32 s81, s81, 16384
    v_mfma_f32_16x16x32_bf16 v[220:223], v[44:47], v[100:103], v[220:223]
    v_mfma_f32_16x16x32_bf16 v[236:239], v[44:47], v[104:107], v[236:239]
    v_mfma_f32_16x16x32_bf16 v[252:255], v[44:47], v[108:111], v[252:255]
    s_add_u32 s84, s84, 4096
    buffer_load_dwordx4 v[96:99], v135, s[16:19], s84 offen offset:0 sc1
    buffer_load_dwordx4 v[100:103], v135, s[16:19], s84 offen offset:256 sc1
    s_waitcnt vmcnt(5)
    s_waitcnt lgkmcnt(0)
    v_mfma_f32_16x16x32_bf16 v[192:195], v[32:35], v[112:115], v[192:195]
    ds_read_b64_tr_b16 v[40:41], v18 offset:12288
    v_mfma_f32_16x16x32_bf16 v[208:211], v[32:35], v[116:119], v[208:211]
    ds_read_b64_tr_b16 v[42:43], v18 offset:13312
    v_mfma_f32_16x16x32_bf16 v[224:227], v[32:35], v[120:123], v[224:227]
    ds_read_b64_tr_b16 v[44:45], v19 offset:12288
    v_mfma_f32_16x16x32_bf16 v[240:243], v[32:35], v[124:127], v[240:243]
    ds_read_b64_tr_b16 v[46:47], v19 offset:13312
    v_mfma_f32_16x16x32_bf16 v[196:199], v[36:39], v[112:115], v[196:199]
    s_add_u32 m0, s79, 10240
    s_nop 0
    buffer_load_dwordx4 v128, s[28:31], s81 offen lds
    buffer_load_dwordx4 v129, s[28:31], s81 offen offset:1024 lds
    s_add_u32 s81, s81, 16384
    v_mfma_f32_16x16x32_bf16 v[212:215], v[36:39], v[116:119], v[212:215]
    v_mfma_f32_16x16x32_bf16 v[228:231], v[36:39], v[120:123], v[228:231]
    v_mfma_f32_16x16x32_bf16 v[244:247], v[36:39], v[124:127], v[244:247]
    s_add_u32 s85, s85, 4096
    buffer_load_dwordx4 v[104:107], v135, s[16:19], s85 offen offset:0 sc1
    buffer_load_dwordx4 v[108:111], v135, s[16:19], s85 offen offset:256 sc1
    s_waitcnt vmcnt(5)
    s_waitcnt lgkmcnt(0)
    v_mfma_f32_16x16x32_bf16 v[200:203], v[40:43], v[112:115], v[200:203]
    ds_read_b64_tr_b16 v[32:33], v16 offset:0
    v_mfma_f32_16x16x32_bf16 v[216:219], v[40:43], v[116:119], v[216:219]
    ds_read_b64_tr_b16 v[34:35], v16 offset:1024
    v_mfma_f32_16x16x32_bf16 v[232:235], v[40:43], v[120:123], v[232:235]
    ds_read_b64_tr_b16 v[36:37], v17 offset:0
    v_mfma_f32_16x16x32_bf16 v[248:251], v[40:43], v[124:127], v[248:251]
    ds_read_b64_tr_b16 v[38:39], v17 offset:1024
    v_mfma_f32_16x16x32_bf16 v[204:207], v[44:47], v[112:115], v[204:207]
    s_add_u32 m0, s79, 12288
    s_nop 0
    buffer_load_dwordx4 v128, s[28:31], s81 offen lds
    buffer_load_dwordx4 v129, s[28:31], s81 offen offset:1024 lds
    s_add_u32 s81, s81, 16384
    v_mfma_f32_16x16x32_bf16 v[220:223], v[44:47], v[116:119], v[220:223]
    v_mfma_f32_16x16x32_bf16 v[236:239], v[44:47], v[120:123], v[236:239]
    v_mfma_f32_16x16x32_bf16 v[252:255], v[44:47], v[124:127], v[252:255]
    buffer_load_dwordx4 v[112:115], v135, s[16:19], s84 offen offset:2048 sc1
    buffer_load_dwordx4 v[116:119], v135, s[16:19], s84 offen offset:2304 sc1
    s_waitcnt vmcnt(5)
    s_waitcnt lgkmcnt(0)
    v_mfma_f32_16x16x32_bf16 v[192:195], v[32:35], v[64:67], v[192:195]
    ds_read_b64_tr_b16 v[40:41], v18 offset:0
    v_mfma_f32_16x16x32_bf16 v[208:211], v[32:35], v[68:71], v[208:211]
    ds_read_b64_tr_b16 v[42:43], v18 offset:1024
    v_mfma_f32_16x16x32_bf16 v[224:227], v[32:35], v[72:75], v[224:227]
    ds_read_b64_tr_b16 v[44:45], v19 offset:0
    v_mfma_f32_16x16x32_bf16 v[240:243], v[32:35], v[76:79], v[240:243]
    ds_read_b64_tr_b16 v[46:47], v19 offset:1024
    v_mfma_f32_16x16x32_bf16 v[196:199], v[36:39], v[64:67], v[196:199]
    s_add_u32 m0, s79, 14336
    s_nop 0
    buffer_load_dwordx4 v128, s[28:31], s81 offen lds
    buffer_load_dwordx4 v129, s[28:31], s81 offen offset:1024 lds
    s_add_u32 s81, s81, 16384
    v_mfma_f32_16x16x32_bf16 v[212:215], v[36:39], v[68:71], v[212:215]
    v_mfma_f32_16x16x32_bf16 v[228:231], v[36:39], v[72:75], v[228:231]
    v_mfma_f32_16x16x32_bf16 v[244:247], v[36:39], v[76:79], v[244:247]
    buffer_load_dwordx4 v[120:123], v135, s[16:19], s85 offen offset:2048 sc1
    buffer_load_dwordx4 v[124:127], v135, s[16:19], s85 offen offset:2304 sc1
    s_waitcnt vmcnt(5)
    s_waitcnt lgkmcnt(0)
    v_mfma_f32_16x16x32_bf16 v[200:203], v[40:43], v[64:67], v[200:203]
    ds_read_b64_tr_b16 v[32:33], v16 offset:4096
    v_mfma_f32_16x16x32_bf16 v[216:219], v[40:43], v[68:71], v[216:219]
    ds_read_b64_tr_b16 v[34:35], v16 offset:5120
    v_mfma_f32_16x16x32_bf16 v[232:235], v[40:43], v[72:75], v[232:235]
    ds_read_b64_tr_b16 v[36:37], v17 offset:4096
    v_mfma_f32_16x16x32_bf16 v[248:251], v[40:43], v[76:79], v[248:251]
    ds_read_b64_tr_b16 v[38:39], v17 offset:5120
    v_mfma_f32_16x16x32_bf16 v[204:207], v[44:47], v[64:67], v[204:207]
    s_add_u32 m0, s79, 0
    s_nop 0
    buffer_load_dwordx4 v128, s[28:31], s81 offen lds
    buffer_load_dwordx4 v129, s[28:31], s81 offen offset:1024 lds
    s_add_u32 s81, s81, 16384
    v_mfma_f32_16x16x32_bf16 v[220:223], v[44:47], v[68:71], v[220:223]
    v_mfma_f32_16x16x32_bf16 v[236:239], v[44:47], v[72:75], v[236:239]
    v_mfma_f32_16x16x32_bf16 v[252:255], v[44:47], v[76:79], v[252:255]
    s_add_u32 s84, s84, 4096
    buffer_load_dwordx4 v[64:67], v135, s[16:19], s84 offen offset:0 sc1
    buffer_load_dwordx4 v[68:71], v135, s[16:19], s84 offen offset:256 sc1
    s_waitcnt vmcnt(5)
    s_waitcnt lgkmcnt(0)
    v_mfma_f32_16x16x32_bf16 v[192:195], v[32:35], v[80:83], v[192:195]
    ds_read_b64_tr_b16 v[40:41], v18 offset:4096
    v_mfma_f32_16x16x32_bf16 v[208:211], v[32:35], v[84:87], v[208:211]
    ds_read_b64_tr_b16 v[42:43], v18 offset:5120
    v_mfma_f32_16x16x32_bf16 v[224:227], v[32:35], v[88:91], v[224:227]
    ds_read_b64_tr_b16 v[44:45], v19 offset:4096
    v_mfma_f32_16x16x32_bf16 v[240:243], v[32:35], v[92:95], v[240:243]
    ds_read_b64_tr_b16 v[46:47], v19 offset:5120
    v_mfma_f32_16x16x32_bf16 v[196:199], v[36:39], v[80:83], v[196:199]
    s_add_u32 m0, s79, 2048
    s_nop 0
    buffer_load_dwordx4 v128, s[28:31], s81 offen lds
    buffer_load_dwordx4 v129, s[28:31], s81 offen offset:1024 lds
    s_add_u32 s81, s81, 16384
    v_mfma_f32_16x16x32_bf16 v[212:215], v[36:39], v[84:87], v[212:215]
    v_mfma_f32_16x16x32_bf16 v[228:231], v[36:39], v[88:91], v[228:231]
    v_mfma_f32_16x16x32_bf16 v[244:247], v[36:39], v[92:95], v[244:247]
    s_add_u32 s85, s85, 4096
    buffer_load_dwordx4 v[72:75], v135, s[16:19], s85 offen offset:0 sc1
    buffer_load_dwordx4 v[76:79], v135, s[16:19], s85 offen offset:256 sc1
    s_waitcnt vmcnt(5)
    s_waitcnt lgkmcnt(0)
    v_mfma_f32_16x16x32_bf16 v[200:203], v[40:43], v[80:83], v[200:203]
    ds_read_b64_tr_b16 v[32:33], v16 offset:8192
    v_mfma_f32_16x16x32_bf16 v[216:219], v[40:43], v[84:87], v[216:219]
    ds_read_b64_tr_b16 v[34:35], v16 offset:9216
    v_mfma_f32_16x16x32_bf16 v[232:235], v[40:43], v[88:91], v[232:235]
    ds_read_b64_tr_b16 v[36:37], v17 offset:8192
    v_mfma_f32_16x16x32_bf16 v[248:251], v[40:43], v[92:95], v[248:251]
    ds_read_b64_tr_b16 v[38:39], v17 offset:9216
    v_mfma_f32_16x16x32_bf16 v[204:207], v[44:47], v[80:83], v[204:207]
    s_add_u32 m0, s79, 4096
    s_nop 0
    buffer_load_dwordx4 v128, s[28:31], s81 offen lds
    buffer_load_dwordx4 v129, s[28:31], s81 offen offset:1024 lds
    s_add_u32 s81, s81, 16384
    v_mfma_f32_16x16x32_bf16 v[220:223], v[44:47], v[84:87], v[220:223]
    v_mfma_f32_16x16x32_bf16 v[236:239], v[44:47], v[88:91], v[236:239]
    v_mfma_f32_16x16x32_bf16 v[252:255], v[44:47], v[92:95], v[252:255]
    buffer_load_dwordx4 v[80:83], v135, s[16:19], s84 offen offset:2048 sc1
    buffer_load_dwordx4 v[84:87], v135, s[16:19], s84 offen offset:2304 sc1
    s_waitcnt vmcnt(5)
    s_waitcnt lgkmcnt(0)
    v_mfma_f32_16x16x32_bf16 v[192:195], v[32:35], v[96:99], v[192:195]
    ds_read_b64_tr_b16 v[40:41], v18 offset:8192
    v_mfma_f32_16x16x32_bf16 v[208:211], v[32:35], v[100:103], v[208:211]
    ds_read_b64_tr_b16 v[42:43], v18 offset:9216
    v_mfma_f32_16x16x32_bf16 v[224:227], v[32:35], v[104:107], v[224:227]
    ds_read_b64_tr_b16 v[44:45], v19 offset:8192
    v_mfma_f32_16x16x32_bf16 v[240:243], v[32:35], v[108:111], v[240:243]
    ds_read_b64_tr_b16 v[46:47], v19 offset:9216
    v_mfma_f32_16x16x32_bf16 v[196:199], v[36:39], v[96:99], v[196:199]
    s_add_u32 m0, s79, 6144
    s_nop 0
    buffer_load_dwordx4 v128, s[28:31], s81 offen lds
    buffer_load_dwordx4 v129, s[28:31], s81 offen offset:1024 lds
    s_add_u32 s81, s81, 16384
    v_mfma_f32_16x16x32_bf16 v[212:215], v[36:39], v[100:103], v[212:215]
    v_mfma_f32_16x16x32_bf16 v[228:231], v[36:39], v[104:107], v[228:231]
    v_mfma_f32_16x16x32_bf16 v[244:247], v[36:39], v[108:111], v[244:247]
    buffer_load_dwordx4 v[88:91], v135, s[16:19], s85 offen offset:2048 sc1
    buffer_load_dwordx4 v[92:95], v135, s[16:19], s85 offen offset:2304 sc1
    s_waitcnt vmcnt(5)
    s_waitcnt lgkmcnt(0)
    v_mfma_f32_16x16x32_bf16 v[200:203], v[40:43], v[96:99], v[200:203]
    ds_read_b64_tr_b16 v[32:33], v16 offset:12288
    v_mfma_f32_16x16x32_bf16 v[216:219], v[40:43], v[100:103], v[216:219]
    ds_read_b64_tr_b16 v[34:35], v16 offset:13312
    v_mfma_f32_16x16x32_bf16 v[232:235], v[40:43], v[104:107], v[232:235]
    ds_read_b64_tr_b16 v[36:37], v17 offset:12288
    v_mfma_f32_16x16x32_bf16 v[248:251], v[40:43], v[108:111], v[248:251]
    ds_read_b64_tr_b16 v[38:39], v17 offset:13312
    v_mfma_f32_16x16x32_bf16 v[204:207], v[44:47], v[96:99], v[204:207]
    s_add_u32 m0, s79, 8192
    s_nop 0
    buffer_load_dwordx4 v128, s[28:31], s81 offen lds
    buffer_load_dwordx4 v129, s[28:31], s81 offen offset:1024 lds
    s_add_u32 s81, s81, 16384
    v_mfma_f32_16x16x32_bf16 v[220:223], v[44:47], v[100:103], v[220:223]
    v_mfma_f32_16x16x32_bf16 v[236:239], v[44:47], v[104:107], v[236:239]
    v_mfma_f32_16x16x32_bf16 v[252:255], v[44:47], v[108:111], v[252:255]
    s_add_u32 s84, s84, 4096
    buffer_load_dwordx4 v[96:99], v135, s[16:19], s84 offen offset:0 sc1
    buffer_load_dwordx4 v[100:103], v135, s[16:19], s84 offen offset:256 sc1
    s_waitcnt vmcnt(5)
    s_waitcnt lgkmcnt(0)
    v_mfma_f32_16x16x32_bf16 v[192:195], v[32:35], v[112:115], v[192:195]
    ds_read_b64_tr_b16 v[40:41], v18 offset:12288
    v_mfma_f32_16x16x32_bf16 v[208:211], v[32:35], v[116:119], v[208:211]
    ds_read_b64_tr_b16 v[42:43], v18 offset:13312
    v_mfma_f32_16x16x32_bf16 v[224:227], v[32:35], v[120:123], v[224:227]
    ds_read_b64_tr_b16 v[44:45], v19 offset:12288
    v_mfma_f32_16x16x32_bf16 v[240:243], v[32:35], v[124:127], v[240:243]
    ds_read_b64_tr_b16 v[46:47], v19 offset:13312
    v_mfma_f32_16x16x32_bf16 v[196:199], v[36:39], v[112:115], v[196:199]
    s_add_u32 m0, s79, 10240
    s_nop 0
    buffer_load_dwordx4 v128, s[28:31], s81 offen lds
    buffer_load_dwordx4 v129, s[28:31], s81 offen offset:1024 lds
    s_add_u32 s81, s81, 16384
    v_mfma_f32_16x16x32_bf16 v[212:215], v[36:39], v[116:119], v[212:215]
    v_mfma_f32_16x16x32_bf16 v[228:231], v[36:39], v[120:123], v[228:231]
    v_mfma_f32_16x16x32_bf16 v[244:247], v[36:39], v[124:127], v[244:247]
    s_add_u32 s85, s85, 4096
    buffer_load_dwordx4 v[104:107], v135, s[16:19], s85 offen offset:0 sc1
    buffer_load_dwordx4 v[108:111], v135, s[16:19], s85 offen offset:256 sc1
    s_waitcnt vmcnt(5)
    s_waitcnt lgkmcnt(0)
    v_mfma_f32_16x16x32_bf16 v[200:203], v[40:43], v[112:115], v[200:203]
    ds_read_b64_tr_b16 v[32:33], v16 offset:0
    v_mfma_f32_16x16x32_bf16 v[216:219], v[40:43], v[116:119], v[216:219]
    ds_read_b64_tr_b16 v[34:35], v16 offset:1024
    v_mfma_f32_16x16x32_bf16 v[232:235], v[40:43], v[120:123], v[232:235]
    ds_read_b64_tr_b16 v[36:37], v17 offset:0
    v_mfma_f32_16x16x32_bf16 v[248:251], v[40:43], v[124:127], v[248:251]
    ds_read_b64_tr_b16 v[38:39], v17 offset:1024
    v_mfma_f32_16x16x32_bf16 v[204:207], v[44:47], v[112:115], v[204:207]
    s_add_u32 m0, s79, 12288
    s_nop 0
    buffer_load_dwordx4 v128, s[28:31], s81 offen lds
    buffer_load_dwordx4 v129, s[28:31], s81 offen offset:1024 lds
    s_add_u32 s81, s81, 16384
    v_mfma_f32_16x16x32_bf16 v[220:223], v[44:47], v[116:119], v[220:223]
    v_mfma_f32_16x16x32_bf16 v[236:239], v[44:47], v[120:123], v[236:239]
    v_mfma_f32_16x16x32_bf16 v[252:255], v[44:47], v[124:127], v[252:255]
    buffer_load_dwordx4 v[112:115], v135, s[16:19], s84 offen offset:2048 sc1
    buffer_load_dwordx4 v[116:119], v135, s[16:19], s84 offen offset:2304 sc1
    s_waitcnt vmcnt(5)
    s_waitcnt lgkmcnt(0)
    v_mfma_f32_16x16x32_bf16 v[192:195], v[32:35], v[64:67], v[192:195]
    ds_read_b64_tr_b16 v[40:41], v18 offset:0
    v_mfma_f32_16x16x32_bf16 v[208:211], v[32:35], v[68:71], v[208:211]
    ds_read_b64_tr_b16 v[42:43], v18 offset:1024
    v_mfma_f32_16x16x32_bf16 v[224:227], v[32:35], v[72:75], v[224:227]
    ds_read_b64_tr_b16 v[44:45], v19 offset:0
    v_mfma_f32_16x16x32_bf16 v[240:243], v[32:35], v[76:79], v[240:243]
    ds_read_b64_tr_b16 v[46:47], v19 offset:1024
    v_mfma_f32_16x16x32_bf16 v[196:199], v[36:39], v[64:67], v[196:199]
    s_add_u32 m0, s79, 14336
    s_nop 0
    buffer_load_dwordx4 v128, s[28:31], s81 offen lds
    buffer_load_dwordx4 v129, s[28:31], s81 offen offset:1024 lds
    s_add_u32 s81, s81, 16384
    v_mfma_f32_16x16x32_bf16 v[212:215], v[36:39], v[68:71], v[212:215]
    v_mfma_f32_16x16x32_bf16 v[228:231], v[36:39], v[72:75], v[228:231]
    v_mfma_f32_16x16x32_bf16 v[244:247], v[36:39], v[76:79], v[244:247]
    buffer_load_dwordx4 v[120:123], v135, s[16:19], s85 offen offset:2048 sc1
    buffer_load_dwordx4 v[124:127], v135, s[16:19], s85 offen offset:2304 sc1
    s_waitcnt vmcnt(5)
    s_waitcnt lgkmcnt(0)
    v_mfma_f32_16x16x32_bf16 v[200:203], v[40:43], v[64:67], v[200:203]
    ds_read_b64_tr_b16 v[32:33], v16 offset:4096
    v_mfma_f32_16x16x32_bf16 v[216:219], v[40:43], v[68:71], v[216:219]
    ds_read_b64_tr_b16 v[34:35], v16 offset:5120
    v_mfma_f32_16x16x32_bf16 v[232:235], v[40:43], v[72:75], v[232:235]
    ds_read_b64_tr_b16 v[36:37], v17 offset:4096
    v_mfma_f32_16x16x32_bf16 v[248:251], v[40:43], v[76:79], v[248:251]
    ds_read_b64_tr_b16 v[38:39], v17 offset:5120
    v_mfma_f32_16x16x32_bf16 v[204:207], v[44:47], v[64:67], v[204:207]
    s_add_u32 m0, s79, 0
    s_nop 0
    buffer_load_dwordx4 v128, s[28:31], s81 offen lds
    buffer_load_dwordx4 v129, s[28:31], s81 offen offset:1024 lds
    s_add_u32 s81, s81, 16384
    v_mfma_f32_16x16x32_bf16 v[220:223], v[44:47], v[68:71], v[220:223]
    v_mfma_f32_16x16x32_bf16 v[236:239], v[44:47], v[72:75], v[236:239]
    v_mfma_f32_16x16x32_bf16 v[252:255], v[44:47], v[76:79], v[252:255]
    s_add_u32 s84, s84, 4096
    buffer_load_dwordx4 v[64:67], v135, s[16:19], s84 offen offset:0 sc1
    buffer_load_dwordx4 v[68:71], v135, s[16:19], s84 offen offset:256 sc1
    s_waitcnt vmcnt(5)
    s_waitcnt lgkmcnt(0)
    v_mfma_f32_16x16x32_bf16 v[192:195], v[32:35], v[80:83], v[192:195]
    ds_read_b64_tr_b16 v[40:41], v18 offset:4096
    v_mfma_f32_16x16x32_bf16 v[208:211], v[32:35], v[84:87], v[208:211]
    ds_read_b64_tr_b16 v[42:43], v18 offset:5120
    v_mfma_f32_16x16x32_bf16 v[224:227], v[32:35], v[88:91], v[224:227]
    ds_read_b64_tr_b16 v[44:45], v19 offset:4096
    v_mfma_f32_16x16x32_bf16 v[240:243], v[32:35], v[92:95], v[240:243]
    ds_read_b64_tr_b16 v[46:47], v19 offset:5120
    v_mfma_f32_16x16x32_bf16 v[196:199], v[36:39], v[80:83], v[196:199]
    s_add_u32 m0, s79, 2048
    s_nop 0
    buffer_load_dwordx4 v128, s[28:31], s81 offen lds
    buffer_load_dwordx4 v129, s[28:31], s81 offen offset:1024 lds
    s_add_u32 s81, s81, 16384
    v_mfma_f32_16x16x32_bf16 v[212:215], v[36:39], v[84:87], v[212:215]
    v_mfma_f32_16x16x32_bf16 v[228:231], v[36:39], v[88:91], v[228:231]
    v_mfma_f32_16x16x32_bf16 v[244:247], v[36:39], v[92:95], v[244:247]
    s_add_u32 s85, s85, 4096
    buffer_load_dwordx4 v[72:75], v135, s[16:19], s85 offen offset:0 sc1
    buffer_load_dwordx4 v[76:79], v135, s[16:19], s85 offen offset:256 sc1
    s_waitcnt vmcnt(5)
    s_waitcnt lgkmcnt(0)
    v_mfma_f32_16x16x32_bf16 v[200:203], v[40:43], v[80:83], v[200:203]
    ds_read_b64_tr_b16 v[32:33], v16 offset:8192
    v_mfma_f32_16x16x32_bf16 v[216:219], v[40:43], v[84:87], v[216:219]
    ds_read_b64_tr_b16 v[34:35], v16 offset:9216
    v_mfma_f32_16x16x32_bf16 v[232:235], v[40:43], v[88:91], v[232:235]
    ds_read_b64_tr_b16 v[36:37], v17 offset:8192
    v_mfma_f32_16x16x32_bf16 v[248:251], v[40:43], v[92:95], v[248:251]
    ds_read_b64_tr_b16 v[38:39], v17 offset:9216
    v_mfma_f32_16x16x32_bf16 v[204:207], v[44:47], v[80:83], v[204:207]
    s_add_u32 m0, s79, 4096
    s_nop 0
    buffer_load_dwordx4 v128, s[28:31], s81 offen lds
    buffer_load_dwordx4 v129, s[28:31], s81 offen offset:1024 lds
    s_add_u32 s81, s81, 16384
    v_mfma_f32_16x16x32_bf16 v[220:223], v[44:47], v[84:87], v[220:223]
    v_mfma_f32_16x16x32_bf16 v[236:239], v[44:47], v[88:91], v[236:239]
    v_mfma_f32_16x16x32_bf16 v[252:255], v[44:47], v[92:95], v[252:255]
    buffer_load_dwordx4 v[80:83], v135, s[16:19], s84 offen offset:2048 sc1
    buffer_load_dwordx4 v[84:87], v135, s[16:19], s84 offen offset:2304 sc1
    s_waitcnt vmcnt(5)
    s_add_u32 m0, s79, 6144
    s_nop 0
    buffer_load_dwordx4 v128, s[28:31], s81 offen lds
    buffer_load_dwordx4 v129, s[28:31], s81 offen offset:1024 lds
    s_add_u32 s81, s81, 16384
    buffer_load_dwordx4 v[88:91], v135, s[16:19], s85 offen offset:2048 sc1
    buffer_load_dwordx4 v[92:95], v135, s[16:19], s85 offen offset:2304 sc1
    s_setprio 2
    s_barrier
    s_barrier
    s_waitcnt lgkmcnt(0)
    v_mfma_f32_16x16x32_bf16 v[192:195], v[32:35], v[96:99], v[192:195]
    ds_read_b64_tr_b16 v[40:41], v18 offset:8192
    v_mfma_f32_16x16x32_bf16 v[208:211], v[32:35], v[100:103], v[208:211]
    ds_read_b64_tr_b16 v[42:43], v18 offset:9216
    v_mfma_f32_16x16x32_bf16 v[224:227], v[32:35], v[104:107], v[224:227]
    ds_read_b64_tr_b16 v[44:45], v19 offset:8192
    v_mfma_f32_16x16x32_bf16 v[240:243], v[32:35], v[108:111], v[240:243]
    ds_read_b64_tr_b16 v[46:47], v19 offset:9216
    v_mfma_f32_16x16x32_bf16 v[196:199], v[36:39], v[96:99], v[196:199]
    v_mfma_f32_16x16x32_bf16 v[212:215], v[36:39], v[100:103], v[212:215]
    v_mfma_f32_16x16x32_bf16 v[228:231], v[36:39], v[104:107], v[228:231]
    v_mfma_f32_16x16x32_bf16 v[244:247], v[36:39], v[108:111], v[244:247]
    s_waitcnt lgkmcnt(0)
    v_mfma_f32_16x16x32_bf16 v[200:203], v[40:43], v[96:99], v[200:203]
    ds_read_b64_tr_b16 v[32:33], v16 offset:12288
    v_mfma_f32_16x16x32_bf16 v[216:219], v[40:43], v[100:103], v[216:219]
    ds_read_b64_tr_b16 v[34:35], v16 offset:13312
    v_mfma_f32_16x16x32_bf16 v[232:235], v[40:43], v[104:107], v[232:235]
    ds_read_b64_tr_b16 v[36:37], v17 offset:12288
    v_mfma_f32_16x16x32_bf16 v[248:251], v[40:43], v[108:111], v[248:251]
    ds_read_b64_tr_b16 v[38:39], v17 offset:13312
    v_mfma_f32_16x16x32_bf16 v[204:207], v[44:47], v[96:99], v[204:207]
    v_mfma_f32_16x16x32_bf16 v[220:223], v[44:47], v[100:103], v[220:223]
    v_mfma_f32_16x16x32_bf16 v[236:239], v[44:47], v[104:107], v[236:239]
    v_mfma_f32_16x16x32_bf16 v[252:255], v[44:47], v[108:111], v[252:255]
    s_waitcnt lgkmcnt(0)
    v_mfma_f32_16x16x32_bf16 v[192:195], v[32:35], v[112:115], v[192:195]
    ds_read_b64_tr_b16 v[40:41], v18 offset:12288
    v_mfma_f32_16x16x32_bf16 v[208:211], v[32:35], v[116:119], v[208:211]
    ds_read_b64_tr_b16 v[42:43], v18 offset:13312
    v_mfma_f32_16x16x32_bf16 v[224:227], v[32:35], v[120:123], v[224:227]
    ds_read_b64_tr_b16 v[44:45], v19 offset:12288
    v_mfma_f32_16x16x32_bf16 v[240:243], v[32:35], v[124:127], v[240:243]
    ds_read_b64_tr_b16 v[46:47], v19 offset:13312
    v_mfma_f32_16x16x32_bf16 v[196:199], v[36:39], v[112:115], v[196:199]
    v_mfma_f32_16x16x32_bf16 v[212:215], v[36:39], v[116:119], v[212:215]
    v_mfma_f32_16x16x32_bf16 v[228:231], v[36:39], v[120:123], v[228:231]
    v_mfma_f32_16x16x32_bf16 v[244:247], v[36:39], v[124:127], v[244:247]
    s_waitcnt lgkmcnt(0)
    v_mfma_f32_16x16x32_bf16 v[200:203], v[40:43], v[112:115], v[200:203]
    ds_read_b64_tr_b16 v[32:33], v16 offset:0
    v_mfma_f32_16x16x32_bf16 v[216:219], v[40:43], v[116:119], v[216:219]
    ds_read_b64_tr_b16 v[34:35], v16 offset:1024
    v_mfma_f32_16x16x32_bf16 v[232:235], v[40:43], v[120:123], v[232:235]
    ds_read_b64_tr_b16 v[36:37], v17 offset:0
    v_mfma_f32_16x16x32_bf16 v[248:251], v[40:43], v[124:127], v[248:251]
    ds_read_b64_tr_b16 v[38:39], v17 offset:1024
    v_mfma_f32_16x16x32_bf16 v[204:207], v[44:47], v[112:115], v[204:207]
    v_mfma_f32_16x16x32_bf16 v[220:223], v[44:47], v[116:119], v[220:223]
    v_mfma_f32_16x16x32_bf16 v[236:239], v[44:47], v[120:123], v[236:239]
    v_mfma_f32_16x16x32_bf16 v[252:255], v[44:47], v[124:127], v[252:255]
    s_waitcnt vmcnt(8)
    s_waitcnt lgkmcnt(0)
    v_mfma_f32_16x16x32_bf16 v[192:195], v[32:35], v[64:67], v[192:195]
    ds_read_b64_tr_b16 v[40:41], v18 offset:0
    v_mfma_f32_16x16x32_bf16 v[208:211], v[32:35], v[68:71], v[208:211]
    ds_read_b64_tr_b16 v[42:43], v18 offset:1024
    v_mfma_f32_16x16x32_bf16 v[224:227], v[32:35], v[72:75], v[224:227]
    ds_read_b64_tr_b16 v[44:45], v19 offset:0
    v_mfma_f32_16x16x32_bf16 v[240:243], v[32:35], v[76:79], v[240:243]
    ds_read_b64_tr_b16 v[46:47], v19 offset:1024
    v_mfma_f32_16x16x32_bf16 v[196:199], v[36:39], v[64:67], v[196:199]
    v_mfma_f32_16x16x32_bf16 v[212:215], v[36:39], v[68:71], v[212:215]
    v_mfma_f32_16x16x32_bf16 v[228:231], v[36:39], v[72:75], v[228:231]
    v_mfma_f32_16x16x32_bf16 v[244:247], v[36:39], v[76:79], v[244:247]
    s_waitcnt vmcnt(2)
    s_waitcnt lgkmcnt(0)
    v_mfma_f32_16x16x32_bf16 v[200:203], v[40:43], v[64:67], v[200:203]
    ds_read_b64_tr_b16 v[32:33], v16 offset:4096
    v_mfma_f32_16x16x32_bf16 v[216:219], v[40:43], v[68:71], v[216:219]
    ds_read_b64_tr_b16 v[34:35], v16 offset:5120
    v_mfma_f32_16x16x32_bf16 v[232:235], v[40:43], v[72:75], v[232:235]
    ds_read_b64_tr_b16 v[36:37], v17 offset:4096
    v_mfma_f32_16x16x32_bf16 v[248:251], v[40:43], v[76:79], v[248:251]
    ds_read_b64_tr_b16 v[38:39], v17 offset:5120
    v_mfma_f32_16x16x32_bf16 v[204:207], v[44:47], v[64:67], v[204:207]
    v_mfma_f32_16x16x32_bf16 v[220:223], v[44:47], v[68:71], v[220:223]
    v_mfma_f32_16x16x32_bf16 v[236:239], v[44:47], v[72:75], v[236:239]
    v_mfma_f32_16x16x32_bf16 v[252:255], v[44:47], v[76:79], v[252:255]
    s_waitcnt vmcnt(0)
    s_waitcnt lgkmcnt(0)
    v_mfma_f32_16x16x32_bf16 v[192:195], v[32:35], v[80:83], v[192:195]
    ds_read_b64_tr_b16 v[40:41], v18 offset:4096
    v_mfma_f32_16x16x32_bf16 v[208:211], v[32:35], v[84:87], v[208:211]
    ds_read_b64_tr_b16 v[42:43], v18 offset:5120
    v_mfma_f32_16x16x32_bf16 v[224:227], v[32:35], v[88:91], v[224:227]
    ds_read_b64_tr_b16 v[44:45], v19 offset:4096
    v_mfma_f32_16x16x32_bf16 v[240:243], v[32:35], v[92:95], v[240:243]
    ds_read_b64_tr_b16 v[46:47], v19 offset:5120
    v_mfma_f32_16x16x32_bf16 v[196:199], v[36:39], v[80:83], v[196:199]
    v_mfma_f32_16x16x32_bf16 v[212:215], v[36:39], v[84:87], v[212:215]
    v_mfma_f32_16x16x32_bf16 v[228:231], v[36:39], v[88:91], v[228:231]
    v_mfma_f32_16x16x32_bf16 v[244:247], v[36:39], v[92:95], v[244:247]
    s_waitcnt lgkmcnt(0)
    v_mfma_f32_16x16x32_bf16 v[200:203], v[40:43], v[80:83], v[200:203]
    v_mfma_f32_16x16x32_bf16 v[216:219], v[40:43], v[84:87], v[216:219]
    v_mfma_f32_16x16x32_bf16 v[232:235], v[40:43], v[88:91], v[232:235]
    v_mfma_f32_16x16x32_bf16 v[248:251], v[40:43], v[92:95], v[248:251]
    v_mfma_f32_16x16x32_bf16 v[204:207], v[44:47], v[80:83], v[204:207]
    v_mfma_f32_16x16x32_bf16 v[220:223], v[44:47], v[84:87], v[220:223]
    v_mfma_f32_16x16x32_bf16 v[236:239], v[44:47], v[88:91], v[236:239]
    v_mfma_f32_16x16x32_bf16 v[252:255], v[44:47], v[92:95], v[252:255]
    s_mov_b32 s50, 131072
L_pollO:
    s_mov_b64 exec, s[90:91]
    buffer_load_dwordx2 v[8:9], v133, s[16:19], s89 offen sc1
    s_mov_b64 exec, -1
    s_waitcnt vmcnt(0)
L_pollO_w:
    v_cmp_eq_u64 vcc, s[48:49], v[8:9]
    s_sub_u32 s50, s50, 1
    s_cbranch_scc1 L_pollO_x
    s_and_b64 vcc, vcc, s[90:91]
    s_cmp_eq_u64 vcc, s[90:91]
    s_cbranch_scc0 L_pollO
L_pollO_x:
    buffer_load_dwordx4 v[64:67], v135, s[16:19], s86 offen offset:0 sc1
    buffer_load_dwordx4 v[68:71], v135, s[16:19], s86 offen offset:256 sc1
    buffer_load_dwordx4 v[72:75], v135, s[16:19], s86 offen offset:2048 sc1
    buffer_load_dwordx4 v[76:79], v135, s[16:19], s86 offen offset:2304 sc1
    s_add_u32 s86, s86, 4096
    buffer_load_dwordx4 v[80:83], v135, s[16:19], s86 offen offset:0 sc1
    buffer_load_dwordx4 v[84:87], v135, s[16:19], s86 offen offset:256 sc1
    buffer_load_dwordx4 v[88:91], v135, s[16:19], s86 offen offset:2048 sc1
    buffer_load_dwordx4 v[92:95], v135, s[16:19], s86 offen offset:2304 sc1
    buffer_load_dwordx4 v[96:99], v135, s[16:19], s87 offen offset:0 sc1
    buffer_load_dwordx4 v[100:103], v135, s[16:19], s87 offen offset:256 sc1
    buffer_load_dwordx4 v[104:107], v135, s[16:19], s87 offen offset:2048 sc1
    buffer_load_dwordx4 v[108:111], v135, s[16:19], s87 offen offset:2304 sc1
    s_add_u32 s87, s87, 4096
    buffer_load_dwordx4 v[112:115], v135, s[16:19], s87 offen offset:0 sc1
    buffer_load_dwordx4 v[116:119], v135, s[16:19], s87 offen offset:256 sc1
    buffer_load_dwordx4 v[120:123], v135, s[16:19], s87 offen offset:2048 sc1
    buffer_load_dwordx4 v[124:127], v135, s[16:19], s87 offen offset:2304 sc1
    s_waitcnt vmcnt(15)
    v_mfma_f32_16x16x32_bf16 v[192:195], v[144:147], v[64:67], v[192:195]
    v_mfma_f32_16x16x32_bf16 v[196:199], v[148:151], v[64:67], v[196:199]
    v_mfma_f32_16x16x32_bf16 v[200:203], v[152:155], v[64:67], v[200:203]
    v_mfma_f32_16x16x32_bf16 v[204:207], v[156:159], v[64:67], v[204:207]
    s_waitcnt vmcnt(14)
    v_mfma_f32_16x16x32_bf16 v[208:211], v[144:147], v[68:71], v[208:211]
    v_mfma_f32_16x16x32_bf16 v[212:215], v[148:151], v[68:71], v[212:215]
    v_mfma_f32_16x16x32_bf16 v[216:219], v[152:155], v[68:71], v[216:219]
    v_mfma_f32_16x16x32_bf16 v[220:223], v[156:159], v[68:71], v[220:223]
    s_waitcnt vmcnt(13)
    v_mfma_f32_16x16x32_bf16 v[192:195], v[160:163], v[72:75], v[192:195]
    v_mfma_f32_16x16x32_bf16 v[196:199], v[164:167], v[72:75], v[196:199]
    v_mfma_f32_16x16x32_bf16 v[200:203], v[168:171], v[72:75], v[200:203]
    v_mfma_f32_16x16x32_bf16 v[204:207], v[172:175], v[72:75], v[204:207]
    s_waitcnt vmcnt(12)
    v_mfma_f32_16x16x32_bf16 v[208:211], v[160:163], v[76:79], v[208:211]
    v_mfma_f32_16x16x32_bf16 v[212:215], v[164:167], v[76:79], v[212:215]
    v_mfma_f32_16x16x32_bf16 v[216:219], v[168:171], v[76:79], v[216:219]
    v_mfma_f32_16x16x32_bf16 v[220:223], v[172:175], v[76:79], v[220:223]
    s_waitcnt vmcnt(11)
    v_mfma_f32_16x16x32_bf16 v[192:195], v[176:179], v[80:83], v[192:195]
    v_mfma_f32_16x16x32_bf16 v[196:199], v[180:183], v[80:83], v[196:199]
    v_mfma_f32_16x16x32_bf16 v[200:203], v[184:187], v[80:83], v[200:203]
    v_mfma_f32_16x16x32_bf16 v[204:207], v[188:191], v[80:83], v[204:207]
    s_waitcnt vmcnt(10)
    v_mfma_f32_16x16x32_bf16 v[208:211], v[176:179], v[84:87], v[208:211]
    v_mfma_f32_16x16x32_bf16 v[212:215], v[180:183], v[84:87], v[212:215]
    v_mfma_f32_16x16x32_bf16 v[216:219], v[184:187], v[84:87], v[216:219]
    v_mfma_f32_16x16x32_bf16 v[220:223], v[188:191], v[84:87], v[220:223]
    s_waitcnt vmcnt(9)
    v_mfma_f32_16x16x32_bf16 v[192:195], v[48:51], v[88:91], v[192:195]
    v_mfma_f32_16x16x32_bf16 v[196:199], v[52:55], v[88:91], v[196:199]
    v_mfma_f32_16x16x32_bf16 v[200:203], v[56:59], v[88:91], v[200:203]
    v_mfma_f32_16x16x32_bf16 v[204:207], v[60:63], v[88:91], v[204:207]
    s_waitcnt vmcnt(8)
    v_mfma_f32_16x16x32_bf16 v[208:211], v[48:51], v[92:95], v[208:211]
    v_mfma_f32_16x16x32_bf16 v[212:215], v[52:55], v[92:95], v[212:215]
    v_mfma_f32_16x16x32_bf16 v[216:219], v[56:59], v[92:95], v[216:219]
    v_mfma_f32_16x16x32_bf16 v[220:223], v[60:63], v[92:95], v[220:223]
    s_waitcnt vmcnt(7)
    v_mfma_f32_16x16x32_bf16 v[224:227], v[144:147], v[96:99], v[224:227]
    v_mfma_f32_16x16x32_bf16 v[228:231], v[148:151], v[96:99], v[228:231]
    v_mfma_f32_16x16x32_bf16 v[232:235], v[152:155], v[96:99], v[232:235]
    v_mfma_f32_16x16x32_bf16 v[236:239], v[156:159], v[96:99], v[236:239]
    s_waitcnt vmcnt(6)
    v_mfma_f32_16x16x32_bf16 v[240:243], v[144:147], v[100:103], v[240:243]
    v_mfma_f32_16x16x32_bf16 v[244:247], v[148:151], v[100:103], v[244:247]
    v_mfma_f32_16x16x32_bf16 v[248:251], v[152:155], v[100:103], v[248:251]
    v_mfma_f32_16x16x32_bf16 v[252:255], v[156:159], v[100:103], v[252:255]
    s_waitcnt vmcnt(5)
    v_mfma_f32_16x16x32_bf16 v[224:227], v[160:163], v[104:107], v[224:227]
    v_mfma_f32_16x16x32_bf16 v[228:231], v[164:167], v[104:107], v[228:231]
    v_mfma_f32_16x16x32_bf16 v[232:235], v[168:171], v[104:107], v[232:235]
    v_mfma_f32_16x16x32_bf16 v[236:239], v[172:175], v[104:107], v[236:239]
    s_waitcnt vmcnt(4)
    v_mfma_f32_16x16x32_bf16 v[240:243], v[160:163], v[108:111], v[240:243]
    v_mfma_f32_16x16x32_bf16 v[244:247], v[164:167], v[108:111], v[244:247]
    v_mfma_f32_16x16x32_bf16 v[248:251], v[168:171], v[108:111], v[248:251]
    v_mfma_f32_16x16x32_bf16 v[252:255], v[172:175], v[108:111], v[252:255]
    s_waitcnt vmcnt(3)
    v_mfma_f32_16x16x32_bf16 v[224:227], v[176:179], v[112:115], v[224:227]
    v_mfma_f32_16x16x32_bf16 v[228:231], v[180:183], v[112:115], v[228:231]
    v_mfma_f32_16x16x32_bf16 v[232:235], v[184:187], v[112:115], v[232:235]
    v_mfma_f32_16x16x32_bf16 v[236:239], v[188:191], v[112:115], v[236:239]
    ds_write_b128 v134, v[192:195] offset:0
    ds_write_b128 v134, v[196:199] offset:1152
    s_waitcnt vmcnt(2)
    v_mfma_f32_16x16x32_bf16 v[240:243], v[176:179], v[116:119], v[240:243]
    v_mfma_f32_16x16x32_bf16 v[244:247], v[180:183], v[116:119], v[244:247]
    v_mfma_f32_16x16x32_bf16 v[248:251], v[184:187], v[116:119], v[248:251]
    v_mfma_f32_16x16x32_bf16 v[252:255], v[188:191], v[116:119], v[252:255]
    ds_write_b128 v134, v[200:203] offset:2304
    ds_write_b128 v134, v[204:207] offset:3456
    s_waitcnt vmcnt(1)
    v_mfma_f32_16x16x32_bf16 v[224:227], v[48:51], v[120:123], v[224:227]
    v_mfma_f32_16x16x32_bf16 v[228:231], v[52:55], v[120:123], v[228:231]
    v_mfma_f32_16x16x32_bf16 v[232:235], v[56:59], v[120:123], v[232:235]
    v_mfma_f32_16x16x32_bf16 v[236:239], v[60:63], v[120:123], v[236:239]
    ds_write_b128 v134, v[208:211] offset:4608
    ds_write_b128 v134, v[212:215] offset:5760
    s_waitcnt vmcnt(0)
    v_mfma_f32_16x16x32_bf16 v[240:243], v[48:51], v[124:127], v[240:243]
    v_mfma_f32_16x16x32_bf16 v[244:247], v[52:55], v[124:127], v[244:247]
    v_mfma_f32_16x16x32_bf16 v[248:251], v[56:59], v[124:127], v[248:251]
    v_mfma_f32_16x16x32_bf16 v[252:255], v[60:63], v[124:127], v[252:255]
    ds_write_b128 v134, v[216:219] offset:6912
    ds_write_b128 v134, v[220:223] offset:8064
    s_nop 1
    ds_write_b128 v134, v[224:227] offset:9216
    ds_write_b128 v134, v[228:231] offset:10368
    ds_write_b128 v134, v[232:235] offset:11520
    ds_write_b128 v134, v[236:239] offset:12672
    ds_write_b128 v134, v[240:243] offset:13824
    ds_write_b128 v134, v[244:247] offset:14976
    ds_write_b128 v134, v[248:251] offset:16128
    ds_write_b128 v134, v[252:255] offset:17280
L_fin:
    s_waitcnt vmcnt(0)
    v_lshlrev_b32 v64, 16, v140
    v_and_b32 v65, 0xffff0000, v140
    v_lshlrev_b32 v66, 16, v141
    v_and_b32 v67, 0xffff0000, v141
    v_lshlrev_b32 v68, 16, v142
    v_and_b32 v69, 0xffff0000, v142
    v_lshlrev_b32 v70, 16, v143
    v_and_b32 v71, 0xffff0000, v143
    s_waitcnt lgkmcnt(0)
    s_barrier
    ds_read_b128 v[144:147], v136 offset:0
    ds_read_b128 v[148:151], v136 offset:256
    ds_read_b128 v[152:155], v136 offset:18432
    ds_read_b128 v[156:159], v136 offset:18688
    ds_read_b128 v[160:163], v136 offset:36864
    ds_read_b128 v[164:167], v136 offset:37120
    ds_read_b128 v[168:171], v136 offset:55296
    ds_read_b128 v[172:175], v136 offset:55552
    s_waitcnt lgkmcnt(6)
    v_pk_add_f32 v[64:65], v[64:65], v[144:145]
    v_pk_add_f32 v[66:67], v[66:67], v[146:147]
    v_pk_add_f32 v[68:69], v[68:69], v[148:149]
    v_pk_add_f32 v[70:71], v[70:71], v[150:151]
    s_waitcnt lgkmcnt(4)
    v_pk_add_f32 v[64:65], v[64:65], v[152:153]
    v_pk_add_f32 v[66:67], v[66:67], v[154:155]
    v_pk_add_f32 v[68:69], v[68:69], v[156:157]
    v_pk_add_f32 v[70:71], v[70:71], v[158:159]
    s_waitcnt lgkmcnt(2)
    v_pk_add_f32 v[64:65], v[64:65], v[160:161]
    v_pk_add_f32 v[66:67], v[66:67], v[162:163]
    v_pk_add_f32 v[68:69], v[68:69], v[164:165]
    v_pk_add_f32 v[70:71], v[70:71], v[166:167]
    s_waitcnt lgkmcnt(0)
    v_pk_add_f32 v[64:65], v[64:65], v[168:169]
    v_pk_add_f32 v[66:67], v[66:67], v[170:171]
    v_pk_add_f32 v[68:69], v[68:69], v[172:173]
    v_pk_add_f32 v[70:71], v[70:71], v[174:175]
    v_cvt_pk_bf16_f32 v72, v64, v65
    v_cvt_pk_bf16_f32 v73, v66, v67
    v_cvt_pk_bf16_f32 v74, v68, v69
    v_cvt_pk_bf16_f32 v75, v70, v71
    buffer_store_dwordx4 v[72:75], v137, s[40:43], s94 offen sc0 sc1
L_exit:
    s_endpgm
.section .rodata,"a"
.p2align 6
.amdhsa_kernel parallel_sum__mha_block__glu_gated_reglu__prompt_kernel
  .amdhsa_next_free_vgpr 256
  .amdhsa_next_free_sgpr 96
  .amdhsa_accum_offset 256
  .amdhsa_group_segment_fixed_size 0
  .amdhsa_kernarg_size 80
  .amdhsa_user_sgpr_count 2
  .amdhsa_user_sgpr_kernarg_segment_ptr 1
  .amdhsa_system_sgpr_workgroup_id_x 1
.end_amdhsa_kernel
```
